```python
import torch

def _softmax(x, axis=-1):
    return torch.softmax(x, dim=axis)
def _gelu(x):
    return torch.nn.functional.gelu(x, approximate="tanh")
def _silu(x):
    return torch.nn.functional.silu(x)
def _sigmoid(x):
    return torch.sigmoid(x)
def _layernorm(x, axis=-1, eps=1e-5):
    m = x.mean(dim=axis, keepdim=True)
    v = x.var(dim=axis, keepdim=True, unbiased=False)
    return (x - m) / torch.sqrt(v + eps)
def _scatter_add(tgt, idx, src, axis=0):
    return tgt.clone().index_add_(axis, idx, src)
def _segment_sum(src, seg, n):
    out = torch.zeros((n,) + src.shape[1:], dtype=src.dtype)
    return out.index_add_(0, seg, src)
def _pad(x, pw):
    flat = tuple(v for pair in reversed(pw) for v in pair)
    return torch.nn.functional.pad(x, flat)

kernel_name = 'parallel_sum__linear_attn_block__mixer_channel_mlp__prompt'

def setup_inputs():

    _w = (lambda a: (lambda t: t.to(torch.bfloat16) if t.is_floating_point() else t)(torch.as_tensor(a)))
    def _A_setup():
        B, S, D = 1, 2048, 640
        return {
            "x": _w((lambda *s: torch.randn(*s, dtype=torch.bfloat16) * 0.05)(B, S, D)),
            "wqkv": _w((lambda *s: torch.randn(*s, dtype=torch.bfloat16) * 0.1)(D, 3 * D)),
            "wo": _w((lambda *s: torch.randn(*s, dtype=torch.bfloat16) * 0.05)(D, D)),
        }
    _A_in = _A_setup()

    def _B_setup():
        B, S, D, F = 1, 2048, 640, 1536
        return {
            "x": _w((lambda *s: torch.randn(*s, dtype=torch.bfloat16) * 0.05)(B, S, D)),
            "w1": _w((lambda *s: torch.randn(*s, dtype=torch.bfloat16) * 1.6)(D, F) * (D ** -0.5)),
            "b1": _w((lambda *s: torch.randn(*s, dtype=torch.bfloat16) * 0.8)(F)),
            "w2": _w((lambda *s: torch.randn(*s, dtype=torch.bfloat16) * 0.05)(F, D) * (F ** -0.5)),
            "b2": _w((lambda *s: torch.randn(*s, dtype=torch.bfloat16) * 0.05)(D)),
        }
    _B_in = _B_setup()

    return {
        "A_x": _A_in["x"],
        "A_wqkv": _A_in["wqkv"],
        "A_wo": _A_in["wo"],
        "B_x": _B_in["x"],
        "B_w1": _B_in["w1"],
        "B_b1": _B_in["b1"],
        "B_w2": _B_in["w2"],
        "B_b2": _B_in["b2"],
    }

def reference(A_x, A_wqkv, A_wo, B_x, B_w1, B_b1, B_w2, B_b2):
    def _A_ref(x, wqkv, wo):
        B, S, D = x.shape
        H = 32; Dh = D // H
        qkv = (lambda x, *d: x.permute(*d))((x @ wqkv).reshape(B, S, 3, H, Dh), 2, 0, 3, 1, 4)
        q, k, v = qkv[0], qkv[1], qkv[2]
        phi = lambda t: torch.where(t > 0, t + 1, torch.exp(t)) + 1e-6
        pq, pk = phi(q), phi(k)
        kv = torch.einsum("bhsd,bhse->bhde", pk, v)
        z = torch.einsum("bhsd->bhd", pk)
        num = torch.einsum("bhqd,bhde->bhqe", pq, kv)
        den = torch.einsum("bhqd,bhd->bhq", pq, z)[..., None] + 1e-6
        o = num / den
        return (lambda x, *d: x.permute(*d))(o, 0, 2, 1, 3).reshape(B, S, D) @ wo

    def _B_ref(x, w1, b1, w2, b2):
        y = _layernorm(x, axis=-1)
        h = _gelu(torch.einsum("bsd,df->bsf", y, w1) + b1)
        return torch.einsum("bsf,fd->bsd", h, w2) + b2

    x = A_x
    xn = _layernorm(x, axis=-1)
    return x + _A_ref(xn, A_wqkv, A_wo) + _B_ref(xn, B_w1, B_b1, B_w2, B_b2)
```

```asm
; @launch kernel=kf_kernel grid=(256,1,1) block=(256,1,1) lds=163072
.amdgcn_target "amdgcn-amd-amdhsa--gfx950"
.text
.globl kf_kernel
.p2align 8
.type kf_kernel,@function
kf_kernel:
    s_cmp_ge_u32 s2, 256
    s_cbranch_scc1 KF_END
    s_load_dwordx2 s[64:65], s[0:1], 0
    s_load_dwordx2 s[26:27], s[0:1], 8
    s_load_dwordx2 s[66:67], s[0:1], 16
    s_load_dwordx4 s[28:31], s[0:1], 32
    s_load_dwordx8 s[68:75], s[0:1], 48
    s_load_dwordx2 s[76:77], s[0:1], 80
    s_getpc_b64 s[4:5]
KPC:
    s_lshr_b32 s63, s2, 3
    s_mov_b32 s6, KF_END-KPC
    s_mov_b32 s7, 0x00020000
    s_bitcmp1_b32 s63, 4
    s_cselect_b32 s3, K1_QH-KPC, 0
    s_and_b32 s8, s63, 15
    s_lshl_b32 s8, s8, 12
    s_add_u32 s8, s8, s3
    v_lshrrev_b32 v6, 3, v0
    v_lshlrev_b32 v6, 7, v6
    buffer_load_dword v19, v6, s[4:7], s8 offen
    s_getreg_b32 s62, hwreg(HW_REG_XCC_ID, 0, 3)
    v_and_b32 v1, 63, v0
    v_lshrrev_b32 v2, 6, v0
    s_nop 0
    v_readfirstlane_b32 s20, v2
    v_lshrrev_b32 v2, 4, v1
    v_and_b32 v3, 15, v1
    v_lshrrev_b32 v4, 2, v3
    v_and_b32 v5, 3, v3
    s_lshl_b32 s59, s62, 8
    s_mov_b32 s99, s2
    s_and_b32 s3, s2, 7
    s_cmp_lg_u32 s3, s62
    s_cbranch_scc1 SLOW
RESTART:
    s_lshl_b32 s21, s62, 1
    s_and_b32 s3, s63, 1
    s_add_u32 s21, s21, s3
    s_bfe_u32 s22, s63, 0x30001
    s_mov_b32 s61, s22
    s_bitcmp1_b32 s63, 4
    s_cbranch_scc1 K1_QH
    s_lshl_b32 s23, s21, 3
    s_lshl_b32 s36, s20, 1
    s_add_u32 s23, s23, s36
    s_mul_i32 s36, s23, 20480
    v_lshrrev_b32 v24, 3, v1
    v_mul_u32_u24 v25, 1280, v24
    v_add_u32 v25, s36, v25
    v_and_b32 v26, 7, v1
    v_xor_b32 v26, v26, v2
    v_lshl_add_u32 v6, v26, 4, v25
    v_xor_b32 v26, 4, v26
    v_lshl_add_u32 v7, v26, 4, v25
    v_add_u32 v9, 27648, v7
    v_add_u32 v7, 9216, v7
    v_add_u32 v8, 18432, v6
    s_lshl_b32 s47, s20, 12
    s_add_u32 s47, s47, 20480
    s_add_u32 s32, s21, s22
    s_cmp_ge_u32 s32, 20
    s_cselect_b32 s36, 20, 0
    s_sub_u32 s32, s32, s36
    s_cmp_ge_u32 s32, 10
    s_cselect_b32 s36, 10, 0
    s_sub_u32 s32, s32, s36
    s_mul_i32 s49, s22, 12800
    s_add_u32 s49, s49, 131072
    s_mul_i32 s50, s21, 10240
    s_add_u32 s50, s50, 360448
    s_mul_i32 s45, s32, 1280
    s_add_u32 s45, s45, s49
    s_lshl_b32 s46, s32, 10
    s_add_u32 s46, s46, s50
    s_lshl_b32 s32, s32, 7
    s_mul_i32 s34, s20, 5120
    s_lshr_b32 s44, s20, 1
    s_mul_i32 s35, s44, 1280
    s_add_u32 s35, s35, 1280
    s_mul_i32 s36, s22, 160
    s_and_b32 s37, s20, 1
    s_mul_i32 s37, s37, 320
    s_waitcnt lgkmcnt(0)
    s_cmp_ge_u32 s99, 4
    s_cbranch_scc1 ZI_E
    s_add_u32 s80, s76, 0x01400000
    s_addc_u32 s81, s77, 0
    s_mov_b32 s82, 0x00080000
    s_mov_b32 s83, 0x00020000
    s_mov_b32 s99, s2
    s_cmp_ge_u32 s2, 4
    s_cbranch_scc1 ZF_1
    s_and_b32 s3, s2, 1
    s_lshl_b32 s3, s3, 8
    v_add_u32 v24, s3, v0
    s_cmp_ge_u32 s2, 2
    s_cselect_b32 s3, 4, 7
    s_cselect_b32 s92, 0, 65536
    v_lshlrev_b32 v24, s3, v24
    v_mov_b32 v20, 0
    v_mov_b32 v21, 0
    v_mov_b32 v22, 0
    v_mov_b32 v23, 0
    buffer_store_dwordx4 v[20:23], v24, s[80:83], s92 offen sc1
ZF_1:
ZI_E:
    s_mov_b32 s88, s64
    s_mov_b32 s89, s65
    s_mov_b32 s90, 0x00280000
    s_mov_b32 s91, 0x00020000
    s_add_u32 m0, s47, 0
    s_nop 0
    buffer_load_dwordx4 v6, s[88:91], s32 offen offset:0 lds
    buffer_load_dwordx4 v7, s[88:91], s32 offen offset:1024 lds
    buffer_load_dwordx4 v8, s[88:91], s32 offen offset:2048 lds
    buffer_load_dwordx4 v9, s[88:91], s32 offen offset:3072 lds
    s_mov_b32 s8, s26
    s_mov_b32 s9, s27
    s_mov_b32 s10, 0x00258000
    s_mov_b32 s11, 0x00020000
    v_add_u32 v24, s37, v1
    v_mul_u32_u24 v25, 6554, v24
    v_lshrrev_b32 v25, 16, v25
    v_mul_u32_u24 v26, 10, v25
    v_sub_u32 v26, v24, v26
    v_bfe_u32 v27, v25, 2, 1
    v_bfe_u32 v28, v25, 3, 1
    v_xor_b32 v27, v27, v28
    v_mul_u32_u24 v27, 12, v27
    v_xor_b32 v27, v27, v25
    v_mul_u32_u24 v10, 3840, v27
    v_lshl_add_u32 v10, v26, 4, v10
    v_add_u32 v10, s36, v10
    s_mul_i32 s33, s32, 1920
    s_add_u32 s33, s33, s35
    s_add_u32 m0, s34, 0
    s_nop 0
    buffer_load_dwordx4 v10, s[8:11], s33 offen offset:0 lds
    v_add_u32 v24, s37, v1
    v_add_u32 v24, 64, v24
    v_mul_u32_u24 v25, 6554, v24
    v_lshrrev_b32 v25, 16, v25
    v_mul_u32_u24 v26, 10, v25
    v_sub_u32 v26, v24, v26
    v_bfe_u32 v27, v25, 2, 1
    v_bfe_u32 v28, v25, 3, 1
    v_xor_b32 v27, v27, v28
    v_mul_u32_u24 v27, 12, v27
    v_xor_b32 v27, v27, v25
    v_mul_u32_u24 v11, 3840, v27
    v_lshl_add_u32 v11, v26, 4, v11
    v_add_u32 v11, s36, v11
    v_subrev_u32 v11, 1024, v11
    buffer_load_dwordx4 v11, s[8:11], s33 offen offset:1024 lds
    v_add_u32 v24, s37, v1
    v_add_u32 v24, 128, v24
    v_mul_u32_u24 v25, 6554, v24
    v_lshrrev_b32 v25, 16, v25
    v_mul_u32_u24 v26, 10, v25
    v_sub_u32 v26, v24, v26
    v_bfe_u32 v27, v25, 2, 1
    v_bfe_u32 v28, v25, 3, 1
    v_xor_b32 v27, v27, v28
    v_mul_u32_u24 v27, 12, v27
    v_xor_b32 v27, v27, v25
    v_mul_u32_u24 v12, 3840, v27
    v_lshl_add_u32 v12, v26, 4, v12
    v_add_u32 v12, s36, v12
    v_subrev_u32 v12, 2048, v12
    buffer_load_dwordx4 v12, s[8:11], s33 offen offset:2048 lds
    v_add_u32 v24, s37, v1
    v_add_u32 v24, 192, v24
    v_mul_u32_u24 v25, 6554, v24
    v_lshrrev_b32 v25, 16, v25
    v_mul_u32_u24 v26, 10, v25
    v_sub_u32 v26, v24, v26
    v_bfe_u32 v27, v25, 2, 1
    v_bfe_u32 v28, v25, 3, 1
    v_xor_b32 v27, v27, v28
    v_mul_u32_u24 v27, 12, v27
    v_xor_b32 v27, v27, v25
    v_mul_u32_u24 v13, 3840, v27
    v_lshl_add_u32 v13, v26, 4, v13
    v_add_u32 v13, s36, v13
    v_subrev_u32 v13, 3072, v13
    buffer_load_dwordx4 v13, s[8:11], s33 offen offset:3072 lds
    v_add_u32 v24, s37, v1
    v_add_u32 v24, 256, v24
    v_mul_u32_u24 v25, 6554, v24
    v_lshrrev_b32 v25, 16, v25
    v_mul_u32_u24 v26, 10, v25
    v_sub_u32 v26, v24, v26
    v_bfe_u32 v27, v25, 2, 1
    v_bfe_u32 v28, v25, 3, 1
    v_xor_b32 v27, v27, v28
    v_mul_u32_u24 v27, 12, v27
    v_xor_b32 v27, v27, v25
    v_mul_u32_u24 v14, 3840, v27
    v_lshl_add_u32 v14, v26, 4, v14
    v_add_u32 v14, s36, v14
    s_add_u32 m0, s34, 4096
    s_nop 0
    buffer_load_dwordx4 v14, s[8:11], s33 offen offset:0 lds
    s_lshl_b32 s44, s44, 7
    s_add_u32 s44, s44, s32
    s_cmpk_eq_u32 s44, 1280
    s_cselect_b32 s44, 0, s44
    s_mul_i32 s44, s44, 1920
    s_add_u32 s32, s32, 128
    s_cmpk_eq_u32 s32, 1280
    s_cselect_b32 s32, 0, s32
    s_add_u32 m0, s47, 36864
    s_nop 0
    buffer_load_dwordx4 v6, s[88:91], s32 offen offset:0 lds
    buffer_load_dwordx4 v7, s[88:91], s32 offen offset:1024 lds
    buffer_load_dwordx4 v8, s[88:91], s32 offen offset:2048 lds
    buffer_load_dwordx4 v9, s[88:91], s32 offen offset:3072 lds
    s_mov_b64 s[24:25], s[76:77]
    s_mov_b32 s84, s74
    s_mov_b32 s85, s75
    s_mov_b32 s86, 0x00000100
    s_mov_b32 s87, 0x00020000
    s_add_u32 s80, s76, 0x01400000
    s_addc_u32 s81, s77, 0
    s_mov_b32 s82, 0x00080000
    s_mov_b32 s83, 0x00020000
    s_add_u32 s16, s24, 0x00d80000
    s_addc_u32 s17, s25, 0
    s_mov_b32 s18, 0x000d4000
    s_mov_b32 s19, 0x00020000
    v_mov_b32 v96, 0x3f803f80
    v_accvgpr_write_b32 a48, v96
    v_accvgpr_write_b32 a49, v96
    s_mul_i32 s33, s32, 1920
    s_add_u32 s33, s33, s35
    s_add_u32 m0, s34, 36864
    s_nop 0
    buffer_load_dwordx4 v10, s[8:11], s33 offen offset:0 lds
    v_accvgpr_write_b32 a50, v96
    v_accvgpr_write_b32 a51, v96
    s_lshl_b32 s57, s21, 9
    s_lshl_b32 s36, s20, 7
    buffer_load_dwordx4 v11, s[8:11], s33 offen offset:1024 lds
    s_add_u32 s57, s57, s36
    s_lshl_b32 s36, s22, 2
    s_add_u32 s57, s57, s36
    s_add_u32 s57, s57, 32
    buffer_load_dwordx4 v12, s[8:11], s33 offen offset:2048 lds
    s_lshl_b32 s58, s22, 11
    s_lshl_b32 s36, s21, 7
    s_add_u32 s58, s58, s36
    buffer_load_dwordx4 v13, s[8:11], s33 offen offset:3072 lds
    s_add_u32 s58, s58, 65536
    v_lshrrev_b32 v24, 1, v2
    v_lshlrev_b32 v24, 4, v24
    v_and_b32 v25, 1, v2
    s_add_u32 m0, s34, 40960
    s_nop 0
    buffer_load_dwordx4 v14, s[8:11], s33 offen offset:0 lds
    v_lshl_add_u32 v24, v25, 2, v24
    v_add_u32 v24, v24, v4
    v_mul_u32_u24 v28, 160, v24
    v_lshl_add_u32 v28, v5, 3, v28
    s_add_u32 m0, s34, 119808
    s_nop 0
    buffer_load_dwordx4 v10, s[8:11], s44 offen offset:0 lds
    v_add_u32 v96, 73728, v28
    v_add_u32 v99, 140288, v28
    s_lshl_b32 s36, s20, 5
    buffer_load_dwordx4 v11, s[8:11], s44 offen offset:1024 lds
    s_add_u32 s36, s36, 119808
    v_add_u32 v17, s36, v28
    v_lshrrev_b32 v24, 1, v3
    v_xor_b32 v24, v24, v2
    buffer_load_dwordx4 v12, s[8:11], s44 offen offset:2048 lds
    v_lshlrev_b32 v24, 4, v24
    v_lshl_add_u32 v24, v3, 7, v24
    v_add_u32 v22, s47, v24
    v_xor_b32 v24, 64, v24
    buffer_load_dwordx4 v13, s[8:11], s44 offen offset:3072 lds
    v_add_u32 v23, s47, v24
    v_add_u32 v15, 73728, v22
    v_add_u32 v16, 73728, v23
    v_lshlrev_b32 v30, 4, v1
    s_add_u32 m0, s34, 123904
    s_nop 0
    buffer_load_dwordx4 v14, s[8:11], s44 offen offset:0 lds
    s_waitcnt vmcnt(14)
    s_barrier
    ds_read_b128 a[96:99], v22 offset:0
    ds_read_b128 a[100:103], v23 offset:0
    ds_read_b128 a[104:107], v22 offset:2048
    ds_read_b128 a[108:111], v23 offset:2048
    ds_read_b64_tr_b16 v[64:65], v28 offset:0
    ds_read_b64_tr_b16 v[66:67], v28 offset:1280
    ds_read_b64_tr_b16 v[68:69], v28 offset:5120
    ds_read_b64_tr_b16 v[70:71], v28 offset:6400
    ds_read_b64_tr_b16 v[72:73], v28 offset:32
    ds_read_b64_tr_b16 v[74:75], v28 offset:1312
    ds_read_b64_tr_b16 v[76:77], v28 offset:5152
    ds_read_b64_tr_b16 v[78:79], v28 offset:6432
    ds_read_b64_tr_b16 v[80:81], v28 offset:64
    ds_read_b64_tr_b16 v[82:83], v28 offset:1344
    ds_read_b64_tr_b16 v[84:85], v28 offset:5184
    ds_read_b64_tr_b16 v[86:87], v28 offset:6464
    s_lshl_b32 s3, s20, 2
    s_add_u32 s3, s3, s99
    s_cmp_ge_u32 s3, 4
    s_cbranch_scc1 ZS_2
    v_mov_b32 v24, 1
    s_mov_b64 exec, 1
    buffer_store_byte v24, off, s[84:87], s99 sc1
    s_mov_b64 exec, -1
ZS_2:
    s_waitcnt lgkmcnt(8)
    s_add_u32 s32, s32, 128
    s_cmpk_eq_u32 s32, 1280
    s_cselect_b32 s32, 0, s32
    s_add_u32 m0, s47, 73728
    v_mfma_f32_16x16x32_bf16 v[104:107], a[96:99], v[64:67], 0
    ds_read_b64_tr_b16 v[88:89], v28 offset:96
    buffer_load_dwordx4 v6, s[88:91], s32 offen offset:0 lds
    v_mfma_f32_16x16x32_bf16 v[164:167], a[104:107], v[64:67], 0
    ds_read_b64_tr_b16 v[90:91], v28 offset:1376
    v_mfma_f32_16x16x32_bf16 v[104:107], a[100:103], v[68:71], v[104:107]
    ds_read_b64_tr_b16 v[92:93], v28 offset:5216
    buffer_load_dwordx4 v7, s[88:91], s32 offen offset:1024 lds
    v_mfma_f32_16x16x32_bf16 v[164:167], a[108:111], v[68:71], v[164:167]
    ds_read_b64_tr_b16 v[94:95], v28 offset:6496
    s_cmp_lg_u32 s20, 0
    s_cbranch_scc1 SK_3
    v_mfma_f32_16x16x32_bf16 a[68:71], v[64:67], a[48:51], 0
    v_mfma_f32_16x16x32_bf16 a[68:71], v[68:71], a[48:51], a[68:71]
SK_3:
    s_waitcnt lgkmcnt(8)
    v_mfma_f32_16x16x32_bf16 v[108:111], a[96:99], v[72:75], 0
    ds_read_b64_tr_b16 v[64:65], v28 offset:128
    buffer_load_dwordx4 v8, s[88:91], s32 offen offset:2048 lds
    v_mfma_f32_16x16x32_bf16 v[168:171], a[104:107], v[72:75], 0
    ds_read_b64_tr_b16 v[66:67], v28 offset:1408
    v_mfma_f32_16x16x32_bf16 v[108:111], a[100:103], v[76:79], v[108:111]
    ds_read_b64_tr_b16 v[68:69], v28 offset:5248
    buffer_load_dwordx4 v9, s[88:91], s32 offen offset:3072 lds
    v_mfma_f32_16x16x32_bf16 v[168:171], a[108:111], v[76:79], v[168:171]
    ds_read_b64_tr_b16 v[70:71], v28 offset:6528
    v_mfma_f32_16x16x32_bf16 a[52:55], a[48:51], a[96:99], 0
    s_cmp_lg_u32 s20, 1
    s_cbranch_scc1 SK_4
    v_mfma_f32_16x16x32_bf16 a[68:71], v[72:75], a[48:51], 0
    v_mfma_f32_16x16x32_bf16 a[68:71], v[76:79], a[48:51], a[68:71]
SK_4:
    s_waitcnt lgkmcnt(8)
    s_mul_i32 s33, s32, 1920
    s_add_u32 s33, s33, s35
    s_add_u32 m0, s34, 73728
    v_mfma_f32_16x16x32_bf16 v[112:115], a[96:99], v[80:83], 0
    ds_read_b64_tr_b16 v[72:73], v28 offset:10240
    buffer_load_dwordx4 v10, s[8:11], s33 offen offset:0 lds
    v_mfma_f32_16x16x32_bf16 v[172:175], a[104:107], v[80:83], 0
    ds_read_b64_tr_b16 v[74:75], v28 offset:11520
    v_mfma_f32_16x16x32_bf16 v[112:115], a[100:103], v[84:87], v[112:115]
    ds_read_b64_tr_b16 v[76:77], v28 offset:15360
    buffer_load_dwordx4 v11, s[8:11], s33 offen offset:1024 lds
    v_mfma_f32_16x16x32_bf16 v[172:175], a[108:111], v[84:87], v[172:175]
    ds_read_b64_tr_b16 v[78:79], v28 offset:16640
    v_mfma_f32_16x16x32_bf16 a[56:59], a[48:51], a[104:107], 0
    s_cmp_lg_u32 s20, 2
    s_cbranch_scc1 SK_5
    v_mfma_f32_16x16x32_bf16 a[68:71], v[80:83], a[48:51], 0
    v_mfma_f32_16x16x32_bf16 a[68:71], v[84:87], a[48:51], a[68:71]
SK_5:
    s_waitcnt lgkmcnt(8)
    v_mfma_f32_16x16x32_bf16 v[116:119], a[96:99], v[88:91], 0
    ds_read_b64_tr_b16 v[80:81], v28 offset:10272
    buffer_load_dwordx4 v12, s[8:11], s33 offen offset:2048 lds
    v_mfma_f32_16x16x32_bf16 v[176:179], a[104:107], v[88:91], 0
    ds_read_b64_tr_b16 v[82:83], v28 offset:11552
    v_mfma_f32_16x16x32_bf16 v[116:119], a[100:103], v[92:95], v[116:119]
    ds_read_b64_tr_b16 v[84:85], v28 offset:15392
    buffer_load_dwordx4 v13, s[8:11], s33 offen offset:3072 lds
    v_mfma_f32_16x16x32_bf16 v[176:179], a[108:111], v[92:95], v[176:179]
    ds_read_b64_tr_b16 v[86:87], v28 offset:16672
    v_mfma_f32_16x16x32_bf16 a[60:63], a[96:99], a[96:99], 0
    s_cmp_lg_u32 s20, 3
    s_cbranch_scc1 SK_6
    v_mfma_f32_16x16x32_bf16 a[68:71], v[88:91], a[48:51], 0
    v_mfma_f32_16x16x32_bf16 a[68:71], v[92:95], a[48:51], a[68:71]
SK_6:
    s_waitcnt lgkmcnt(8)
    s_add_u32 m0, s34, 77824
    v_mfma_f32_16x16x32_bf16 v[120:123], a[96:99], v[64:67], 0
    ds_read_b64_tr_b16 v[88:89], v28 offset:10304
    buffer_load_dwordx4 v14, s[8:11], s33 offen offset:0 lds
    v_mfma_f32_16x16x32_bf16 v[180:183], a[104:107], v[64:67], 0
    ds_read_b64_tr_b16 v[90:91], v28 offset:11584
    v_mfma_f32_16x16x32_bf16 v[120:123], a[100:103], v[68:71], v[120:123]
    ds_read_b64_tr_b16 v[92:93], v28 offset:15424
    v_mfma_f32_16x16x32_bf16 v[180:183], a[108:111], v[68:71], v[180:183]
    ds_read_b64_tr_b16 v[94:95], v28 offset:16704
    v_mfma_f32_16x16x32_bf16 a[64:67], a[104:107], a[104:107], 0
    s_cmp_lg_u32 s20, 0
    s_cbranch_scc1 SK_7
    v_mfma_f32_16x16x32_bf16 a[72:75], v[64:67], a[48:51], 0
    v_mfma_f32_16x16x32_bf16 a[72:75], v[68:71], a[48:51], a[72:75]
SK_7:
    s_waitcnt lgkmcnt(8)
    v_mfma_f32_16x16x32_bf16 v[124:127], a[96:99], v[72:75], 0
    ds_read_b64_tr_b16 v[64:65], v28 offset:10336
    v_mfma_f32_16x16x32_bf16 v[184:187], a[104:107], v[72:75], 0
    ds_read_b64_tr_b16 v[66:67], v28 offset:11616
    v_mfma_f32_16x16x32_bf16 v[124:127], a[100:103], v[76:79], v[124:127]
    ds_read_b64_tr_b16 v[68:69], v28 offset:15456
    v_mfma_f32_16x16x32_bf16 v[184:187], a[108:111], v[76:79], v[184:187]
    ds_read_b64_tr_b16 v[70:71], v28 offset:16736
    v_mfma_f32_16x16x32_bf16 a[52:55], a[48:51], a[100:103], a[52:55]
    s_cmp_lg_u32 s20, 1
    s_cbranch_scc1 SK_8
    v_mfma_f32_16x16x32_bf16 a[72:75], v[72:75], a[48:51], 0
    v_mfma_f32_16x16x32_bf16 a[72:75], v[76:79], a[48:51], a[72:75]
SK_8:
    s_waitcnt lgkmcnt(8)
    v_mfma_f32_16x16x32_bf16 v[128:131], a[96:99], v[80:83], 0
    ds_read_b64_tr_b16 v[72:73], v28 offset:10368
    v_mfma_f32_16x16x32_bf16 v[188:191], a[104:107], v[80:83], 0
    ds_read_b64_tr_b16 v[74:75], v28 offset:11648
    v_mfma_f32_16x16x32_bf16 v[128:131], a[100:103], v[84:87], v[128:131]
    ds_read_b64_tr_b16 v[76:77], v28 offset:15488
    v_mfma_f32_16x16x32_bf16 v[188:191], a[108:111], v[84:87], v[188:191]
    ds_read_b64_tr_b16 v[78:79], v28 offset:16768
    v_mfma_f32_16x16x32_bf16 a[56:59], a[48:51], a[108:111], a[56:59]
    s_cmp_lg_u32 s20, 2
    s_cbranch_scc1 SK_9
    v_mfma_f32_16x16x32_bf16 a[72:75], v[80:83], a[48:51], 0
    v_mfma_f32_16x16x32_bf16 a[72:75], v[84:87], a[48:51], a[72:75]
SK_9:
    s_waitcnt lgkmcnt(8)
    v_mfma_f32_16x16x32_bf16 v[132:135], a[96:99], v[88:91], 0
    v_mfma_f32_16x16x32_bf16 v[192:195], a[104:107], v[88:91], 0
    v_mfma_f32_16x16x32_bf16 v[132:135], a[100:103], v[92:95], v[132:135]
    v_mfma_f32_16x16x32_bf16 v[192:195], a[108:111], v[92:95], v[192:195]
    v_mfma_f32_16x16x32_bf16 a[60:63], a[100:103], a[100:103], a[60:63]
    s_cmp_lg_u32 s20, 3
    s_cbranch_scc1 SK_10
    v_mfma_f32_16x16x32_bf16 a[72:75], v[88:91], a[48:51], 0
    v_mfma_f32_16x16x32_bf16 a[72:75], v[92:95], a[48:51], a[72:75]
SK_10:
    s_waitcnt lgkmcnt(0)
    s_waitcnt vmcnt(9)
    s_barrier
    v_mfma_f32_16x16x32_bf16 v[136:139], a[96:99], v[64:67], 0
    ds_read_b128 a[112:115], v22 offset:36864
    ds_read_b64_tr_b16 v[80:81], v28 offset:36864
    v_mfma_f32_16x16x32_bf16 v[196:199], a[104:107], v[64:67], 0
    ds_read_b128 a[116:119], v23 offset:36864
    ds_read_b64_tr_b16 v[82:83], v28 offset:38144
    v_mfma_f32_16x16x32_bf16 v[136:139], a[100:103], v[68:71], v[136:139]
    ds_read_b128 a[120:123], v22 offset:38912
    ds_read_b64_tr_b16 v[84:85], v28 offset:41984
    v_mfma_f32_16x16x32_bf16 v[196:199], a[108:111], v[68:71], v[196:199]
    ds_read_b128 a[124:127], v23 offset:38912
    ds_read_b64_tr_b16 v[86:87], v28 offset:43264
    v_mfma_f32_16x16x32_bf16 a[64:67], a[108:111], a[108:111], a[64:67]
    s_cmp_lg_u32 s20, 0
    s_cbranch_scc1 SK_11
    v_mfma_f32_16x16x32_bf16 a[76:79], v[64:67], a[48:51], 0
    v_mfma_f32_16x16x32_bf16 a[76:79], v[68:71], a[48:51], a[76:79]
SK_11:
    v_mfma_f32_16x16x32_bf16 v[140:143], a[96:99], v[72:75], 0
    ds_read_b64_tr_b16 v[88:89], v28 offset:36896
    ds_read_b64_tr_b16 v[64:65], v28 offset:36928
    v_mfma_f32_16x16x32_bf16 v[200:203], a[104:107], v[72:75], 0
    ds_read_b64_tr_b16 v[90:91], v28 offset:38176
    ds_read_b64_tr_b16 v[66:67], v28 offset:38208
    v_mfma_f32_16x16x32_bf16 v[140:143], a[100:103], v[76:79], v[140:143]
    ds_read_b64_tr_b16 v[92:93], v28 offset:42016
    ds_read_b64_tr_b16 v[68:69], v28 offset:42048
    v_mfma_f32_16x16x32_bf16 v[200:203], a[108:111], v[76:79], v[200:203]
    ds_read_b64_tr_b16 v[94:95], v28 offset:43296
    ds_read_b64_tr_b16 v[70:71], v28 offset:43328
    s_cmp_lg_u32 s20, 1
    s_cbranch_scc1 SK_12
    v_mfma_f32_16x16x32_bf16 a[76:79], v[72:75], a[48:51], 0
    v_mfma_f32_16x16x32_bf16 a[76:79], v[76:79], a[48:51], a[76:79]
SK_12:
    s_waitcnt lgkmcnt(8)
    s_add_u32 s32, s32, 128
    s_cmpk_eq_u32 s32, 1280
    s_cselect_b32 s32, 0, s32
    s_add_u32 m0, s47, 0
    v_mfma_f32_16x16x32_bf16 v[104:107], a[112:115], v[80:83], v[104:107]
    ds_read_b64_tr_b16 v[72:73], v28 offset:36960
    buffer_load_dwordx4 v6, s[88:91], s32 offen offset:0 lds
    v_mfma_f32_16x16x32_bf16 v[164:167], a[120:123], v[80:83], v[164:167]
    ds_read_b64_tr_b16 v[74:75], v28 offset:38240
    v_mfma_f32_16x16x32_bf16 v[104:107], a[116:119], v[84:87], v[104:107]
    ds_read_b64_tr_b16 v[76:77], v28 offset:42080
    buffer_load_dwordx4 v7, s[88:91], s32 offen offset:1024 lds
    v_mfma_f32_16x16x32_bf16 v[164:167], a[124:127], v[84:87], v[164:167]
    ds_read_b64_tr_b16 v[78:79], v28 offset:43360
    s_waitcnt lgkmcnt(5)
    v_mfma_f32_16x16x32_bf16 v[108:111], a[112:115], v[88:91], v[108:111]
    ds_read_b64_tr_b16 v[80:81], v28 offset:36992
    buffer_load_dwordx4 v8, s[88:91], s32 offen offset:2048 lds
    v_mfma_f32_16x16x32_bf16 v[168:171], a[120:123], v[88:91], v[168:171]
    ds_read_b64_tr_b16 v[82:83], v28 offset:38272
    v_mfma_f32_16x16x32_bf16 v[108:111], a[116:119], v[92:95], v[108:111]
    ds_read_b64_tr_b16 v[84:85], v28 offset:42112
    buffer_load_dwordx4 v9, s[88:91], s32 offen offset:3072 lds
    v_mfma_f32_16x16x32_bf16 v[168:171], a[124:127], v[92:95], v[168:171]
    ds_read_b64_tr_b16 v[86:87], v28 offset:43392
    ds_read_b64_tr_b16 v[32:33], v17 offset:0
    ds_read_b64_tr_b16 v[34:35], v17 offset:1280
    ds_read_b64_tr_b16 v[36:37], v17 offset:5120
    ds_read_b64_tr_b16 v[38:39], v17 offset:6400
    s_waitcnt lgkmcnt(12)
    s_mul_i32 s33, s32, 1920
    s_add_u32 s33, s33, s35
    s_add_u32 m0, s34, 0
    v_mfma_f32_16x16x32_bf16 v[112:115], a[112:115], v[64:67], v[112:115]
    ds_read_b64_tr_b16 v[88:89], v28 offset:47104
    buffer_load_dwordx4 v10, s[8:11], s33 offen offset:0 lds
    v_mfma_f32_16x16x32_bf16 v[172:175], a[120:123], v[64:67], v[172:175]
    ds_read_b64_tr_b16 v[90:91], v28 offset:48384
    v_mfma_f32_16x16x32_bf16 v[112:115], a[116:119], v[68:71], v[112:115]
    ds_read_b64_tr_b16 v[92:93], v28 offset:52224
    buffer_load_dwordx4 v11, s[8:11], s33 offen offset:1024 lds
    v_mfma_f32_16x16x32_bf16 v[172:175], a[124:127], v[68:71], v[172:175]
    ds_read_b64_tr_b16 v[94:95], v28 offset:53504
    ds_read_b64_tr_b16 v[40:41], v17 offset:128
    ds_read_b64_tr_b16 v[42:43], v17 offset:1408
    ds_read_b64_tr_b16 v[44:45], v17 offset:5248
    ds_read_b64_tr_b16 v[46:47], v17 offset:6528
    s_waitcnt lgkmcnt(15)
    v_mfma_f32_16x16x32_bf16 v[116:119], a[112:115], v[72:75], v[116:119]
    ds_read_b64_tr_b16 v[64:65], v28 offset:47136
    buffer_load_dwordx4 v12, s[8:11], s33 offen offset:2048 lds
    v_mfma_f32_16x16x32_bf16 v[176:179], a[120:123], v[72:75], v[176:179]
    ds_read_b64_tr_b16 v[66:67], v28 offset:48416
    v_mfma_f32_16x16x32_bf16 v[116:119], a[116:119], v[76:79], v[116:119]
    ds_read_b64_tr_b16 v[68:69], v28 offset:52256
    buffer_load_dwordx4 v13, s[8:11], s33 offen offset:3072 lds
    v_mfma_f32_16x16x32_bf16 v[176:179], a[124:127], v[76:79], v[176:179]
    ds_read_b64_tr_b16 v[70:71], v28 offset:53536
    s_waitcnt lgkmcnt(12)
    s_add_u32 m0, s34, 4096
    v_mfma_f32_16x16x32_bf16 v[120:123], a[112:115], v[80:83], v[120:123]
    ds_read_b64_tr_b16 v[72:73], v28 offset:47168
    buffer_load_dwordx4 v14, s[8:11], s33 offen offset:0 lds
    v_mfma_f32_16x16x32_bf16 v[180:183], a[120:123], v[80:83], v[180:183]
    ds_read_b64_tr_b16 v[74:75], v28 offset:48448
    v_mfma_f32_16x16x32_bf16 v[120:123], a[116:119], v[84:87], v[120:123]
    ds_read_b64_tr_b16 v[76:77], v28 offset:52288
    v_mfma_f32_16x16x32_bf16 v[180:183], a[124:127], v[84:87], v[180:183]
    ds_read_b64_tr_b16 v[78:79], v28 offset:53568
    v_mfma_f32_16x16x32_bf16 a[80:83], v[32:35], a[48:51], 0
    v_mfma_f32_16x16x32_bf16 a[80:83], v[36:39], a[48:51], a[80:83]
    s_waitcnt lgkmcnt(8)
    v_mfma_f32_16x16x32_bf16 v[124:127], a[112:115], v[88:91], v[124:127]
    ds_read_b64_tr_b16 v[80:81], v28 offset:47200
    v_mfma_f32_16x16x32_bf16 v[184:187], a[120:123], v[88:91], v[184:187]
    ds_read_b64_tr_b16 v[82:83], v28 offset:48480
    v_mfma_f32_16x16x32_bf16 v[124:127], a[116:119], v[92:95], v[124:127]
    ds_read_b64_tr_b16 v[84:85], v28 offset:52320
    v_mfma_f32_16x16x32_bf16 v[184:187], a[124:127], v[92:95], v[184:187]
    ds_read_b64_tr_b16 v[86:87], v28 offset:53600
    v_mfma_f32_16x16x32_bf16 a[84:87], v[40:43], a[48:51], 0
    v_mfma_f32_16x16x32_bf16 a[84:87], v[44:47], a[48:51], a[84:87]
    s_waitcnt lgkmcnt(8)
    v_mfma_f32_16x16x32_bf16 v[128:131], a[112:115], v[64:67], v[128:131]
    ds_read_b64_tr_b16 v[88:89], v28 offset:47232
    v_mfma_f32_16x16x32_bf16 v[188:191], a[120:123], v[64:67], v[188:191]
    ds_read_b64_tr_b16 v[90:91], v28 offset:48512
    v_mfma_f32_16x16x32_bf16 v[128:131], a[116:119], v[68:71], v[128:131]
    ds_read_b64_tr_b16 v[92:93], v28 offset:52352
    v_mfma_f32_16x16x32_bf16 v[188:191], a[124:127], v[68:71], v[188:191]
    ds_read_b64_tr_b16 v[94:95], v28 offset:53632
    s_waitcnt lgkmcnt(8)
    v_mfma_f32_16x16x32_bf16 v[132:135], a[112:115], v[72:75], v[132:135]
    v_mfma_f32_16x16x32_bf16 v[192:195], a[120:123], v[72:75], v[192:195]
    v_mfma_f32_16x16x32_bf16 v[132:135], a[116:119], v[76:79], v[132:135]
    v_mfma_f32_16x16x32_bf16 v[192:195], a[124:127], v[76:79], v[192:195]
    s_waitcnt lgkmcnt(0)
    s_waitcnt vmcnt(9)
    s_barrier
    v_mfma_f32_16x16x32_bf16 v[136:139], a[112:115], v[80:83], v[136:139]
    ds_read_b128 a[128:131], v15 offset:0
    ds_read_b64_tr_b16 v[64:65], v96 offset:0
    v_mfma_f32_16x16x32_bf16 v[196:199], a[120:123], v[80:83], v[196:199]
    ds_read_b128 a[132:135], v16 offset:0
    ds_read_b64_tr_b16 v[66:67], v96 offset:1280
    v_mfma_f32_16x16x32_bf16 v[136:139], a[116:119], v[84:87], v[136:139]
    ds_read_b128 a[136:139], v15 offset:2048
    ds_read_b64_tr_b16 v[68:69], v96 offset:5120
    v_mfma_f32_16x16x32_bf16 v[196:199], a[124:127], v[84:87], v[196:199]
    ds_read_b128 a[140:143], v16 offset:2048
    ds_read_b64_tr_b16 v[70:71], v96 offset:6400
    v_mfma_f32_16x16x32_bf16 v[140:143], a[112:115], v[88:91], v[140:143]
    ds_read_b64_tr_b16 v[72:73], v96 offset:32
    ds_read_b64_tr_b16 v[80:81], v96 offset:64
    v_mfma_f32_16x16x32_bf16 v[200:203], a[120:123], v[88:91], v[200:203]
    ds_read_b64_tr_b16 v[74:75], v96 offset:1312
    ds_read_b64_tr_b16 v[82:83], v96 offset:1344
    v_mfma_f32_16x16x32_bf16 v[140:143], a[116:119], v[92:95], v[140:143]
    ds_read_b64_tr_b16 v[76:77], v96 offset:5152
    ds_read_b64_tr_b16 v[84:85], v96 offset:5184
    v_mfma_f32_16x16x32_bf16 v[200:203], a[124:127], v[92:95], v[200:203]
    ds_read_b64_tr_b16 v[78:79], v96 offset:6432
    ds_read_b64_tr_b16 v[86:87], v96 offset:6464
    s_lshl_b32 s36, s20, 6
    v_lshl_add_u32 v102, v2, 4, s36
    s_lshl_b32 s36, s20, 8
    v_lshl_add_u32 v103, v3, 3, s36
    v_accvgpr_read_b32 v244, a52
    v_accvgpr_read_b32 v245, a60
    v_accvgpr_read_b32 v248, a61
    v_accvgpr_read_b32 v249, a62
    v_accvgpr_read_b32 v250, a63
    v_accvgpr_read_b32 v246, a56
    v_accvgpr_read_b32 v247, a64
    v_accvgpr_read_b32 v251, a65
    v_accvgpr_read_b32 v252, a66
    v_accvgpr_read_b32 v253, a67
    v_cmp_eq_u32 vcc, 1, v5
    s_nop 1
    v_cndmask_b32 v245, v245, v248, vcc
    v_cndmask_b32 v247, v247, v251, vcc
    v_cmp_eq_u32 vcc, 2, v5
    s_nop 1
    v_cndmask_b32 v245, v245, v249, vcc
    v_cndmask_b32 v247, v247, v252, vcc
    v_cmp_eq_u32 vcc, 3, v5
    s_nop 1
    v_cndmask_b32 v245, v245, v250, vcc
    v_cndmask_b32 v247, v247, v253, vcc
    s_mov_b32 exec_lo, 0x00010001
    s_mov_b32 exec_hi, 0x00010001
    buffer_store_dwordx4 a[68:71], v102, s[80:83], s45 offen offset:0 sc1
    buffer_store_dwordx4 a[72:75], v102, s[80:83], s45 offen offset:256 sc1
    buffer_store_dwordx4 a[76:79], v102, s[80:83], s45 offen offset:512 sc1
    buffer_store_dwordx4 a[80:83], v102, s[80:83], s45 offen offset:768 sc1
    buffer_store_dwordx4 a[84:87], v102, s[80:83], s45 offen offset:1024 sc1
    s_mov_b32 exec_lo, 0x00f0000f
    s_mov_b32 exec_hi, 0xf0000f00
    buffer_store_dwordx2 v[244:245], v103, s[80:83], s46 offen offset:0
    buffer_store_dwordx2 v[246:247], v103, s[80:83], s46 offen offset:128
    s_mov_b64 exec, -1
    s_lshl_b32 s36, s22, 13
    s_lshl_b32 s37, s21, 9
    s_add_u32 s36, s36, s37
    v_and_b32 v24, 127, v0
    v_lshlrev_b32 v24, 2, v24
    v_mov_b32 v25, 0
    buffer_store_dword v25, v24, s[16:19], s36 offen sc1
    s_waitcnt lgkmcnt(8)
    s_add_u32 s32, s32, 128
    s_cmpk_eq_u32 s32, 1280
    s_cselect_b32 s32, 0, s32
    s_add_u32 m0, s47, 36864
    v_mfma_f32_16x16x32_bf16 v[104:107], a[128:131], v[64:67], v[104:107]
    ds_read_b64_tr_b16 v[88:89], v96 offset:96
    buffer_load_dwordx4 v6, s[88:91], s32 offen offset:0 lds
    v_mfma_f32_16x16x32_bf16 v[164:167], a[136:139], v[64:67], v[164:167]
    ds_read_b64_tr_b16 v[90:91], v96 offset:1376
    v_mfma_f32_16x16x32_bf16 v[104:107], a[132:135], v[68:71], v[104:107]
    ds_read_b64_tr_b16 v[92:93], v96 offset:5216
    buffer_load_dwordx4 v7, s[88:91], s32 offen offset:1024 lds
    v_mfma_f32_16x16x32_bf16 v[164:167], a[140:143], v[68:71], v[164:167]
    ds_read_b64_tr_b16 v[94:95], v96 offset:6496
    s_waitcnt lgkmcnt(5)
    v_mfma_f32_16x16x32_bf16 v[108:111], a[128:131], v[72:75], v[108:111]
    ds_read_b64_tr_b16 v[64:65], v96 offset:128
    buffer_load_dwordx4 v8, s[88:91], s32 offen offset:2048 lds
    v_mfma_f32_16x16x32_bf16 v[168:171], a[136:139], v[72:75], v[168:171]
    ds_read_b64_tr_b16 v[66:67], v96 offset:1408
    v_mfma_f32_16x16x32_bf16 v[108:111], a[132:135], v[76:79], v[108:111]
    ds_read_b64_tr_b16 v[68:69], v96 offset:5248
    buffer_load_dwordx4 v9, s[88:91], s32 offen offset:3072 lds
    v_mfma_f32_16x16x32_bf16 v[168:171], a[140:143], v[76:79], v[168:171]
    ds_read_b64_tr_b16 v[70:71], v96 offset:6528
    s_waitcnt lgkmcnt(8)
    s_mul_i32 s33, s32, 1920
    s_add_u32 s33, s33, s35
    s_add_u32 m0, s34, 36864
    v_mfma_f32_16x16x32_bf16 v[112:115], a[128:131], v[80:83], v[112:115]
    ds_read_b64_tr_b16 v[72:73], v96 offset:10240
    buffer_load_dwordx4 v10, s[8:11], s33 offen offset:0 lds
    v_mfma_f32_16x16x32_bf16 v[172:175], a[136:139], v[80:83], v[172:175]
    ds_read_b64_tr_b16 v[74:75], v96 offset:11520
    v_mfma_f32_16x16x32_bf16 v[112:115], a[132:135], v[84:87], v[112:115]
    ds_read_b64_tr_b16 v[76:77], v96 offset:15360
    buffer_load_dwordx4 v11, s[8:11], s33 offen offset:1024 lds
    v_mfma_f32_16x16x32_bf16 v[172:175], a[140:143], v[84:87], v[172:175]
    ds_read_b64_tr_b16 v[78:79], v96 offset:16640
    s_waitcnt lgkmcnt(8)
    v_mfma_f32_16x16x32_bf16 v[116:119], a[128:131], v[88:91], v[116:119]
    ds_read_b64_tr_b16 v[80:81], v96 offset:10272
    buffer_load_dwordx4 v12, s[8:11], s33 offen offset:2048 lds
    v_mfma_f32_16x16x32_bf16 v[176:179], a[136:139], v[88:91], v[176:179]
    ds_read_b64_tr_b16 v[82:83], v96 offset:11552
    v_mfma_f32_16x16x32_bf16 v[116:119], a[132:135], v[92:95], v[116:119]
    ds_read_b64_tr_b16 v[84:85], v96 offset:15392
    buffer_load_dwordx4 v13, s[8:11], s33 offen offset:3072 lds
    v_mfma_f32_16x16x32_bf16 v[176:179], a[140:143], v[92:95], v[176:179]
    ds_read_b64_tr_b16 v[86:87], v96 offset:16672
    s_waitcnt lgkmcnt(8)
    s_add_u32 m0, s34, 40960
    v_mfma_f32_16x16x32_bf16 v[120:123], a[128:131], v[64:67], v[120:123]
    ds_read_b64_tr_b16 v[88:89], v96 offset:10304
    buffer_load_dwordx4 v14, s[8:11], s33 offen offset:0 lds
    v_mfma_f32_16x16x32_bf16 v[180:183], a[136:139], v[64:67], v[180:183]
    ds_read_b64_tr_b16 v[90:91], v96 offset:11584
    v_mfma_f32_16x16x32_bf16 v[120:123], a[132:135], v[68:71], v[120:123]
    ds_read_b64_tr_b16 v[92:93], v96 offset:15424
    v_mfma_f32_16x16x32_bf16 v[180:183], a[140:143], v[68:71], v[180:183]
    ds_read_b64_tr_b16 v[94:95], v96 offset:16704
    s_waitcnt lgkmcnt(8)
    v_mfma_f32_16x16x32_bf16 v[124:127], a[128:131], v[72:75], v[124:127]
    ds_read_b64_tr_b16 v[64:65], v96 offset:10336
    v_mfma_f32_16x16x32_bf16 v[184:187], a[136:139], v[72:75], v[184:187]
    ds_read_b64_tr_b16 v[66:67], v96 offset:11616
    v_mfma_f32_16x16x32_bf16 v[124:127], a[132:135], v[76:79], v[124:127]
    ds_read_b64_tr_b16 v[68:69], v96 offset:15456
    v_mfma_f32_16x16x32_bf16 v[184:187], a[140:143], v[76:79], v[184:187]
    ds_read_b64_tr_b16 v[70:71], v96 offset:16736
    s_waitcnt lgkmcnt(8)
    v_mfma_f32_16x16x32_bf16 v[128:131], a[128:131], v[80:83], v[128:131]
    ds_read_b64_tr_b16 v[72:73], v96 offset:10368
    v_mfma_f32_16x16x32_bf16 v[188:191], a[136:139], v[80:83], v[188:191]
    ds_read_b64_tr_b16 v[74:75], v96 offset:11648
    v_mfma_f32_16x16x32_bf16 v[128:131], a[132:135], v[84:87], v[128:131]
    ds_read_b64_tr_b16 v[76:77], v96 offset:15488
    v_mfma_f32_16x16x32_bf16 v[188:191], a[140:143], v[84:87], v[188:191]
    ds_read_b64_tr_b16 v[78:79], v96 offset:16768
    s_waitcnt lgkmcnt(8)
    v_mfma_f32_16x16x32_bf16 v[132:135], a[128:131], v[88:91], v[132:135]
    v_mfma_f32_16x16x32_bf16 v[192:195], a[136:139], v[88:91], v[192:195]
    v_mfma_f32_16x16x32_bf16 v[132:135], a[132:135], v[92:95], v[132:135]
    v_mfma_f32_16x16x32_bf16 v[192:195], a[140:143], v[92:95], v[192:195]
    s_waitcnt lgkmcnt(0)
    s_waitcnt vmcnt(17)
    s_barrier
    v_mfma_f32_16x16x32_bf16 v[136:139], a[128:131], v[64:67], v[136:139]
    ds_read_b128 a[144:147], v22 offset:0
    ds_read_b64_tr_b16 v[80:81], v28 offset:0
    v_mfma_f32_16x16x32_bf16 v[196:199], a[136:139], v[64:67], v[196:199]
    ds_read_b128 a[148:151], v23 offset:0
    ds_read_b64_tr_b16 v[82:83], v28 offset:1280
    v_mfma_f32_16x16x32_bf16 v[136:139], a[132:135], v[68:71], v[136:139]
    ds_read_b128 a[152:155], v22 offset:2048
    ds_read_b64_tr_b16 v[84:85], v28 offset:5120
    v_mfma_f32_16x16x32_bf16 v[196:199], a[140:143], v[68:71], v[196:199]
    ds_read_b128 a[156:159], v23 offset:2048
    ds_read_b64_tr_b16 v[86:87], v28 offset:6400
    v_mfma_f32_16x16x32_bf16 v[140:143], a[128:131], v[72:75], v[140:143]
    ds_read_b64_tr_b16 v[88:89], v28 offset:32
    ds_read_b64_tr_b16 v[64:65], v28 offset:64
    v_mfma_f32_16x16x32_bf16 v[200:203], a[136:139], v[72:75], v[200:203]
    ds_read_b64_tr_b16 v[90:91], v28 offset:1312
    ds_read_b64_tr_b16 v[66:67], v28 offset:1344
    v_mfma_f32_16x16x32_bf16 v[140:143], a[132:135], v[76:79], v[140:143]
    ds_read_b64_tr_b16 v[92:93], v28 offset:5152
    ds_read_b64_tr_b16 v[68:69], v28 offset:5184
    v_mfma_f32_16x16x32_bf16 v[200:203], a[140:143], v[76:79], v[200:203]
    ds_read_b64_tr_b16 v[94:95], v28 offset:6432
    ds_read_b64_tr_b16 v[70:71], v28 offset:6464
    s_cmp_lg_u32 s20, 0
    s_cbranch_scc1 W0_13
    buffer_load_dword v20, off, s[84:87], 0 sc1
W0_13:
    s_waitcnt lgkmcnt(8)
    s_add_u32 s32, s32, 128
    s_cmpk_eq_u32 s32, 1280
    s_cselect_b32 s32, 0, s32
    s_add_u32 m0, s47, 73728
    v_mfma_f32_16x16x32_bf16 v[104:107], a[144:147], v[80:83], v[104:107]
    ds_read_b64_tr_b16 v[72:73], v28 offset:96
    buffer_load_dwordx4 v6, s[88:91], s32 offen offset:0 lds
    v_mov_b32 v24, v0
    v_mul_u32_u24 v25, 49933, v24
    v_mfma_f32_16x16x32_bf16 v[164:167], a[152:155], v[80:83], v[164:167]
    ds_read_b64_tr_b16 v[74:75], v28 offset:1376
    v_lshrrev_b32 v25, 20, v25
    v_mul_u32_u24 v26, 21, v25
    v_mfma_f32_16x16x32_bf16 v[104:107], a[148:151], v[84:87], v[104:107]
    ds_read_b64_tr_b16 v[76:77], v28 offset:5216
    buffer_load_dwordx4 v7, s[88:91], s32 offen offset:1024 lds
    v_sub_u32 v26, v24, v26
    v_mul_u32_u24 v27, 9987, v24
    v_mfma_f32_16x16x32_bf16 v[164:167], a[156:159], v[84:87], v[164:167]
    ds_read_b64_tr_b16 v[78:79], v28 offset:6496
    v_lshrrev_b32 v27, 20, v27
    v_mul_u32_u24 v24, 105, v27
    s_waitcnt lgkmcnt(5)
    v_mfma_f32_16x16x32_bf16 v[108:111], a[144:147], v[88:91], v[108:111]
    ds_read_b64_tr_b16 v[80:81], v28 offset:128
    buffer_load_dwordx4 v8, s[88:91], s32 offen offset:2048 lds
    v_sub_u32 v24, v24, v24
    v_mul_u32_u24 v27, 20, v27
    v_mfma_f32_16x16x32_bf16 v[168:171], a[152:155], v[88:91], v[168:171]
    ds_read_b64_tr_b16 v[82:83], v28 offset:1408
    v_add_u32 v27, v27, v26
    v_lshrrev_b32 v24, 2, v25
    v_mfma_f32_16x16x32_bf16 v[108:111], a[148:151], v[92:95], v[108:111]
    ds_read_b64_tr_b16 v[84:85], v28 offset:5248
    buffer_load_dwordx4 v9, s[88:91], s32 offen offset:3072 lds
    v_lshrrev_b32 v97, 4, v27
    v_lshl_add_u32 v97, v24, 1, v97
    v_mfma_f32_16x16x32_bf16 v[168:171], a[156:159], v[92:95], v[168:171]
    ds_read_b64_tr_b16 v[86:87], v28 offset:6528
    v_lshlrev_b32 v97, 10, v97
    v_and_b32 v24, 3, v25
    s_waitcnt lgkmcnt(8)
    s_mul_i32 s33, s32, 1920
    s_add_u32 s33, s33, s35
    s_add_u32 m0, s34, 73728
    v_mfma_f32_16x16x32_bf16 v[112:115], a[144:147], v[64:67], v[112:115]
    ds_read_b64_tr_b16 v[88:89], v28 offset:10240
    buffer_load_dwordx4 v10, s[8:11], s33 offen offset:0 lds
    v_lshl_add_u32 v97, v24, 8, v97
    v_and_b32 v27, 15, v27
    v_mfma_f32_16x16x32_bf16 v[172:175], a[152:155], v[64:67], v[172:175]
    ds_read_b64_tr_b16 v[90:91], v28 offset:11520
    v_lshl_add_u32 v97, v27, 4, v97
    v_lshlrev_b32 v25, 4, v25
    v_mfma_f32_16x16x32_bf16 v[112:115], a[148:151], v[68:71], v[112:115]
    ds_read_b64_tr_b16 v[92:93], v28 offset:15360
    buffer_load_dwordx4 v11, s[8:11], s33 offen offset:1024 lds
    v_add_u32 v25, 13312, v25
    v_cmp_eq_u32 vcc, 20, v26
    v_mfma_f32_16x16x32_bf16 v[172:175], a[156:159], v[68:71], v[172:175]
    ds_read_b64_tr_b16 v[94:95], v28 offset:16640
    v_cndmask_b32 v97, v97, v25, vcc
    v_add_u32 v24, 256, v0
    s_waitcnt lgkmcnt(8)
    v_mfma_f32_16x16x32_bf16 v[116:119], a[144:147], v[72:75], v[116:119]
    ds_read_b64_tr_b16 v[64:65], v28 offset:10272
    buffer_load_dwordx4 v12, s[8:11], s33 offen offset:2048 lds
    v_min_u32 v24, 419, v24
    v_mul_u32_u24 v25, 49933, v24
    v_mfma_f32_16x16x32_bf16 v[176:179], a[152:155], v[72:75], v[176:179]
    ds_read_b64_tr_b16 v[66:67], v28 offset:11552
    v_lshrrev_b32 v25, 20, v25
    v_mul_u32_u24 v26, 21, v25
    v_mfma_f32_16x16x32_bf16 v[116:119], a[148:151], v[76:79], v[116:119]
    ds_read_b64_tr_b16 v[68:69], v28 offset:15392
    buffer_load_dwordx4 v13, s[8:11], s33 offen offset:3072 lds
    v_sub_u32 v26, v24, v26
    v_mul_u32_u24 v27, 9987, v24
    v_mfma_f32_16x16x32_bf16 v[176:179], a[156:159], v[76:79], v[176:179]
    ds_read_b64_tr_b16 v[70:71], v28 offset:16672
    v_lshrrev_b32 v27, 20, v27
    v_mul_u32_u24 v24, 105, v27
    s_waitcnt lgkmcnt(8)
    s_add_u32 m0, s34, 77824
    v_mfma_f32_16x16x32_bf16 v[120:123], a[144:147], v[80:83], v[120:123]
    ds_read_b64_tr_b16 v[72:73], v28 offset:10304
    buffer_load_dwordx4 v14, s[8:11], s33 offen offset:0 lds
    v_sub_u32 v24, v24, v24
    v_mul_u32_u24 v27, 20, v27
    v_mfma_f32_16x16x32_bf16 v[180:183], a[152:155], v[80:83], v[180:183]
    ds_read_b64_tr_b16 v[74:75], v28 offset:11584
    v_add_u32 v27, v27, v26
    v_lshrrev_b32 v24, 2, v25
    v_mfma_f32_16x16x32_bf16 v[120:123], a[148:151], v[84:87], v[120:123]
    ds_read_b64_tr_b16 v[76:77], v28 offset:15424
    v_lshrrev_b32 v98, 4, v27
    v_lshl_add_u32 v98, v24, 1, v98
    v_mfma_f32_16x16x32_bf16 v[180:183], a[156:159], v[84:87], v[180:183]
    ds_read_b64_tr_b16 v[78:79], v28 offset:16704
    v_lshlrev_b32 v98, 10, v98
    v_and_b32 v24, 3, v25
    s_waitcnt lgkmcnt(8)
    v_mfma_f32_16x16x32_bf16 v[124:127], a[144:147], v[88:91], v[124:127]
    ds_read_b64_tr_b16 v[80:81], v28 offset:10336
    v_lshl_add_u32 v98, v24, 8, v98
    v_and_b32 v27, 15, v27
    v_mfma_f32_16x16x32_bf16 v[184:187], a[152:155], v[88:91], v[184:187]
    ds_read_b64_tr_b16 v[82:83], v28 offset:11616
    v_lshl_add_u32 v98, v27, 4, v98
    v_lshlrev_b32 v25, 4, v25
    v_mfma_f32_16x16x32_bf16 v[124:127], a[148:151], v[92:95], v[124:127]
    ds_read_b64_tr_b16 v[84:85], v28 offset:15456
    v_add_u32 v25, 13312, v25
    v_cmp_eq_u32 vcc, 20, v26
    v_mfma_f32_16x16x32_bf16 v[184:187], a[156:159], v[92:95], v[184:187]
    ds_read_b64_tr_b16 v[86:87], v28 offset:16736
    v_cndmask_b32 v98, v98, v25, vcc
    s_waitcnt lgkmcnt(8)
    v_mfma_f32_16x16x32_bf16 v[128:131], a[144:147], v[64:67], v[128:131]
    ds_read_b64_tr_b16 v[88:89], v28 offset:10368
    v_mfma_f32_16x16x32_bf16 v[188:191], a[152:155], v[64:67], v[188:191]
    ds_read_b64_tr_b16 v[90:91], v28 offset:11648
    v_mfma_f32_16x16x32_bf16 v[128:131], a[148:151], v[68:71], v[128:131]
    ds_read_b64_tr_b16 v[92:93], v28 offset:15488
    v_mfma_f32_16x16x32_bf16 v[188:191], a[156:159], v[68:71], v[188:191]
    ds_read_b64_tr_b16 v[94:95], v28 offset:16768
    s_waitcnt lgkmcnt(8)
    v_mfma_f32_16x16x32_bf16 v[132:135], a[144:147], v[72:75], v[132:135]
    v_mfma_f32_16x16x32_bf16 v[192:195], a[152:155], v[72:75], v[192:195]
    v_mfma_f32_16x16x32_bf16 v[132:135], a[148:151], v[76:79], v[132:135]
    v_mfma_f32_16x16x32_bf16 v[192:195], a[156:159], v[76:79], v[192:195]
    s_waitcnt lgkmcnt(0)
    s_waitcnt vmcnt(9)
    s_cmp_lg_u32 s20, 0
    s_cbranch_scc1 W0_14
    s_mov_b32 s98, 0
PL_15:
    v_cmp_ne_u32 vcc, 0x01010101, v20
    s_cbranch_vccz PD_16
    s_add_u32 s98, s98, 1
    s_cmp_ge_u32 s98, 0x40000
    s_cbranch_scc1 PD_16
    s_sleep 0
    buffer_load_dword v20, off, s[84:87], 0 sc1
    s_waitcnt vmcnt(0)
    s_branch PL_15
PD_16:
W0_14:
    s_barrier
    s_cmp_lg_u32 s20, 0
    s_cbranch_scc1 W0_17
    s_lshl_b32 s36, s22, 4
    s_add_u32 s36, s36, s21
    s_lshl_b32 s36, s36, 7
    s_add_u32 s36, s36, 98304
    v_mov_b32 v24, 1
    s_mov_b64 exec, 1
    buffer_store_dword v24, off, s[80:83], s36 sc1
    s_mov_b64 exec, -1
W0_17:
    v_mfma_f32_16x16x32_bf16 v[136:139], a[144:147], v[80:83], v[136:139]
    ds_read_b128 a[160:163], v22 offset:36864
    ds_read_b64_tr_b16 v[64:65], v28 offset:36864
    v_mfma_f32_16x16x32_bf16 v[196:199], a[152:155], v[80:83], v[196:199]
    ds_read_b128 a[164:167], v23 offset:36864
    ds_read_b64_tr_b16 v[66:67], v28 offset:38144
    v_mfma_f32_16x16x32_bf16 v[136:139], a[148:151], v[84:87], v[136:139]
    ds_read_b128 a[168:171], v22 offset:38912
    ds_read_b64_tr_b16 v[68:69], v28 offset:41984
    v_mfma_f32_16x16x32_bf16 v[196:199], a[156:159], v[84:87], v[196:199]
    ds_read_b128 a[172:175], v23 offset:38912
    ds_read_b64_tr_b16 v[70:71], v28 offset:43264
    v_mfma_f32_16x16x32_bf16 v[140:143], a[144:147], v[88:91], v[140:143]
    ds_read_b64_tr_b16 v[72:73], v28 offset:36896
    ds_read_b64_tr_b16 v[80:81], v28 offset:36928
    v_mfma_f32_16x16x32_bf16 v[200:203], a[152:155], v[88:91], v[200:203]
    ds_read_b64_tr_b16 v[74:75], v28 offset:38176
    ds_read_b64_tr_b16 v[82:83], v28 offset:38208
    v_mfma_f32_16x16x32_bf16 v[140:143], a[148:151], v[92:95], v[140:143]
    ds_read_b64_tr_b16 v[76:77], v28 offset:42016
    ds_read_b64_tr_b16 v[84:85], v28 offset:42048
    v_mfma_f32_16x16x32_bf16 v[200:203], a[156:159], v[92:95], v[200:203]
    ds_read_b64_tr_b16 v[78:79], v28 offset:43296
    ds_read_b64_tr_b16 v[86:87], v28 offset:43328
    s_waitcnt lgkmcnt(8)
    s_add_u32 s32, s32, 128
    s_cmpk_eq_u32 s32, 1280
    s_cselect_b32 s32, 0, s32
    s_add_u32 m0, s47, 0
    v_mfma_f32_16x16x32_bf16 v[104:107], a[160:163], v[64:67], v[104:107]
    ds_read_b64_tr_b16 v[88:89], v28 offset:36960
    buffer_load_dwordx4 v6, s[88:91], s32 offen offset:0 lds
    v_mfma_f32_16x16x32_bf16 v[164:167], a[168:171], v[64:67], v[164:167]
    ds_read_b64_tr_b16 v[90:91], v28 offset:38240
    v_mfma_f32_16x16x32_bf16 v[104:107], a[164:167], v[68:71], v[104:107]
    ds_read_b64_tr_b16 v[92:93], v28 offset:42080
    buffer_load_dwordx4 v7, s[88:91], s32 offen offset:1024 lds
    v_mfma_f32_16x16x32_bf16 v[164:167], a[172:175], v[68:71], v[164:167]
    ds_read_b64_tr_b16 v[94:95], v28 offset:43360
    s_waitcnt lgkmcnt(5)
    v_mfma_f32_16x16x32_bf16 v[108:111], a[160:163], v[72:75], v[108:111]
    ds_read_b64_tr_b16 v[64:65], v28 offset:36992
    buffer_load_dwordx4 v8, s[88:91], s32 offen offset:2048 lds
    v_mfma_f32_16x16x32_bf16 v[168:171], a[168:171], v[72:75], v[168:171]
    ds_read_b64_tr_b16 v[66:67], v28 offset:38272
    v_mfma_f32_16x16x32_bf16 v[108:111], a[164:167], v[76:79], v[108:111]
    ds_read_b64_tr_b16 v[68:69], v28 offset:42112
    buffer_load_dwordx4 v9, s[88:91], s32 offen offset:3072 lds
    v_mfma_f32_16x16x32_bf16 v[168:171], a[172:175], v[76:79], v[168:171]
    ds_read_b64_tr_b16 v[70:71], v28 offset:43392
    s_waitcnt lgkmcnt(8)
    s_mul_i32 s33, s32, 1920
    s_add_u32 s33, s33, s35
    s_add_u32 m0, s34, 0
    v_mfma_f32_16x16x32_bf16 v[112:115], a[160:163], v[80:83], v[112:115]
    ds_read_b64_tr_b16 v[72:73], v28 offset:47104
    buffer_load_dwordx4 v10, s[8:11], s33 offen offset:0 lds
    v_mfma_f32_16x16x32_bf16 v[172:175], a[168:171], v[80:83], v[172:175]
    ds_read_b64_tr_b16 v[74:75], v28 offset:48384
    v_mfma_f32_16x16x32_bf16 v[112:115], a[164:167], v[84:87], v[112:115]
    ds_read_b64_tr_b16 v[76:77], v28 offset:52224
    buffer_load_dwordx4 v11, s[8:11], s33 offen offset:1024 lds
    v_mfma_f32_16x16x32_bf16 v[172:175], a[172:175], v[84:87], v[172:175]
    ds_read_b64_tr_b16 v[78:79], v28 offset:53504
    s_waitcnt lgkmcnt(8)
    v_mfma_f32_16x16x32_bf16 v[116:119], a[160:163], v[88:91], v[116:119]
    ds_read_b64_tr_b16 v[80:81], v28 offset:47136
    buffer_load_dwordx4 v12, s[8:11], s33 offen offset:2048 lds
    v_mfma_f32_16x16x32_bf16 v[176:179], a[168:171], v[88:91], v[176:179]
    ds_read_b64_tr_b16 v[82:83], v28 offset:48416
    v_mfma_f32_16x16x32_bf16 v[116:119], a[164:167], v[92:95], v[116:119]
    ds_read_b64_tr_b16 v[84:85], v28 offset:52256
    buffer_load_dwordx4 v13, s[8:11], s33 offen offset:3072 lds
    v_mfma_f32_16x16x32_bf16 v[176:179], a[172:175], v[92:95], v[176:179]
    ds_read_b64_tr_b16 v[86:87], v28 offset:53536
    s_waitcnt lgkmcnt(8)
    s_add_u32 m0, s34, 4096
    v_mfma_f32_16x16x32_bf16 v[120:123], a[160:163], v[64:67], v[120:123]
    ds_read_b64_tr_b16 v[88:89], v28 offset:47168
    buffer_load_dwordx4 v14, s[8:11], s33 offen offset:0 lds
    v_mfma_f32_16x16x32_bf16 v[180:183], a[168:171], v[64:67], v[180:183]
    ds_read_b64_tr_b16 v[90:91], v28 offset:48448
    v_mfma_f32_16x16x32_bf16 v[120:123], a[164:167], v[68:71], v[120:123]
    ds_read_b64_tr_b16 v[92:93], v28 offset:52288
    v_mfma_f32_16x16x32_bf16 v[180:183], a[172:175], v[68:71], v[180:183]
    ds_read_b64_tr_b16 v[94:95], v28 offset:53568
    s_waitcnt lgkmcnt(8)
    v_mfma_f32_16x16x32_bf16 v[124:127], a[160:163], v[72:75], v[124:127]
    ds_read_b64_tr_b16 v[64:65], v28 offset:47200
    v_mfma_f32_16x16x32_bf16 v[184:187], a[168:171], v[72:75], v[184:187]
    ds_read_b64_tr_b16 v[66:67], v28 offset:48480
    v_mfma_f32_16x16x32_bf16 v[124:127], a[164:167], v[76:79], v[124:127]
    ds_read_b64_tr_b16 v[68:69], v28 offset:52320
    v_mfma_f32_16x16x32_bf16 v[184:187], a[172:175], v[76:79], v[184:187]
    ds_read_b64_tr_b16 v[70:71], v28 offset:53600
    s_waitcnt lgkmcnt(8)
    v_mfma_f32_16x16x32_bf16 v[128:131], a[160:163], v[80:83], v[128:131]
    ds_read_b64_tr_b16 v[72:73], v28 offset:47232
    v_mfma_f32_16x16x32_bf16 v[188:191], a[168:171], v[80:83], v[188:191]
    ds_read_b64_tr_b16 v[74:75], v28 offset:48512
    v_mfma_f32_16x16x32_bf16 v[128:131], a[164:167], v[84:87], v[128:131]
    ds_read_b64_tr_b16 v[76:77], v28 offset:52352
    v_mfma_f32_16x16x32_bf16 v[188:191], a[172:175], v[84:87], v[188:191]
    ds_read_b64_tr_b16 v[78:79], v28 offset:53632
    s_waitcnt lgkmcnt(8)
    v_mfma_f32_16x16x32_bf16 v[132:135], a[160:163], v[88:91], v[132:135]
    v_mfma_f32_16x16x32_bf16 v[192:195], a[168:171], v[88:91], v[192:195]
    v_mfma_f32_16x16x32_bf16 v[132:135], a[164:167], v[92:95], v[132:135]
    v_mfma_f32_16x16x32_bf16 v[192:195], a[172:175], v[92:95], v[192:195]
    s_waitcnt lgkmcnt(0)
    s_waitcnt vmcnt(9)
    s_barrier
    v_mfma_f32_16x16x32_bf16 v[136:139], a[160:163], v[64:67], v[136:139]
    ds_read_b128 a[176:179], v15 offset:0
    ds_read_b64_tr_b16 v[80:81], v96 offset:0
    v_mfma_f32_16x16x32_bf16 v[196:199], a[168:171], v[64:67], v[196:199]
    ds_read_b128 a[180:183], v16 offset:0
    ds_read_b64_tr_b16 v[82:83], v96 offset:1280
    v_mfma_f32_16x16x32_bf16 v[136:139], a[164:167], v[68:71], v[136:139]
    ds_read_b128 a[184:187], v15 offset:2048
    ds_read_b64_tr_b16 v[84:85], v96 offset:5120
    v_mfma_f32_16x16x32_bf16 v[196:199], a[172:175], v[68:71], v[196:199]
    ds_read_b128 a[188:191], v16 offset:2048
    ds_read_b64_tr_b16 v[86:87], v96 offset:6400
    v_mfma_f32_16x16x32_bf16 v[140:143], a[160:163], v[72:75], v[140:143]
    ds_read_b64_tr_b16 v[88:89], v96 offset:32
    ds_read_b64_tr_b16 v[64:65], v96 offset:64
    v_mfma_f32_16x16x32_bf16 v[200:203], a[168:171], v[72:75], v[200:203]
    ds_read_b64_tr_b16 v[90:91], v96 offset:1312
    ds_read_b64_tr_b16 v[66:67], v96 offset:1344
    v_mfma_f32_16x16x32_bf16 v[140:143], a[164:167], v[76:79], v[140:143]
    ds_read_b64_tr_b16 v[92:93], v96 offset:5152
    ds_read_b64_tr_b16 v[68:69], v96 offset:5184
    v_mfma_f32_16x16x32_bf16 v[200:203], a[172:175], v[76:79], v[200:203]
    ds_read_b64_tr_b16 v[94:95], v96 offset:6432
    ds_read_b64_tr_b16 v[70:71], v96 offset:6464
    s_waitcnt lgkmcnt(8)
    s_add_u32 s32, s32, 128
    s_cmpk_eq_u32 s32, 1280
    s_cselect_b32 s32, 0, s32
    s_add_u32 m0, s47, 36864
    v_mfma_f32_16x16x32_bf16 v[104:107], a[176:179], v[80:83], v[104:107]
    ds_read_b64_tr_b16 v[72:73], v96 offset:96
    buffer_load_dwordx4 v6, s[88:91], s32 offen offset:0 lds
    v_mfma_f32_16x16x32_bf16 v[164:167], a[184:187], v[80:83], v[164:167]
    ds_read_b64_tr_b16 v[74:75], v96 offset:1376
    v_mfma_f32_16x16x32_bf16 v[104:107], a[180:183], v[84:87], v[104:107]
    ds_read_b64_tr_b16 v[76:77], v96 offset:5216
    buffer_load_dwordx4 v7, s[88:91], s32 offen offset:1024 lds
    v_mfma_f32_16x16x32_bf16 v[164:167], a[188:191], v[84:87], v[164:167]
    ds_read_b64_tr_b16 v[78:79], v96 offset:6496
    s_waitcnt lgkmcnt(5)
    v_mfma_f32_16x16x32_bf16 v[108:111], a[176:179], v[88:91], v[108:111]
    ds_read_b64_tr_b16 v[80:81], v96 offset:128
    buffer_load_dwordx4 v8, s[88:91], s32 offen offset:2048 lds
    v_mfma_f32_16x16x32_bf16 v[168:171], a[184:187], v[88:91], v[168:171]
    ds_read_b64_tr_b16 v[82:83], v96 offset:1408
    v_mfma_f32_16x16x32_bf16 v[108:111], a[180:183], v[92:95], v[108:111]
    ds_read_b64_tr_b16 v[84:85], v96 offset:5248
    buffer_load_dwordx4 v9, s[88:91], s32 offen offset:3072 lds
    v_mfma_f32_16x16x32_bf16 v[168:171], a[188:191], v[92:95], v[168:171]
    ds_read_b64_tr_b16 v[86:87], v96 offset:6528
    s_waitcnt lgkmcnt(8)
    s_mul_i32 s33, s32, 1920
    s_add_u32 s33, s33, s35
    s_add_u32 m0, s34, 36864
    v_mfma_f32_16x16x32_bf16 v[112:115], a[176:179], v[64:67], v[112:115]
    ds_read_b64_tr_b16 v[88:89], v96 offset:10240
    buffer_load_dwordx4 v10, s[8:11], s33 offen offset:0 lds
    v_mfma_f32_16x16x32_bf16 v[172:175], a[184:187], v[64:67], v[172:175]
    ds_read_b64_tr_b16 v[90:91], v96 offset:11520
    v_mfma_f32_16x16x32_bf16 v[112:115], a[180:183], v[68:71], v[112:115]
    ds_read_b64_tr_b16 v[92:93], v96 offset:15360
    buffer_load_dwordx4 v11, s[8:11], s33 offen offset:1024 lds
    v_mfma_f32_16x16x32_bf16 v[172:175], a[188:191], v[68:71], v[172:175]
    ds_read_b64_tr_b16 v[94:95], v96 offset:16640
    s_waitcnt lgkmcnt(8)
    v_mfma_f32_16x16x32_bf16 v[116:119], a[176:179], v[72:75], v[116:119]
    ds_read_b64_tr_b16 v[64:65], v96 offset:10272
    buffer_load_dwordx4 v12, s[8:11], s33 offen offset:2048 lds
    v_mfma_f32_16x16x32_bf16 v[176:179], a[184:187], v[72:75], v[176:179]
    ds_read_b64_tr_b16 v[66:67], v96 offset:11552
    v_mfma_f32_16x16x32_bf16 v[116:119], a[180:183], v[76:79], v[116:119]
    ds_read_b64_tr_b16 v[68:69], v96 offset:15392
    buffer_load_dwordx4 v13, s[8:11], s33 offen offset:3072 lds
    v_mfma_f32_16x16x32_bf16 v[176:179], a[188:191], v[76:79], v[176:179]
    ds_read_b64_tr_b16 v[70:71], v96 offset:16672
    s_waitcnt lgkmcnt(8)
    s_add_u32 m0, s34, 40960
    v_mfma_f32_16x16x32_bf16 v[120:123], a[176:179], v[80:83], v[120:123]
    ds_read_b64_tr_b16 v[72:73], v96 offset:10304
    buffer_load_dwordx4 v14, s[8:11], s33 offen offset:0 lds
    v_mfma_f32_16x16x32_bf16 v[180:183], a[184:187], v[80:83], v[180:183]
    ds_read_b64_tr_b16 v[74:75], v96 offset:11584
    v_mfma_f32_16x16x32_bf16 v[120:123], a[180:183], v[84:87], v[120:123]
    ds_read_b64_tr_b16 v[76:77], v96 offset:15424
    v_mfma_f32_16x16x32_bf16 v[180:183], a[188:191], v[84:87], v[180:183]
    ds_read_b64_tr_b16 v[78:79], v96 offset:16704
    s_waitcnt lgkmcnt(8)
    v_mfma_f32_16x16x32_bf16 v[124:127], a[176:179], v[88:91], v[124:127]
    ds_read_b64_tr_b16 v[80:81], v96 offset:10336
    v_mfma_f32_16x16x32_bf16 v[184:187], a[184:187], v[88:91], v[184:187]
    ds_read_b64_tr_b16 v[82:83], v96 offset:11616
    v_mfma_f32_16x16x32_bf16 v[124:127], a[180:183], v[92:95], v[124:127]
    ds_read_b64_tr_b16 v[84:85], v96 offset:15456
    v_mfma_f32_16x16x32_bf16 v[184:187], a[188:191], v[92:95], v[184:187]
    ds_read_b64_tr_b16 v[86:87], v96 offset:16736
    s_waitcnt lgkmcnt(8)
    v_mfma_f32_16x16x32_bf16 v[128:131], a[176:179], v[64:67], v[128:131]
    ds_read_b64_tr_b16 v[88:89], v96 offset:10368
    v_mfma_f32_16x16x32_bf16 v[188:191], a[184:187], v[64:67], v[188:191]
    ds_read_b64_tr_b16 v[90:91], v96 offset:11648
    v_mfma_f32_16x16x32_bf16 v[128:131], a[180:183], v[68:71], v[128:131]
    ds_read_b64_tr_b16 v[92:93], v96 offset:15488
    v_mfma_f32_16x16x32_bf16 v[188:191], a[188:191], v[68:71], v[188:191]
    ds_read_b64_tr_b16 v[94:95], v96 offset:16768
    s_waitcnt lgkmcnt(8)
    v_mfma_f32_16x16x32_bf16 v[132:135], a[176:179], v[72:75], v[132:135]
    v_mfma_f32_16x16x32_bf16 v[192:195], a[184:187], v[72:75], v[192:195]
    v_mfma_f32_16x16x32_bf16 v[132:135], a[180:183], v[76:79], v[132:135]
    v_mfma_f32_16x16x32_bf16 v[192:195], a[188:191], v[76:79], v[192:195]
    s_waitcnt lgkmcnt(0)
    s_waitcnt vmcnt(9)
    s_barrier
    v_mfma_f32_16x16x32_bf16 v[136:139], a[176:179], v[80:83], v[136:139]
    ds_read_b128 a[192:195], v22 offset:0
    ds_read_b64_tr_b16 v[64:65], v28 offset:0
    v_mfma_f32_16x16x32_bf16 v[196:199], a[184:187], v[80:83], v[196:199]
    ds_read_b128 a[196:199], v23 offset:0
    ds_read_b64_tr_b16 v[66:67], v28 offset:1280
    v_mfma_f32_16x16x32_bf16 v[136:139], a[180:183], v[84:87], v[136:139]
    ds_read_b128 a[200:203], v22 offset:2048
    ds_read_b64_tr_b16 v[68:69], v28 offset:5120
    v_mfma_f32_16x16x32_bf16 v[196:199], a[188:191], v[84:87], v[196:199]
    ds_read_b128 a[204:207], v23 offset:2048
    ds_read_b64_tr_b16 v[70:71], v28 offset:6400
    v_mfma_f32_16x16x32_bf16 v[140:143], a[176:179], v[88:91], v[140:143]
    ds_read_b64_tr_b16 v[72:73], v28 offset:32
    ds_read_b64_tr_b16 v[80:81], v28 offset:64
    v_mfma_f32_16x16x32_bf16 v[200:203], a[184:187], v[88:91], v[200:203]
    ds_read_b64_tr_b16 v[74:75], v28 offset:1312
    ds_read_b64_tr_b16 v[82:83], v28 offset:1344
    v_mfma_f32_16x16x32_bf16 v[140:143], a[180:183], v[92:95], v[140:143]
    ds_read_b64_tr_b16 v[76:77], v28 offset:5152
    ds_read_b64_tr_b16 v[84:85], v28 offset:5184
    v_mfma_f32_16x16x32_bf16 v[200:203], a[188:191], v[92:95], v[200:203]
    ds_read_b64_tr_b16 v[78:79], v28 offset:6432
    ds_read_b64_tr_b16 v[86:87], v28 offset:6464
    s_waitcnt lgkmcnt(8)
    s_add_u32 s32, s32, 128
    s_cmpk_eq_u32 s32, 1280
    s_cselect_b32 s32, 0, s32
    s_add_u32 m0, s47, 73728
    v_mfma_f32_16x16x32_bf16 v[104:107], a[192:195], v[64:67], v[104:107]
    ds_read_b64_tr_b16 v[88:89], v28 offset:96
    buffer_load_dwordx4 v6, s[88:91], s32 offen offset:0 lds
    v_mfma_f32_16x16x32_bf16 v[164:167], a[200:203], v[64:67], v[164:167]
    ds_read_b64_tr_b16 v[90:91], v28 offset:1376
    v_mfma_f32_16x16x32_bf16 v[104:107], a[196:199], v[68:71], v[104:107]
    ds_read_b64_tr_b16 v[92:93], v28 offset:5216
    buffer_load_dwordx4 v7, s[88:91], s32 offen offset:1024 lds
    v_mfma_f32_16x16x32_bf16 v[164:167], a[204:207], v[68:71], v[164:167]
    ds_read_b64_tr_b16 v[94:95], v28 offset:6496
    s_waitcnt lgkmcnt(5)
    v_mfma_f32_16x16x32_bf16 v[108:111], a[192:195], v[72:75], v[108:111]
    ds_read_b64_tr_b16 v[64:65], v28 offset:128
    buffer_load_dwordx4 v8, s[88:91], s32 offen offset:2048 lds
    v_mfma_f32_16x16x32_bf16 v[168:171], a[200:203], v[72:75], v[168:171]
    ds_read_b64_tr_b16 v[66:67], v28 offset:1408
    v_mfma_f32_16x16x32_bf16 v[108:111], a[196:199], v[76:79], v[108:111]
    ds_read_b64_tr_b16 v[68:69], v28 offset:5248
    buffer_load_dwordx4 v9, s[88:91], s32 offen offset:3072 lds
    v_mfma_f32_16x16x32_bf16 v[168:171], a[204:207], v[76:79], v[168:171]
    ds_read_b64_tr_b16 v[70:71], v28 offset:6528
    s_waitcnt lgkmcnt(8)
    s_mul_i32 s33, s32, 1920
    s_add_u32 s33, s33, s35
    s_add_u32 m0, s34, 73728
    v_mfma_f32_16x16x32_bf16 v[112:115], a[192:195], v[80:83], v[112:115]
    ds_read_b64_tr_b16 v[72:73], v28 offset:10240
    buffer_load_dwordx4 v10, s[8:11], s33 offen offset:0 lds
    v_mfma_f32_16x16x32_bf16 v[172:175], a[200:203], v[80:83], v[172:175]
    ds_read_b64_tr_b16 v[74:75], v28 offset:11520
    v_mfma_f32_16x16x32_bf16 v[112:115], a[196:199], v[84:87], v[112:115]
    ds_read_b64_tr_b16 v[76:77], v28 offset:15360
    buffer_load_dwordx4 v11, s[8:11], s33 offen offset:1024 lds
    v_mfma_f32_16x16x32_bf16 v[172:175], a[204:207], v[84:87], v[172:175]
    ds_read_b64_tr_b16 v[78:79], v28 offset:16640
    s_waitcnt lgkmcnt(8)
    v_mfma_f32_16x16x32_bf16 v[116:119], a[192:195], v[88:91], v[116:119]
    ds_read_b64_tr_b16 v[80:81], v28 offset:10272
    buffer_load_dwordx4 v12, s[8:11], s33 offen offset:2048 lds
    v_mfma_f32_16x16x32_bf16 v[176:179], a[200:203], v[88:91], v[176:179]
    ds_read_b64_tr_b16 v[82:83], v28 offset:11552
    v_mfma_f32_16x16x32_bf16 v[116:119], a[196:199], v[92:95], v[116:119]
    ds_read_b64_tr_b16 v[84:85], v28 offset:15392
    buffer_load_dwordx4 v13, s[8:11], s33 offen offset:3072 lds
    v_mfma_f32_16x16x32_bf16 v[176:179], a[204:207], v[92:95], v[176:179]
    ds_read_b64_tr_b16 v[86:87], v28 offset:16672
    s_waitcnt lgkmcnt(8)
    s_add_u32 m0, s34, 77824
    v_mfma_f32_16x16x32_bf16 v[120:123], a[192:195], v[64:67], v[120:123]
    ds_read_b64_tr_b16 v[88:89], v28 offset:10304
    buffer_load_dwordx4 v14, s[8:11], s33 offen offset:0 lds
    v_mfma_f32_16x16x32_bf16 v[180:183], a[200:203], v[64:67], v[180:183]
    ds_read_b64_tr_b16 v[90:91], v28 offset:11584
    s_add_u32 s44, s44, 491520
    s_cmp_ge_u32 s44, 2457600
    s_cselect_b32 s3, 2457600, 0
    s_sub_u32 s44, s44, s3
    s_add_u32 m0, s34, 140288
    v_mfma_f32_16x16x32_bf16 v[120:123], a[196:199], v[68:71], v[120:123]
    ds_read_b64_tr_b16 v[92:93], v28 offset:15424
    buffer_load_dwordx4 v10, s[8:11], s44 offen offset:0 lds
    v_mfma_f32_16x16x32_bf16 v[180:183], a[204:207], v[68:71], v[180:183]
    ds_read_b64_tr_b16 v[94:95], v28 offset:16704
    s_waitcnt lgkmcnt(8)
    v_mfma_f32_16x16x32_bf16 v[124:127], a[192:195], v[72:75], v[124:127]
    ds_read_b64_tr_b16 v[64:65], v28 offset:10336
    buffer_load_dwordx4 v11, s[8:11], s44 offen offset:1024 lds
    v_mfma_f32_16x16x32_bf16 v[184:187], a[200:203], v[72:75], v[184:187]
    ds_read_b64_tr_b16 v[66:67], v28 offset:11616
    v_mfma_f32_16x16x32_bf16 v[124:127], a[196:199], v[76:79], v[124:127]
    ds_read_b64_tr_b16 v[68:69], v28 offset:15456
    buffer_load_dwordx4 v12, s[8:11], s44 offen offset:2048 lds
    v_mfma_f32_16x16x32_bf16 v[184:187], a[204:207], v[76:79], v[184:187]
    ds_read_b64_tr_b16 v[70:71], v28 offset:16736
    s_waitcnt lgkmcnt(8)
    v_mfma_f32_16x16x32_bf16 v[128:131], a[192:195], v[80:83], v[128:131]
    ds_read_b64_tr_b16 v[72:73], v28 offset:10368
    buffer_load_dwordx4 v13, s[8:11], s44 offen offset:3072 lds
    v_mfma_f32_16x16x32_bf16 v[188:191], a[200:203], v[80:83], v[188:191]
    ds_read_b64_tr_b16 v[74:75], v28 offset:11648
    s_add_u32 m0, s34, 144384
    v_mfma_f32_16x16x32_bf16 v[128:131], a[196:199], v[84:87], v[128:131]
    ds_read_b64_tr_b16 v[76:77], v28 offset:15488
    buffer_load_dwordx4 v14, s[8:11], s44 offen offset:0 lds
    v_mfma_f32_16x16x32_bf16 v[188:191], a[204:207], v[84:87], v[188:191]
    ds_read_b64_tr_b16 v[78:79], v28 offset:16768
    s_waitcnt lgkmcnt(8)
    v_mfma_f32_16x16x32_bf16 v[132:135], a[192:195], v[88:91], v[132:135]
    v_mfma_f32_16x16x32_bf16 v[192:195], a[200:203], v[88:91], v[192:195]
    v_mfma_f32_16x16x32_bf16 v[132:135], a[196:199], v[92:95], v[132:135]
    v_mfma_f32_16x16x32_bf16 v[192:195], a[204:207], v[92:95], v[192:195]
    s_waitcnt lgkmcnt(0)
    s_waitcnt vmcnt(14)
    s_barrier
    v_mfma_f32_16x16x32_bf16 v[136:139], a[192:195], v[64:67], v[136:139]
    ds_read_b128 a[208:211], v22 offset:36864
    ds_read_b64_tr_b16 v[80:81], v28 offset:36864
    v_mfma_f32_16x16x32_bf16 v[196:199], a[200:203], v[64:67], v[196:199]
    ds_read_b128 a[212:215], v23 offset:36864
    ds_read_b64_tr_b16 v[82:83], v28 offset:38144
    v_mfma_f32_16x16x32_bf16 v[136:139], a[196:199], v[68:71], v[136:139]
    ds_read_b128 a[216:219], v22 offset:38912
    ds_read_b64_tr_b16 v[84:85], v28 offset:41984
    v_mfma_f32_16x16x32_bf16 v[196:199], a[204:207], v[68:71], v[196:199]
    ds_read_b128 a[220:223], v23 offset:38912
    ds_read_b64_tr_b16 v[86:87], v28 offset:43264
    v_mfma_f32_16x16x32_bf16 v[140:143], a[192:195], v[72:75], v[140:143]
    ds_read_b64_tr_b16 v[88:89], v28 offset:36896
    ds_read_b64_tr_b16 v[64:65], v28 offset:36928
    v_mfma_f32_16x16x32_bf16 v[200:203], a[200:203], v[72:75], v[200:203]
    ds_read_b64_tr_b16 v[90:91], v28 offset:38176
    ds_read_b64_tr_b16 v[66:67], v28 offset:38208
    v_mfma_f32_16x16x32_bf16 v[140:143], a[196:199], v[76:79], v[140:143]
    ds_read_b64_tr_b16 v[92:93], v28 offset:42016
    ds_read_b64_tr_b16 v[68:69], v28 offset:42048
    v_mfma_f32_16x16x32_bf16 v[200:203], a[204:207], v[76:79], v[200:203]
    ds_read_b64_tr_b16 v[94:95], v28 offset:43296
    ds_read_b64_tr_b16 v[70:71], v28 offset:43328
    s_lshl_b32 s36, s22, 4
    v_add_u32 v101, s36, v3
    v_lshl_add_u32 v21, v3, 4, s21
    v_and_b32 v20, 1, v2
    v_cmp_eq_u32 vcc, 0, v20
    s_nop 1
    v_cndmask_b32 v101, v21, v101, vcc
    v_lshlrev_b32 v101, 7, v101
    v_add_u32 v101, 98304, v101
    s_cmp_lg_u32 s20, 0
    s_cbranch_scc1 W0_18
    buffer_load_dword v20, v101, s[80:83], 0 offen sc1
W0_18:
    s_add_u32 s4, s76, 0x01500000
    s_addc_u32 s5, s77, 0
    s_mov_b32 s6, 0x002a8000
    s_mov_b32 s7, 0x00020000
    v_lshlrev_b32 v19, 7, v3
    s_lshl_b32 s48, s61, 11
    s_add_u32 s48, s48, 81920
    s_waitcnt lgkmcnt(8)
    s_add_u32 s32, s32, 128
    s_cmpk_eq_u32 s32, 1280
    s_cselect_b32 s32, 0, s32
    s_add_u32 m0, s47, 0
    v_mfma_f32_16x16x32_bf16 v[104:107], a[208:211], v[80:83], v[104:107]
    ds_read_b64_tr_b16 v[72:73], v28 offset:36960
    buffer_load_dwordx4 v6, s[88:91], s32 offen offset:0 lds
    v_mfma_f32_16x16x32_bf16 v[164:167], a[216:219], v[80:83], v[164:167]
    ds_read_b64_tr_b16 v[74:75], v28 offset:38240
    v_mfma_f32_16x16x32_bf16 v[104:107], a[212:215], v[84:87], v[104:107]
    ds_read_b64_tr_b16 v[76:77], v28 offset:42080
    buffer_load_dwordx4 v7, s[88:91], s32 offen offset:1024 lds
    v_mfma_f32_16x16x32_bf16 v[164:167], a[220:223], v[84:87], v[164:167]
    ds_read_b64_tr_b16 v[78:79], v28 offset:43360
    s_waitcnt lgkmcnt(5)
    v_mfma_f32_16x16x32_bf16 v[108:111], a[208:211], v[88:91], v[108:111]
    ds_read_b64_tr_b16 v[80:81], v28 offset:36992
    buffer_load_dwordx4 v8, s[88:91], s32 offen offset:2048 lds
    v_mfma_f32_16x16x32_bf16 v[168:171], a[216:219], v[88:91], v[168:171]
    ds_read_b64_tr_b16 v[82:83], v28 offset:38272
    v_mfma_f32_16x16x32_bf16 v[108:111], a[212:215], v[92:95], v[108:111]
    ds_read_b64_tr_b16 v[84:85], v28 offset:42112
    buffer_load_dwordx4 v9, s[88:91], s32 offen offset:3072 lds
    v_mfma_f32_16x16x32_bf16 v[168:171], a[220:223], v[92:95], v[168:171]
    ds_read_b64_tr_b16 v[86:87], v28 offset:43392
    s_waitcnt lgkmcnt(8)
    s_mul_i32 s33, s32, 1920
    s_add_u32 s33, s33, s35
    s_add_u32 m0, s34, 0
    v_mfma_f32_16x16x32_bf16 v[112:115], a[208:211], v[64:67], v[112:115]
    ds_read_b64_tr_b16 v[88:89], v28 offset:47104
    buffer_load_dwordx4 v10, s[8:11], s33 offen offset:0 lds
    v_mfma_f32_16x16x32_bf16 v[172:175], a[216:219], v[64:67], v[172:175]
    ds_read_b64_tr_b16 v[90:91], v28 offset:48384
    v_mfma_f32_16x16x32_bf16 v[112:115], a[212:215], v[68:71], v[112:115]
    ds_read_b64_tr_b16 v[92:93], v28 offset:52224
    buffer_load_dwordx4 v11, s[8:11], s33 offen offset:1024 lds
    v_mfma_f32_16x16x32_bf16 v[172:175], a[220:223], v[68:71], v[172:175]
    ds_read_b64_tr_b16 v[94:95], v28 offset:53504
    s_waitcnt lgkmcnt(8)
    v_mfma_f32_16x16x32_bf16 v[116:119], a[208:211], v[72:75], v[116:119]
    ds_read_b64_tr_b16 v[64:65], v28 offset:47136
    buffer_load_dwordx4 v12, s[8:11], s33 offen offset:2048 lds
    v_mfma_f32_16x16x32_bf16 v[176:179], a[216:219], v[72:75], v[176:179]
    ds_read_b64_tr_b16 v[66:67], v28 offset:48416
    v_mfma_f32_16x16x32_bf16 v[116:119], a[212:215], v[76:79], v[116:119]
    ds_read_b64_tr_b16 v[68:69], v28 offset:52256
    buffer_load_dwordx4 v13, s[8:11], s33 offen offset:3072 lds
    v_mfma_f32_16x16x32_bf16 v[176:179], a[220:223], v[76:79], v[176:179]
    ds_read_b64_tr_b16 v[70:71], v28 offset:53536
    s_waitcnt lgkmcnt(8)
    s_add_u32 m0, s34, 4096
    v_mfma_f32_16x16x32_bf16 v[120:123], a[208:211], v[80:83], v[120:123]
    ds_read_b64_tr_b16 v[72:73], v28 offset:47168
    buffer_load_dwordx4 v14, s[8:11], s33 offen offset:0 lds
    v_mfma_f32_16x16x32_bf16 v[180:183], a[216:219], v[80:83], v[180:183]
    ds_read_b64_tr_b16 v[74:75], v28 offset:48448
    v_mfma_f32_16x16x32_bf16 v[120:123], a[212:215], v[84:87], v[120:123]
    ds_read_b64_tr_b16 v[76:77], v28 offset:52288
    buffer_load_dword v18, v19, s[80:83], s48 offen sc1
    v_mfma_f32_16x16x32_bf16 v[180:183], a[220:223], v[84:87], v[180:183]
    ds_read_b64_tr_b16 v[78:79], v28 offset:53568
    s_waitcnt lgkmcnt(8)
    v_mfma_f32_16x16x32_bf16 v[124:127], a[208:211], v[88:91], v[124:127]
    ds_read_b64_tr_b16 v[80:81], v28 offset:47200
    v_mfma_f32_16x16x32_bf16 v[184:187], a[216:219], v[88:91], v[184:187]
    ds_read_b64_tr_b16 v[82:83], v28 offset:48480
    v_mfma_f32_16x16x32_bf16 v[124:127], a[212:215], v[92:95], v[124:127]
    ds_read_b64_tr_b16 v[84:85], v28 offset:52320
    v_mfma_f32_16x16x32_bf16 v[184:187], a[220:223], v[92:95], v[184:187]
    ds_read_b64_tr_b16 v[86:87], v28 offset:53600
    s_waitcnt lgkmcnt(8)
    v_mfma_f32_16x16x32_bf16 v[128:131], a[208:211], v[64:67], v[128:131]
    ds_read_b64_tr_b16 v[88:89], v28 offset:47232
    v_mfma_f32_16x16x32_bf16 v[188:191], a[216:219], v[64:67], v[188:191]
    ds_read_b64_tr_b16 v[90:91], v28 offset:48512
    v_mfma_f32_16x16x32_bf16 v[128:131], a[212:215], v[68:71], v[128:131]
    ds_read_b64_tr_b16 v[92:93], v28 offset:52352
    v_mfma_f32_16x16x32_bf16 v[188:191], a[220:223], v[68:71], v[188:191]
    ds_read_b64_tr_b16 v[94:95], v28 offset:53632
    s_waitcnt lgkmcnt(8)
    v_mfma_f32_16x16x32_bf16 v[132:135], a[208:211], v[72:75], v[132:135]
    v_mfma_f32_16x16x32_bf16 v[192:195], a[216:219], v[72:75], v[192:195]
    v_mfma_f32_16x16x32_bf16 v[132:135], a[212:215], v[76:79], v[132:135]
    v_mfma_f32_16x16x32_bf16 v[192:195], a[220:223], v[76:79], v[192:195]
    s_waitcnt lgkmcnt(0)
    s_waitcnt vmcnt(10)
    s_cmp_lg_u32 s20, 0
    s_cbranch_scc1 W0_19
    s_mov_b32 s98, 0
PL_20:
    v_cmp_ne_u32 vcc, 1, v20
    s_cbranch_vccz PD_21
    s_add_u32 s98, s98, 1
    s_cmp_ge_u32 s98, 0x40000
    s_cbranch_scc1 PD_21
    s_sleep 0
    buffer_load_dword v20, v101, s[80:83], 0 offen sc1
    s_waitcnt vmcnt(0)
    s_branch PL_20
PD_21:
W0_19:
    s_barrier
    v_mfma_f32_16x16x32_bf16 v[136:139], a[208:211], v[80:83], v[136:139]
    ds_read_b128 a[224:227], v15 offset:0
    ds_read_b64_tr_b16 v[64:65], v96 offset:0
    v_mfma_f32_16x16x32_bf16 v[196:199], a[216:219], v[80:83], v[196:199]
    ds_read_b128 a[228:231], v16 offset:0
    ds_read_b64_tr_b16 v[66:67], v96 offset:1280
    v_mfma_f32_16x16x32_bf16 v[136:139], a[212:215], v[84:87], v[136:139]
    ds_read_b128 a[232:235], v15 offset:2048
    ds_read_b64_tr_b16 v[68:69], v96 offset:5120
    v_mfma_f32_16x16x32_bf16 v[196:199], a[220:223], v[84:87], v[196:199]
    ds_read_b128 a[236:239], v16 offset:2048
    ds_read_b64_tr_b16 v[70:71], v96 offset:6400
    v_mfma_f32_16x16x32_bf16 v[140:143], a[208:211], v[88:91], v[140:143]
    ds_read_b64_tr_b16 v[72:73], v96 offset:32
    ds_read_b64_tr_b16 v[80:81], v96 offset:64
    v_mfma_f32_16x16x32_bf16 v[200:203], a[216:219], v[88:91], v[200:203]
    ds_read_b64_tr_b16 v[74:75], v96 offset:1312
    ds_read_b64_tr_b16 v[82:83], v96 offset:1344
    v_mfma_f32_16x16x32_bf16 v[140:143], a[212:215], v[92:95], v[140:143]
    ds_read_b64_tr_b16 v[76:77], v96 offset:5152
    ds_read_b64_tr_b16 v[84:85], v96 offset:5184
    v_mfma_f32_16x16x32_bf16 v[200:203], a[220:223], v[92:95], v[200:203]
    ds_read_b64_tr_b16 v[78:79], v96 offset:6432
    ds_read_b64_tr_b16 v[86:87], v96 offset:6464
    v_min_u32 v26, 135, v0
    v_lshlrev_b32 v26, 3, v26
    v_add_u32 v31, 160768, v26
    v_and_b32 v27, 31, v1
    s_lshl_b32 s36, s20, 8
    v_lshl_add_u32 v27, v27, 3, s36
    v_lshrrev_b32 v25, 5, v1
    v_lshl_add_u32 v27, v25, 10, v27
    s_waitcnt lgkmcnt(8)
    v_mfma_f32_16x16x32_bf16 v[104:107], a[224:227], v[64:67], v[104:107]
    ds_read_b64_tr_b16 v[88:89], v96 offset:96
    buffer_load_dwordx2 v[244:245], v27, s[80:83], s50 offen offset:0
    v_mfma_f32_16x16x32_bf16 v[164:167], a[232:235], v[64:67], v[164:167]
    ds_read_b64_tr_b16 v[90:91], v96 offset:1376
    v_mfma_f32_16x16x32_bf16 v[104:107], a[228:231], v[68:71], v[104:107]
    ds_read_b64_tr_b16 v[92:93], v96 offset:5216
    buffer_load_dwordx2 v[246:247], v27, s[80:83], s50 offen offset:2048
    v_mfma_f32_16x16x32_bf16 v[164:167], a[236:239], v[68:71], v[164:167]
    ds_read_b64_tr_b16 v[94:95], v96 offset:6496
    s_waitcnt lgkmcnt(5)
    s_add_u32 s50, s50, 4096
    v_mfma_f32_16x16x32_bf16 v[108:111], a[224:227], v[72:75], v[108:111]
    ds_read_b64_tr_b16 v[64:65], v96 offset:128
    buffer_load_dwordx2 v[248:249], v27, s[80:83], s50 offen offset:0
    v_mfma_f32_16x16x32_bf16 v[168:171], a[232:235], v[72:75], v[168:171]
    ds_read_b64_tr_b16 v[66:67], v96 offset:1408
    v_mfma_f32_16x16x32_bf16 v[108:111], a[228:231], v[76:79], v[108:111]
    ds_read_b64_tr_b16 v[68:69], v96 offset:5248
    buffer_load_dwordx2 v[250:251], v27, s[80:83], s50 offen offset:2048
    v_mfma_f32_16x16x32_bf16 v[168:171], a[236:239], v[76:79], v[168:171]
    ds_read_b64_tr_b16 v[70:71], v96 offset:6528
    s_waitcnt lgkmcnt(8)
    s_add_u32 s50, s50, 4096
    v_mfma_f32_16x16x32_bf16 v[112:115], a[224:227], v[80:83], v[112:115]
    ds_read_b64_tr_b16 v[72:73], v96 offset:10240
    buffer_load_dwordx2 v[252:253], v27, s[80:83], s50 offen offset:0
    v_mfma_f32_16x16x32_bf16 v[172:175], a[232:235], v[80:83], v[172:175]
    ds_read_b64_tr_b16 v[74:75], v96 offset:11520
    v_mfma_f32_16x16x32_bf16 v[112:115], a[228:231], v[84:87], v[112:115]
    ds_read_b64_tr_b16 v[76:77], v96 offset:15360
    buffer_load_dwordx2 v[32:33], v26, s[80:83], s49 offen offset:0
    v_mfma_f32_16x16x32_bf16 v[172:175], a[236:239], v[84:87], v[172:175]
    ds_read_b64_tr_b16 v[78:79], v96 offset:16640
    s_waitcnt lgkmcnt(8)
    v_mfma_f32_16x16x32_bf16 v[116:119], a[224:227], v[88:91], v[116:119]
    ds_read_b64_tr_b16 v[80:81], v96 offset:10272
    buffer_load_dwordx2 v[34:35], v26, s[80:83], s49 offen offset:1280
    v_mfma_f32_16x16x32_bf16 v[176:179], a[232:235], v[88:91], v[176:179]
    ds_read_b64_tr_b16 v[82:83], v96 offset:11552
    v_mfma_f32_16x16x32_bf16 v[116:119], a[228:231], v[92:95], v[116:119]
    ds_read_b64_tr_b16 v[84:85], v96 offset:15392
    buffer_load_dwordx2 v[36:37], v26, s[80:83], s49 offen offset:2560
    v_mfma_f32_16x16x32_bf16 v[176:179], a[236:239], v[92:95], v[176:179]
    ds_read_b64_tr_b16 v[86:87], v96 offset:16672
    s_waitcnt lgkmcnt(8)
    v_mfma_f32_16x16x32_bf16 v[120:123], a[224:227], v[64:67], v[120:123]
    ds_read_b64_tr_b16 v[88:89], v96 offset:10304
    buffer_load_dwordx2 v[38:39], v26, s[80:83], s49 offen offset:3840
    v_mfma_f32_16x16x32_bf16 v[180:183], a[232:235], v[64:67], v[180:183]
    ds_read_b64_tr_b16 v[90:91], v96 offset:11584
    s_add_u32 s49, s49, 5120
    v_mfma_f32_16x16x32_bf16 v[120:123], a[228:231], v[68:71], v[120:123]
    ds_read_b64_tr_b16 v[92:93], v96 offset:15424
    buffer_load_dwordx2 v[40:41], v26, s[80:83], s49 offen offset:0
    v_mfma_f32_16x16x32_bf16 v[180:183], a[236:239], v[68:71], v[180:183]
    ds_read_b64_tr_b16 v[94:95], v96 offset:16704
    s_waitcnt lgkmcnt(8)
    v_mfma_f32_16x16x32_bf16 v[124:127], a[224:227], v[72:75], v[124:127]
    ds_read_b64_tr_b16 v[64:65], v96 offset:10336
    buffer_load_dwordx2 v[42:43], v26, s[80:83], s49 offen offset:1280
    v_mfma_f32_16x16x32_bf16 v[184:187], a[232:235], v[72:75], v[184:187]
    ds_read_b64_tr_b16 v[66:67], v96 offset:11616
    v_mfma_f32_16x16x32_bf16 v[124:127], a[228:231], v[76:79], v[124:127]
    ds_read_b64_tr_b16 v[68:69], v96 offset:15456
    buffer_load_dwordx2 v[44:45], v26, s[80:83], s49 offen offset:2560
    v_mfma_f32_16x16x32_bf16 v[184:187], a[236:239], v[76:79], v[184:187]
    ds_read_b64_tr_b16 v[70:71], v96 offset:16736
    s_waitcnt lgkmcnt(8)
    v_mfma_f32_16x16x32_bf16 v[128:131], a[224:227], v[80:83], v[128:131]
    ds_read_b64_tr_b16 v[72:73], v96 offset:10368
    buffer_load_dwordx2 v[46:47], v26, s[80:83], s49 offen offset:3840
    v_mfma_f32_16x16x32_bf16 v[188:191], a[232:235], v[80:83], v[188:191]
    ds_read_b64_tr_b16 v[74:75], v96 offset:11648
    s_add_u32 s49, s49, 5120
    v_mfma_f32_16x16x32_bf16 v[128:131], a[228:231], v[84:87], v[128:131]
    ds_read_b64_tr_b16 v[76:77], v96 offset:15488
    buffer_load_dwordx2 v[48:49], v26, s[80:83], s49 offen offset:0
    v_mfma_f32_16x16x32_bf16 v[188:191], a[236:239], v[84:87], v[188:191]
    ds_read_b64_tr_b16 v[78:79], v96 offset:16768
    s_waitcnt lgkmcnt(8)
    v_mfma_f32_16x16x32_bf16 v[132:135], a[224:227], v[88:91], v[132:135]
    buffer_load_dwordx2 v[50:51], v26, s[80:83], s49 offen offset:1280
    v_mfma_f32_16x16x32_bf16 v[192:195], a[232:235], v[88:91], v[192:195]
    v_mfma_f32_16x16x32_bf16 v[132:135], a[228:231], v[92:95], v[132:135]
    v_mfma_f32_16x16x32_bf16 v[192:195], a[236:239], v[92:95], v[192:195]
    s_waitcnt lgkmcnt(0)
    s_waitcnt vmcnt(16)
    s_barrier
    v_mfma_f32_16x16x32_bf16 v[136:139], a[224:227], v[64:67], v[136:139]
    ds_read_b128 a[240:243], v22 offset:0
    ds_read_b64_tr_b16 v[80:81], v28 offset:0
    v_mfma_f32_16x16x32_bf16 v[196:199], a[232:235], v[64:67], v[196:199]
    ds_read_b128 a[244:247], v23 offset:0
    ds_read_b64_tr_b16 v[82:83], v28 offset:1280
    v_mfma_f32_16x16x32_bf16 v[136:139], a[228:231], v[68:71], v[136:139]
    ds_read_b128 a[248:251], v22 offset:2048
    ds_read_b64_tr_b16 v[84:85], v28 offset:5120
    v_mfma_f32_16x16x32_bf16 v[196:199], a[236:239], v[68:71], v[196:199]
    ds_read_b128 a[252:255], v23 offset:2048
    ds_read_b64_tr_b16 v[86:87], v28 offset:6400
    v_mfma_f32_16x16x32_bf16 v[140:143], a[224:227], v[72:75], v[140:143]
    ds_read_b64_tr_b16 v[88:89], v28 offset:32
    ds_read_b64_tr_b16 v[64:65], v28 offset:64
    v_mfma_f32_16x16x32_bf16 v[200:203], a[232:235], v[72:75], v[200:203]
    ds_read_b64_tr_b16 v[90:91], v28 offset:1312
    ds_read_b64_tr_b16 v[66:67], v28 offset:1344
    v_mfma_f32_16x16x32_bf16 v[140:143], a[228:231], v[76:79], v[140:143]
    ds_read_b64_tr_b16 v[92:93], v28 offset:5152
    ds_read_b64_tr_b16 v[68:69], v28 offset:5184
    v_mfma_f32_16x16x32_bf16 v[200:203], a[236:239], v[76:79], v[200:203]
    ds_read_b64_tr_b16 v[94:95], v28 offset:6432
    ds_read_b64_tr_b16 v[70:71], v28 offset:6464
    s_waitcnt lgkmcnt(8)
    s_add_u32 s44, s44, 491520
    s_cmp_ge_u32 s44, 2457600
    s_cselect_b32 s3, 2457600, 0
    s_sub_u32 s44, s44, s3
    s_add_u32 m0, s34, 73728
    v_mfma_f32_16x16x32_bf16 v[104:107], a[240:243], v[80:83], v[104:107]
    ds_read_b64_tr_b16 v[72:73], v28 offset:96
    buffer_load_dwordx4 v10, s[8:11], s44 offen offset:0 lds
    v_mfma_f32_16x16x32_bf16 v[164:167], a[248:251], v[80:83], v[164:167]
    ds_read_b64_tr_b16 v[74:75], v28 offset:1376
    v_mfma_f32_16x16x32_bf16 v[104:107], a[244:247], v[84:87], v[104:107]
    ds_read_b64_tr_b16 v[76:77], v28 offset:5216
    buffer_load_dwordx4 v11, s[8:11], s44 offen offset:1024 lds
    v_mfma_f32_16x16x32_bf16 v[164:167], a[252:255], v[84:87], v[164:167]
    ds_read_b64_tr_b16 v[78:79], v28 offset:6496
    s_waitcnt lgkmcnt(5)
    v_mfma_f32_16x16x32_bf16 v[108:111], a[240:243], v[88:91], v[108:111]
    ds_read_b64_tr_b16 v[80:81], v28 offset:128
    buffer_load_dwordx4 v12, s[8:11], s44 offen offset:2048 lds
    v_mfma_f32_16x16x32_bf16 v[168:171], a[248:251], v[88:91], v[168:171]
    ds_read_b64_tr_b16 v[82:83], v28 offset:1408
    v_mfma_f32_16x16x32_bf16 v[108:111], a[244:247], v[92:95], v[108:111]
    ds_read_b64_tr_b16 v[84:85], v28 offset:5248
    buffer_load_dwordx4 v13, s[8:11], s44 offen offset:3072 lds
    v_mfma_f32_16x16x32_bf16 v[168:171], a[252:255], v[92:95], v[168:171]
    ds_read_b64_tr_b16 v[86:87], v28 offset:6528
    s_waitcnt lgkmcnt(8)
    s_add_u32 m0, s34, 77824
    v_mfma_f32_16x16x32_bf16 v[112:115], a[240:243], v[64:67], v[112:115]
    ds_read_b64_tr_b16 v[88:89], v28 offset:10240
    buffer_load_dwordx4 v14, s[8:11], s44 offen offset:0 lds
    v_mfma_f32_16x16x32_bf16 v[172:175], a[248:251], v[64:67], v[172:175]
    ds_read_b64_tr_b16 v[90:91], v28 offset:11520
    s_add_u32 s44, s44, 491520
    s_cmp_ge_u32 s44, 2457600
    s_cselect_b32 s3, 2457600, 0
    s_sub_u32 s44, s44, s3
    s_add_u32 m0, s34, 94208
    v_mfma_f32_16x16x32_bf16 v[112:115], a[244:247], v[68:71], v[112:115]
    ds_read_b64_tr_b16 v[92:93], v28 offset:15360
    buffer_load_dwordx4 v10, s[8:11], s44 offen offset:0 lds
    v_mfma_f32_16x16x32_bf16 v[172:175], a[252:255], v[68:71], v[172:175]
    ds_read_b64_tr_b16 v[94:95], v28 offset:16640
    s_waitcnt lgkmcnt(8)
    v_mfma_f32_16x16x32_bf16 v[116:119], a[240:243], v[72:75], v[116:119]
    ds_read_b64_tr_b16 v[64:65], v28 offset:10272
    buffer_load_dwordx4 v11, s[8:11], s44 offen offset:1024 lds
    v_mfma_f32_16x16x32_bf16 v[176:179], a[248:251], v[72:75], v[176:179]
    ds_read_b64_tr_b16 v[66:67], v28 offset:11552
    v_mfma_f32_16x16x32_bf16 v[116:119], a[244:247], v[76:79], v[116:119]
    ds_read_b64_tr_b16 v[68:69], v28 offset:15392
    buffer_load_dwordx4 v12, s[8:11], s44 offen offset:2048 lds
    v_mfma_f32_16x16x32_bf16 v[176:179], a[252:255], v[76:79], v[176:179]
    ds_read_b64_tr_b16 v[70:71], v28 offset:16672
    s_waitcnt lgkmcnt(8)
    v_mfma_f32_16x16x32_bf16 v[120:123], a[240:243], v[80:83], v[120:123]
    ds_read_b64_tr_b16 v[72:73], v28 offset:10304
    buffer_load_dwordx4 v13, s[8:11], s44 offen offset:3072 lds
    v_mfma_f32_16x16x32_bf16 v[180:183], a[248:251], v[80:83], v[180:183]
    ds_read_b64_tr_b16 v[74:75], v28 offset:11584
    s_add_u32 m0, s34, 98304
    v_mfma_f32_16x16x32_bf16 v[120:123], a[244:247], v[84:87], v[120:123]
    ds_read_b64_tr_b16 v[76:77], v28 offset:15424
    buffer_load_dwordx4 v14, s[8:11], s44 offen offset:0 lds
    v_mfma_f32_16x16x32_bf16 v[180:183], a[252:255], v[84:87], v[180:183]
    ds_read_b64_tr_b16 v[78:79], v28 offset:16704
    s_waitcnt lgkmcnt(8)
    v_mfma_f32_16x16x32_bf16 v[124:127], a[240:243], v[88:91], v[124:127]
    ds_read_b64_tr_b16 v[80:81], v28 offset:10336
    v_mfma_f32_16x16x32_bf16 v[184:187], a[248:251], v[88:91], v[184:187]
    ds_read_b64_tr_b16 v[82:83], v28 offset:11616
    v_mfma_f32_16x16x32_bf16 v[124:127], a[244:247], v[92:95], v[124:127]
    ds_read_b64_tr_b16 v[84:85], v28 offset:15456
    v_mfma_f32_16x16x32_bf16 v[184:187], a[252:255], v[92:95], v[184:187]
    ds_read_b64_tr_b16 v[86:87], v28 offset:16736
    s_waitcnt lgkmcnt(8)
    v_mfma_f32_16x16x32_bf16 v[128:131], a[240:243], v[64:67], v[128:131]
    ds_read_b64_tr_b16 v[88:89], v28 offset:10368
    v_mfma_f32_16x16x32_bf16 v[188:191], a[248:251], v[64:67], v[188:191]
    ds_read_b64_tr_b16 v[90:91], v28 offset:11648
    v_mfma_f32_16x16x32_bf16 v[128:131], a[244:247], v[68:71], v[128:131]
    ds_read_b64_tr_b16 v[92:93], v28 offset:15488
    v_mfma_f32_16x16x32_bf16 v[188:191], a[252:255], v[68:71], v[188:191]
    ds_read_b64_tr_b16 v[94:95], v28 offset:16768
    s_waitcnt lgkmcnt(8)
    v_mfma_f32_16x16x32_bf16 v[132:135], a[240:243], v[72:75], v[132:135]
    s_waitcnt vmcnt(10)
    v_pk_add_f32 v[32:33], v[32:33], v[34:35]
    v_pk_add_f32 v[36:37], v[36:37], v[38:39]
    v_pk_add_f32 v[40:41], v[40:41], v[42:43]
    v_pk_add_f32 v[44:45], v[44:45], v[46:47]
    v_mfma_f32_16x16x32_bf16 v[192:195], a[248:251], v[72:75], v[192:195]
    v_pk_add_f32 v[48:49], v[48:49], v[50:51]
    v_pk_add_f32 v[32:33], v[32:33], v[36:37]
    v_pk_add_f32 v[40:41], v[40:41], v[44:45]
    v_pk_add_f32 v[32:33], v[32:33], v[48:49]
    v_pk_add_f32 v[32:33], v[32:33], v[40:41]
    v_mfma_f32_16x16x32_bf16 v[132:135], a[244:247], v[76:79], v[132:135]
    ds_write_b64 v31, v[32:33]
    v_pk_add_f32 v[244:245], v[244:245], v[246:247]
    v_pk_add_f32 v[248:249], v[248:249], v[250:251]
    v_pk_add_f32 v[244:245], v[244:245], v[252:253]
    v_pk_add_f32 v[244:245], v[244:245], v[248:249]
    v_mfma_f32_16x16x32_bf16 v[192:195], a[252:255], v[76:79], v[192:195]
    v_mov_b32 v246, v244
    v_mov_b32 v247, v245
    s_nop 0
    v_permlane32_swap_b32 v244, v246
    v_permlane32_swap_b32 v245, v247
    v_add_f32 v248, v244, v246
    s_waitcnt lgkmcnt(5)
    v_mfma_f32_16x16x32_bf16 v[136:139], a[240:243], v[80:83], v[136:139]
    v_add_f32 v249, v245, v247
    v_mul_f32 v248, 0x3acccccd, v248
    v_mul_f32 v249, 0x3acccccd, v249
    v_fma_f32 v249, -v248, v248, v249
    v_max_f32 v249, 0, v249
    v_mfma_f32_16x16x32_bf16 v[196:199], a[248:251], v[80:83], v[196:199]
    v_cvt_pk_bf16_f32 v250, v248, v249
    v_and_b32 v244, 0xffff0000, v250
    v_lshlrev_b32 v250, 16, v250
    v_add_f32 v244, 0x3727c5ac, v244
    v_cvt_pk_bf16_f32 v244, v244, v244
    v_mfma_f32_16x16x32_bf16 v[136:139], a[244:247], v[84:87], v[136:139]
    v_lshlrev_b32 v244, 16, v244
    v_sqrt_f32 v244, v244
    s_nop 0
    v_cvt_pk_bf16_f32 v244, v244, v244
    v_lshlrev_b32 v244, 16, v244
    v_rcp_f32 v244, v244
    v_mfma_f32_16x16x32_bf16 v[196:199], a[252:255], v[84:87], v[196:199]
    v_mul_f32 v246, -v250, v244
    v_lshlrev_b32 v24, 4, v2
    ds_bpermute_b32 v224, v24, v244 offset:0
    ds_bpermute_b32 v232, v24, v246 offset:0
    ds_bpermute_b32 v225, v24, v244 offset:4
    s_waitcnt lgkmcnt(4)
    v_mfma_f32_16x16x32_bf16 v[140:143], a[240:243], v[88:91], v[140:143]
    ds_bpermute_b32 v233, v24, v246 offset:4
    ds_bpermute_b32 v226, v24, v244 offset:8
    ds_bpermute_b32 v234, v24, v246 offset:8
    ds_bpermute_b32 v227, v24, v244 offset:12
    ds_bpermute_b32 v235, v24, v246 offset:12
    v_mfma_f32_16x16x32_bf16 v[200:203], a[248:251], v[88:91], v[200:203]
    ds_bpermute_b32 v228, v24, v244 offset:64
    ds_bpermute_b32 v236, v24, v246 offset:64
    ds_bpermute_b32 v229, v24, v244 offset:68
    ds_bpermute_b32 v237, v24, v246 offset:68
    ds_bpermute_b32 v230, v24, v244 offset:72
    v_mfma_f32_16x16x32_bf16 v[140:143], a[244:247], v[92:95], v[140:143]
    ds_bpermute_b32 v238, v24, v246 offset:72
    ds_bpermute_b32 v231, v24, v244 offset:76
    ds_bpermute_b32 v239, v24, v246 offset:76
    v_mov_b32 v240, v244
    v_mov_b32 v241, v244
    v_mfma_f32_16x16x32_bf16 v[200:203], a[252:255], v[92:95], v[200:203]
    v_mov_b32 v242, v246
    v_mov_b32 v243, v246
    v_permlane16_swap_b32 v240, v241
    s_nop 0
    v_permlane16_swap_b32 v242, v243
    s_waitcnt lgkmcnt(0)
    s_barrier
    s_add_u32 s12, s24, 0x01000000
    s_addc_u32 s13, s25, 0
    s_mov_b32 s14, 0x00280000
    s_mov_b32 s15, 0x00020000
    s_mul_i32 s36, s23, 20480
    s_lshr_b32 s37, s22, 1
    s_mul_i32 s37, s37, 5120
    s_add_u32 s36, s36, s37
    s_bitcmp1_b32 s22, 0
    s_cselect_b32 s37, 2048, 0
    s_add_u32 s38, s36, s37
    v_and_b32 v24, 31, v1
    v_min_u32 v24, 23, v24
    v_lshlrev_b32 v24, 7, v24
    v_lshrrev_b32 v25, 5, v1
    v_mul_u32_u24 v25, 20480, v25
    v_add_u32 v24, v24, v25
    buffer_load_dword a60, v24, s[12:15], s38 offen
    v_lshlrev_b32 v25, 2, v3
    v_add_u32 v25, 160768, v25
    ds_read_b32 v76, v25 offset:0
    ds_read_b32 v77, v25 offset:64
    ds_read_b32 v78, v25 offset:128
    ds_read_b32 v79, v25 offset:192
    ds_read_b32 v80, v25 offset:256
    ds_read_b32 v81, v25 offset:320
    ds_read_b32 v82, v25 offset:384
    ds_read_b32 v83, v25 offset:448
    ds_read_b32 v84, v25 offset:512
    ds_read_b32 v85, v25 offset:576
    s_mov_b32 s36, 0x3fb8aa3b
    s_mov_b32 s37, 0x3fb8aa3b
    v_mov_b32 v94, 0x358637bd
    v_mov_b32 v95, 0x358637bd
    v_mov_b32 v72, 0
    v_mov_b32 v73, 0
    v_mov_b32 v74, 0
    v_mov_b32 v75, 0
    v_lshlrev_b32 v24, 4, v0
    v_add_u32 v24, 55296, v24
    ds_write_b128 v24, v[72:75] offset:0
    ds_write_b128 v24, v[72:75] offset:4096
    ds_write_b128 v24, v[72:75] offset:8192
    ds_write_b128 v24, v[72:75] offset:12288
    ds_write_b128 v24, v[72:75] offset:14336
    s_mul_i32 s38, s20, 13824
    v_add_u32 v23, s38, v30
    v_lshl_add_u32 v22, v2, 4, s38
    s_waitcnt lgkmcnt(5)
    v_mov_b32 v72, 0x3f803f80
    v_mov_b32 v73, 0x3f803f80
    v_mov_b32 v74, 0x3f803f80
    v_mov_b32 v75, 0x3f803f80
    v_pk_fma_f32 v[86:87], v[232:233], v[76:77], v[94:95] op_sel:[0,0,0] op_sel_hi:[1,0,1]
    v_pk_fma_f32 v[88:89], v[234:235], v[76:77], v[94:95] op_sel:[0,0,0] op_sel_hi:[1,0,1]
    v_pk_fma_f32 v[104:105], v[104:105], v[224:225], v[86:87]
    v_pk_fma_f32 v[106:107], v[106:107], v[226:227], v[88:89]
    v_pk_mul_f32 v[86:87], v[104:105], s[36:37]
    v_pk_mul_f32 v[88:89], v[106:107], s[36:37]
    v_exp_f32 v86, v86 clamp
    v_exp_f32 v87, v87 clamp
    v_exp_f32 v88, v88 clamp
    v_exp_f32 v89, v89 clamp
    v_max_f32 v104, v104, v94
    v_max_f32 v105, v105, v94
    v_max_f32 v106, v106, v94
    v_max_f32 v107, v107, v94
    v_pk_add_f32 v[104:105], v[104:105], v[86:87]
    v_pk_add_f32 v[106:107], v[106:107], v[88:89]
    v_cvt_pk_bf16_f32 v32, v104, v105
    v_cvt_pk_bf16_f32 v33, v106, v107
    v_pk_fma_f32 v[90:91], v[236:237], v[76:77], v[94:95] op_sel:[0,0,0] op_sel_hi:[1,0,1]
    v_pk_fma_f32 v[92:93], v[238:239], v[76:77], v[94:95] op_sel:[0,0,0] op_sel_hi:[1,0,1]
    v_pk_fma_f32 v[164:165], v[164:165], v[228:229], v[90:91]
    v_pk_fma_f32 v[166:167], v[166:167], v[230:231], v[92:93]
    v_pk_mul_f32 v[90:91], v[164:165], s[36:37]
    v_pk_mul_f32 v[92:93], v[166:167], s[36:37]
    v_exp_f32 v90, v90 clamp
    v_exp_f32 v91, v91 clamp
    v_exp_f32 v92, v92 clamp
    v_exp_f32 v93, v93 clamp
    v_max_f32 v164, v164, v94
    v_max_f32 v165, v165, v94
    v_max_f32 v166, v166, v94
    v_max_f32 v167, v167, v94
    v_pk_add_f32 v[164:165], v[164:165], v[90:91]
    v_pk_add_f32 v[166:167], v[166:167], v[92:93]
    v_cvt_pk_bf16_f32 v34, v164, v165
    v_cvt_pk_bf16_f32 v35, v166, v167
    v_pk_mul_f32 v[86:87], v[232:233], v[80:81] op_sel:[0,1] op_sel_hi:[1,1]
    v_pk_mul_f32 v[88:89], v[234:235], v[80:81] op_sel:[0,1] op_sel_hi:[1,1]
    v_pk_fma_f32 v[124:125], v[124:125], v[224:225], v[86:87]
    v_pk_fma_f32 v[126:127], v[126:127], v[226:227], v[88:89]
    v_cvt_pk_bf16_f32 v52, v124, v125
    v_cvt_pk_bf16_f32 v53, v126, v127
    v_pk_mul_f32 v[90:91], v[236:237], v[80:81] op_sel:[0,1] op_sel_hi:[1,1]
    v_pk_mul_f32 v[92:93], v[238:239], v[80:81] op_sel:[0,1] op_sel_hi:[1,1]
    v_pk_fma_f32 v[184:185], v[184:185], v[228:229], v[90:91]
    v_pk_fma_f32 v[186:187], v[186:187], v[230:231], v[92:93]
    v_cvt_pk_bf16_f32 v54, v184, v185
    v_cvt_pk_bf16_f32 v55, v186, v187
    s_nop 1
    v_mfma_f32_16x16x32_bf16 v[104:107], v[32:35], v[52:55], 0
    v_mfma_f32_16x16x32_bf16 v[164:167], v[32:35], v[72:75], 0
    v_pk_fma_f32 v[86:87], v[232:233], v[76:77], v[94:95] op_sel:[0,1,0] op_sel_hi:[1,1,1]
    v_pk_fma_f32 v[88:89], v[234:235], v[76:77], v[94:95] op_sel:[0,1,0] op_sel_hi:[1,1,1]
    v_pk_fma_f32 v[108:109], v[108:109], v[224:225], v[86:87]
    v_pk_fma_f32 v[110:111], v[110:111], v[226:227], v[88:89]
    v_pk_mul_f32 v[86:87], v[108:109], s[36:37]
    v_pk_mul_f32 v[88:89], v[110:111], s[36:37]
    v_exp_f32 v86, v86 clamp
    v_exp_f32 v87, v87 clamp
    v_exp_f32 v88, v88 clamp
    v_exp_f32 v89, v89 clamp
    v_max_f32 v108, v108, v94
    v_max_f32 v109, v109, v94
    v_max_f32 v110, v110, v94
    v_max_f32 v111, v111, v94
    v_pk_add_f32 v[108:109], v[108:109], v[86:87]
    v_pk_add_f32 v[110:111], v[110:111], v[88:89]
    v_cvt_pk_bf16_f32 v36, v108, v109
    v_cvt_pk_bf16_f32 v37, v110, v111
    v_pk_fma_f32 v[90:91], v[236:237], v[76:77], v[94:95] op_sel:[0,1,0] op_sel_hi:[1,1,1]
    v_pk_fma_f32 v[92:93], v[238:239], v[76:77], v[94:95] op_sel:[0,1,0] op_sel_hi:[1,1,1]
    v_pk_fma_f32 v[168:169], v[168:169], v[228:229], v[90:91]
    v_pk_fma_f32 v[170:171], v[170:171], v[230:231], v[92:93]
    v_pk_mul_f32 v[90:91], v[168:169], s[36:37]
    v_pk_mul_f32 v[92:93], v[170:171], s[36:37]
    v_exp_f32 v90, v90 clamp
    v_exp_f32 v91, v91 clamp
    v_exp_f32 v92, v92 clamp
    v_exp_f32 v93, v93 clamp
    v_max_f32 v168, v168, v94
    v_max_f32 v169, v169, v94
    v_max_f32 v170, v170, v94
    v_max_f32 v171, v171, v94
    v_pk_add_f32 v[168:169], v[168:169], v[90:91]
    v_pk_add_f32 v[170:171], v[170:171], v[92:93]
    v_cvt_pk_bf16_f32 v38, v168, v169
    v_cvt_pk_bf16_f32 v39, v170, v171
    ds_write_b128 v23, v[104:107] offset:0
    v_pk_mul_f32 v[86:87], v[232:233], v[82:83] op_sel:[0,0] op_sel_hi:[1,0]
    v_pk_mul_f32 v[88:89], v[234:235], v[82:83] op_sel:[0,0] op_sel_hi:[1,0]
    v_pk_fma_f32 v[128:129], v[128:129], v[224:225], v[86:87]
    v_pk_fma_f32 v[130:131], v[130:131], v[226:227], v[88:89]
    v_cvt_pk_bf16_f32 v56, v128, v129
    v_cvt_pk_bf16_f32 v57, v130, v131
    v_pk_mul_f32 v[90:91], v[236:237], v[82:83] op_sel:[0,0] op_sel_hi:[1,0]
    v_pk_mul_f32 v[92:93], v[238:239], v[82:83] op_sel:[0,0] op_sel_hi:[1,0]
    v_pk_fma_f32 v[188:189], v[188:189], v[228:229], v[90:91]
    v_pk_fma_f32 v[190:191], v[190:191], v[230:231], v[92:93]
    v_cvt_pk_bf16_f32 v58, v188, v189
    v_cvt_pk_bf16_f32 v59, v190, v191
    s_nop 1
    v_mfma_f32_16x16x32_bf16 v[124:127], v[32:35], v[56:59], 0
    v_mfma_f32_16x16x32_bf16 v[184:187], v[36:39], v[52:55], 0
    v_mfma_f32_16x16x32_bf16 v[108:111], v[36:39], v[56:59], 0
    v_mfma_f32_16x16x32_bf16 v[168:171], v[36:39], v[72:75], 0
    v_pk_fma_f32 v[86:87], v[232:233], v[78:79], v[94:95] op_sel:[0,0,0] op_sel_hi:[1,0,1]
    v_pk_fma_f32 v[88:89], v[234:235], v[78:79], v[94:95] op_sel:[0,0,0] op_sel_hi:[1,0,1]
    v_pk_fma_f32 v[112:113], v[112:113], v[224:225], v[86:87]
    v_pk_fma_f32 v[114:115], v[114:115], v[226:227], v[88:89]
    v_pk_mul_f32 v[86:87], v[112:113], s[36:37]
    v_pk_mul_f32 v[88:89], v[114:115], s[36:37]
    v_exp_f32 v86, v86 clamp
    v_exp_f32 v87, v87 clamp
    v_exp_f32 v88, v88 clamp
    v_exp_f32 v89, v89 clamp
    v_max_f32 v112, v112, v94
    v_max_f32 v113, v113, v94
    v_max_f32 v114, v114, v94
    v_max_f32 v115, v115, v94
    v_pk_add_f32 v[112:113], v[112:113], v[86:87]
    v_pk_add_f32 v[114:115], v[114:115], v[88:89]
    v_cvt_pk_bf16_f32 v40, v112, v113
    v_cvt_pk_bf16_f32 v41, v114, v115
    ds_write_b128 v23, v[124:127] offset:1024
    ds_write_b128 v23, v[184:187] offset:2048
    v_pk_fma_f32 v[90:91], v[236:237], v[78:79], v[94:95] op_sel:[0,0,0] op_sel_hi:[1,0,1]
    v_pk_fma_f32 v[92:93], v[238:239], v[78:79], v[94:95] op_sel:[0,0,0] op_sel_hi:[1,0,1]
    v_pk_fma_f32 v[172:173], v[172:173], v[228:229], v[90:91]
    v_pk_fma_f32 v[174:175], v[174:175], v[230:231], v[92:93]
    v_pk_mul_f32 v[90:91], v[172:173], s[36:37]
    v_pk_mul_f32 v[92:93], v[174:175], s[36:37]
    v_exp_f32 v90, v90 clamp
    v_exp_f32 v91, v91 clamp
    v_exp_f32 v92, v92 clamp
    v_exp_f32 v93, v93 clamp
    v_max_f32 v172, v172, v94
    v_max_f32 v173, v173, v94
    v_max_f32 v174, v174, v94
    v_max_f32 v175, v175, v94
    v_pk_add_f32 v[172:173], v[172:173], v[90:91]
    v_pk_add_f32 v[174:175], v[174:175], v[92:93]
    v_cvt_pk_bf16_f32 v42, v172, v173
    v_cvt_pk_bf16_f32 v43, v174, v175
    ds_write_b128 v23, v[108:111] offset:3072
    v_pk_mul_f32 v[86:87], v[232:233], v[82:83] op_sel:[0,1] op_sel_hi:[1,1]
    v_pk_mul_f32 v[88:89], v[234:235], v[82:83] op_sel:[0,1] op_sel_hi:[1,1]
    v_pk_fma_f32 v[132:133], v[132:133], v[224:225], v[86:87]
    v_pk_fma_f32 v[134:135], v[134:135], v[226:227], v[88:89]
    v_cvt_pk_bf16_f32 v60, v132, v133
    v_cvt_pk_bf16_f32 v61, v134, v135
    v_pk_mul_f32 v[90:91], v[236:237], v[82:83] op_sel:[0,1] op_sel_hi:[1,1]
    v_pk_mul_f32 v[92:93], v[238:239], v[82:83] op_sel:[0,1] op_sel_hi:[1,1]
    v_pk_fma_f32 v[192:193], v[192:193], v[228:229], v[90:91]
    v_pk_fma_f32 v[194:195], v[194:195], v[230:231], v[92:93]
    v_cvt_pk_bf16_f32 v62, v192, v193
    v_cvt_pk_bf16_f32 v63, v194, v195
    s_nop 1
    v_mfma_f32_16x16x32_bf16 v[128:131], v[36:39], v[60:63], 0
    v_mfma_f32_16x16x32_bf16 v[188:191], v[40:43], v[56:59], 0
    v_mfma_f32_16x16x32_bf16 v[112:115], v[40:43], v[60:63], 0
    v_mfma_f32_16x16x32_bf16 v[172:175], v[40:43], v[72:75], 0
    v_pk_fma_f32 v[86:87], v[232:233], v[78:79], v[94:95] op_sel:[0,1,0] op_sel_hi:[1,1,1]
    v_pk_fma_f32 v[88:89], v[234:235], v[78:79], v[94:95] op_sel:[0,1,0] op_sel_hi:[1,1,1]
    v_pk_fma_f32 v[116:117], v[116:117], v[224:225], v[86:87]
    v_pk_fma_f32 v[118:119], v[118:119], v[226:227], v[88:89]
    v_pk_mul_f32 v[86:87], v[116:117], s[36:37]
    v_pk_mul_f32 v[88:89], v[118:119], s[36:37]
    v_exp_f32 v86, v86 clamp
    v_exp_f32 v87, v87 clamp
    v_exp_f32 v88, v88 clamp
    v_exp_f32 v89, v89 clamp
    v_max_f32 v116, v116, v94
    v_max_f32 v117, v117, v94
    v_max_f32 v118, v118, v94
    v_max_f32 v119, v119, v94
    v_pk_add_f32 v[116:117], v[116:117], v[86:87]
    v_pk_add_f32 v[118:119], v[118:119], v[88:89]
    v_cvt_pk_bf16_f32 v44, v116, v117
    v_cvt_pk_bf16_f32 v45, v118, v119
    ds_write_b128 v23, v[128:131] offset:4096
    ds_write_b128 v23, v[188:191] offset:5120
    v_pk_fma_f32 v[90:91], v[236:237], v[78:79], v[94:95] op_sel:[0,1,0] op_sel_hi:[1,1,1]
    v_pk_fma_f32 v[92:93], v[238:239], v[78:79], v[94:95] op_sel:[0,1,0] op_sel_hi:[1,1,1]
    v_pk_fma_f32 v[176:177], v[176:177], v[228:229], v[90:91]
    v_pk_fma_f32 v[178:179], v[178:179], v[230:231], v[92:93]
    v_pk_mul_f32 v[90:91], v[176:177], s[36:37]
    v_pk_mul_f32 v[92:93], v[178:179], s[36:37]
    v_exp_f32 v90, v90 clamp
    v_exp_f32 v91, v91 clamp
    v_exp_f32 v92, v92 clamp
    v_exp_f32 v93, v93 clamp
    v_max_f32 v176, v176, v94
    v_max_f32 v177, v177, v94
    v_max_f32 v178, v178, v94
    v_max_f32 v179, v179, v94
    v_pk_add_f32 v[176:177], v[176:177], v[90:91]
    v_pk_add_f32 v[178:179], v[178:179], v[92:93]
    v_cvt_pk_bf16_f32 v46, v176, v177
    v_cvt_pk_bf16_f32 v47, v178, v179
    ds_write_b128 v23, v[112:115] offset:6144
    v_pk_mul_f32 v[86:87], v[232:233], v[84:85] op_sel:[0,0] op_sel_hi:[1,0]
    v_pk_mul_f32 v[88:89], v[234:235], v[84:85] op_sel:[0,0] op_sel_hi:[1,0]
    v_pk_fma_f32 v[136:137], v[136:137], v[224:225], v[86:87]
    v_pk_fma_f32 v[138:139], v[138:139], v[226:227], v[88:89]
    v_cvt_pk_bf16_f32 v64, v136, v137
    v_cvt_pk_bf16_f32 v65, v138, v139
    v_pk_mul_f32 v[90:91], v[236:237], v[84:85] op_sel:[0,0] op_sel_hi:[1,0]
    v_pk_mul_f32 v[92:93], v[238:239], v[84:85] op_sel:[0,0] op_sel_hi:[1,0]
    v_pk_fma_f32 v[196:197], v[196:197], v[228:229], v[90:91]
    v_pk_fma_f32 v[198:199], v[198:199], v[230:231], v[92:93]
    v_cvt_pk_bf16_f32 v66, v196, v197
    v_cvt_pk_bf16_f32 v67, v198, v199
    s_nop 1
    v_mfma_f32_16x16x32_bf16 v[132:135], v[40:43], v[64:67], 0
    v_mfma_f32_16x16x32_bf16 v[192:195], v[44:47], v[60:63], 0
    v_mfma_f32_16x16x32_bf16 v[116:119], v[44:47], v[64:67], 0
    v_mfma_f32_16x16x32_bf16 v[176:179], v[44:47], v[72:75], 0
    v_pk_fma_f32 v[86:87], v[232:233], v[80:81], v[94:95] op_sel:[0,0,0] op_sel_hi:[1,0,1]
    v_pk_fma_f32 v[88:89], v[234:235], v[80:81], v[94:95] op_sel:[0,0,0] op_sel_hi:[1,0,1]
    v_pk_fma_f32 v[120:121], v[120:121], v[224:225], v[86:87]
    v_pk_fma_f32 v[122:123], v[122:123], v[226:227], v[88:89]
    v_pk_mul_f32 v[86:87], v[120:121], s[36:37]
    v_pk_mul_f32 v[88:89], v[122:123], s[36:37]
    v_exp_f32 v86, v86 clamp
    v_exp_f32 v87, v87 clamp
    v_exp_f32 v88, v88 clamp
    v_exp_f32 v89, v89 clamp
    v_max_f32 v120, v120, v94
    v_max_f32 v121, v121, v94
    v_max_f32 v122, v122, v94
    v_max_f32 v123, v123, v94
    v_pk_add_f32 v[120:121], v[120:121], v[86:87]
    v_pk_add_f32 v[122:123], v[122:123], v[88:89]
    v_cvt_pk_bf16_f32 v48, v120, v121
    v_cvt_pk_bf16_f32 v49, v122, v123
    ds_write_b128 v23, v[132:135] offset:7168
    ds_write_b128 v23, v[192:195] offset:8192
    v_pk_fma_f32 v[90:91], v[236:237], v[80:81], v[94:95] op_sel:[0,0,0] op_sel_hi:[1,0,1]
    v_pk_fma_f32 v[92:93], v[238:239], v[80:81], v[94:95] op_sel:[0,0,0] op_sel_hi:[1,0,1]
    v_pk_fma_f32 v[180:181], v[180:181], v[228:229], v[90:91]
    v_pk_fma_f32 v[182:183], v[182:183], v[230:231], v[92:93]
    v_pk_mul_f32 v[90:91], v[180:181], s[36:37]
    v_pk_mul_f32 v[92:93], v[182:183], s[36:37]
    v_exp_f32 v90, v90 clamp
    v_exp_f32 v91, v91 clamp
    v_exp_f32 v92, v92 clamp
    v_exp_f32 v93, v93 clamp
    v_max_f32 v180, v180, v94
    v_max_f32 v181, v181, v94
    v_max_f32 v182, v182, v94
    v_max_f32 v183, v183, v94
    v_pk_add_f32 v[180:181], v[180:181], v[90:91]
    v_pk_add_f32 v[182:183], v[182:183], v[92:93]
    v_cvt_pk_bf16_f32 v50, v180, v181
    v_cvt_pk_bf16_f32 v51, v182, v183
    ds_write_b128 v23, v[116:119] offset:9216
    v_pk_mul_f32 v[86:87], v[232:233], v[84:85] op_sel:[0,1] op_sel_hi:[1,1]
    v_pk_mul_f32 v[88:89], v[234:235], v[84:85] op_sel:[0,1] op_sel_hi:[1,1]
    v_pk_fma_f32 v[140:141], v[140:141], v[224:225], v[86:87]
    v_pk_fma_f32 v[142:143], v[142:143], v[226:227], v[88:89]
    v_cvt_pk_bf16_f32 v68, v140, v141
    v_cvt_pk_bf16_f32 v69, v142, v143
    v_pk_mul_f32 v[90:91], v[236:237], v[84:85] op_sel:[0,1] op_sel_hi:[1,1]
    v_pk_mul_f32 v[92:93], v[238:239], v[84:85] op_sel:[0,1] op_sel_hi:[1,1]
    v_pk_fma_f32 v[200:201], v[200:201], v[228:229], v[90:91]
    v_pk_fma_f32 v[202:203], v[202:203], v[230:231], v[92:93]
    v_cvt_pk_bf16_f32 v70, v200, v201
    v_cvt_pk_bf16_f32 v71, v202, v203
    s_nop 1
    v_mfma_f32_16x16x32_bf16 v[136:139], v[44:47], v[68:71], 0
    v_mfma_f32_16x16x32_bf16 v[196:199], v[48:51], v[64:67], 0
    v_mfma_f32_16x16x32_bf16 v[120:123], v[48:51], v[68:71], 0
    v_mfma_f32_16x16x32_bf16 v[180:183], v[48:51], v[72:75], 0
    s_lshl_b32 s39, s22, 13
    v_lshlrev_b32 v26, 2, v0
    v_add_u32 v27, 4096, v26
    v_mov_b32 v24, 0x7fff0000
    v_cmp_lt_u32 vcc, 163, v0
    s_nop 1
    v_cndmask_b32 v27, v27, v24, vcc
    ds_write_b128 v23, v[136:139] offset:10240
    ds_write_b128 v23, v[196:199] offset:11264
    ds_write_b128 v23, v[120:123] offset:12288
    s_mov_b32 exec_lo, 0x00010001
    s_mov_b32 exec_hi, 0x00010001
    ds_write_b128 v22, v[164:167] offset:13312
    ds_write_b128 v22, v[168:171] offset:13376
    ds_write_b128 v22, v[172:175] offset:13440
    ds_write_b128 v22, v[176:179] offset:13504
    ds_write_b128 v22, v[180:183] offset:13568
    s_mov_b64 exec, -1
    s_waitcnt lgkmcnt(0)
    s_barrier
    ds_read_b128 v[32:35], v97 offset:0
    ds_read_b128 v[36:39], v97 offset:13824
    ds_read_b128 v[40:43], v97 offset:27648
    ds_read_b128 v[44:47], v97 offset:41472
    ds_read_b128 v[48:51], v98 offset:0
    ds_read_b128 v[52:55], v98 offset:13824
    ds_read_b128 v[56:59], v98 offset:27648
    ds_read_b128 v[60:63], v98 offset:41472
    s_waitcnt lgkmcnt(4)
    ds_read_b64_tr_b16 v[64:65], v96 offset:46080
    ds_read_b64_tr_b16 v[66:67], v96 offset:47360
    ds_read_b64_tr_b16 v[68:69], v96 offset:51200
    ds_read_b64_tr_b16 v[70:71], v96 offset:52480
    v_pk_add_f32 v[32:33], v[32:33], v[36:37]
    v_pk_add_f32 v[34:35], v[34:35], v[38:39]
    v_pk_add_f32 v[40:41], v[40:41], v[44:45]
    v_pk_add_f32 v[42:43], v[42:43], v[46:47]
    v_pk_add_f32 v[32:33], v[32:33], v[40:41]
    v_pk_add_f32 v[34:35], v[34:35], v[42:43]
    buffer_atomic_add_f32 v32, v26, s[16:19], s39 offen offset:0 sc1
    buffer_atomic_add_f32 v33, v26, s[16:19], s39 offen offset:1024 sc1
    buffer_atomic_add_f32 v34, v26, s[16:19], s39 offen offset:2048 sc1
    buffer_atomic_add_f32 v35, v26, s[16:19], s39 offen offset:3072 sc1
    s_waitcnt lgkmcnt(4)
    v_pk_add_f32 v[48:49], v[48:49], v[52:53]
    v_pk_add_f32 v[50:51], v[50:51], v[54:55]
    v_pk_add_f32 v[56:57], v[56:57], v[60:61]
    v_pk_add_f32 v[58:59], v[58:59], v[62:63]
    v_pk_add_f32 v[48:49], v[48:49], v[56:57]
    v_pk_add_f32 v[50:51], v[50:51], v[58:59]
    buffer_atomic_add_f32 v48, v27, s[16:19], s39 offen offset:0 sc1
    buffer_atomic_add_f32 v49, v27, s[16:19], s39 offen offset:1024 sc1
    buffer_atomic_add_f32 v50, v27, s[16:19], s39 offen offset:2048 sc1
    buffer_atomic_add_f32 v51, v27, s[16:19], s39 offen offset:3072 sc1
    ds_read_b64_tr_b16 v[72:73], v96 offset:46112
    ds_read_b64_tr_b16 v[74:75], v96 offset:47392
    ds_read_b64_tr_b16 v[76:77], v96 offset:51232
    ds_read_b64_tr_b16 v[78:79], v96 offset:52512
    ds_read_b64_tr_b16 v[80:81], v96 offset:46144
    ds_read_b64_tr_b16 v[82:83], v96 offset:47424
    ds_read_b64_tr_b16 v[84:85], v96 offset:51264
    ds_read_b64_tr_b16 v[86:87], v96 offset:52544
    s_waitcnt lgkmcnt(8)
    v_mfma_f32_16x16x32_bf16 v[144:147], v[64:67], a[96:99], 0
    ds_read_b64_tr_b16 v[88:89], v96 offset:46176
    v_lshlrev_b32 v15, 7, v3
    s_lshl_b32 s52, s22, 11
    v_mfma_f32_16x16x32_bf16 v[204:207], v[64:67], a[104:107], 0
    ds_read_b64_tr_b16 v[90:91], v96 offset:47456
    s_add_u32 s52, s52, 65536
    s_mul_i32 s32, s61, 348160
    v_mfma_f32_16x16x32_bf16 v[144:147], v[68:71], a[100:103], v[144:147]
    ds_read_b64_tr_b16 v[92:93], v96 offset:51296
    s_mul_i32 s53, s20, 5120
    s_add_u32 s32, s32, s53
    v_mfma_f32_16x16x32_bf16 v[204:207], v[68:71], a[108:111], v[204:207]
    ds_read_b64_tr_b16 v[94:95], v96 offset:52576
    s_add_u32 s32, s32, 245760
    v_add_u32 v29, s32, v30
    s_waitcnt lgkmcnt(8)
    v_mfma_f32_16x16x32_bf16 v[148:151], v[72:75], a[96:99], 0
    ds_read_b64_tr_b16 v[64:65], v96 offset:46208
    s_lshl_b32 s47, s20, 10
    s_lshl_b32 s46, s20, 12
    v_mfma_f32_16x16x32_bf16 v[208:211], v[72:75], a[104:107], 0
    ds_read_b64_tr_b16 v[66:67], v96 offset:47488
    s_sub_u32 s46, 20480, s46
    s_sub_u32 s56, 24576, s53
    v_mfma_f32_16x16x32_bf16 v[148:151], v[76:79], a[100:103], v[148:151]
    ds_read_b64_tr_b16 v[68:69], v96 offset:51328
    s_lshl_b32 s32, s20, 4
    s_lshl_b64 s[36:37], 0xffff, s32
    v_mfma_f32_16x16x32_bf16 v[208:211], v[76:79], a[108:111], v[208:211]
    ds_read_b64_tr_b16 v[70:71], v96 offset:52608
    s_mul_i32 s32, s20, 105
    s_mul_i32 s33, s20, 5
    s_waitcnt lgkmcnt(8)
    v_mfma_f32_16x16x32_bf16 v[152:155], v[80:83], a[96:99], 0
    ds_read_b64_tr_b16 v[72:73], v96 offset:56320
    s_mul_i32 s35, s20, 20
    s_mov_b32 s98, 0
PL_22:
    v_cmp_ne_u32 vcc, 1, v18
    s_cbranch_vccz PD_23
    s_add_u32 s98, s98, 1
    s_cmp_ge_u32 s98, 0x40000
    s_cbranch_scc1 PD_23
    s_sleep 4
    buffer_load_dword v18, v19, s[80:83], s48 offen sc1
    s_waitcnt vmcnt(0)
    s_branch PL_22
PD_23:
    v_mfma_f32_16x16x32_bf16 v[212:215], v[80:83], a[104:107], 0
    ds_read_b64_tr_b16 v[74:75], v96 offset:57600
    v_mov_b32 v244, v1
    v_mul_u32_u24 v245, 52429, v244
    v_mfma_f32_16x16x32_bf16 v[152:155], v[84:87], a[100:103], v[152:155]
    ds_read_b64_tr_b16 v[76:77], v96 offset:61440
    v_lshrrev_b32 v245, 20, v245
    v_mul_u32_u24 v246, 20, v245
    v_mfma_f32_16x16x32_bf16 v[212:215], v[84:87], a[108:111], v[212:215]
    ds_read_b64_tr_b16 v[78:79], v96 offset:62720
    v_sub_u32 v246, v244, v246
    v_add_u32 v247, s35, v246
    s_waitcnt lgkmcnt(8)
    v_mfma_f32_16x16x32_bf16 v[156:159], v[88:91], a[96:99], 0
    ds_read_b64_tr_b16 v[80:81], v96 offset:56352
    v_mul_u32_u24 v18, 21, v245
    v_add3_u32 v18, v18, v246, s32
    v_mfma_f32_16x16x32_bf16 v[216:219], v[88:91], a[104:107], 0
    ds_read_b64_tr_b16 v[82:83], v96 offset:57632
    v_lshrrev_b32 v244, 8, v18
    v_and_b32 v18, 255, v18
    v_mfma_f32_16x16x32_bf16 v[156:159], v[92:95], a[100:103], v[156:159]
    ds_read_b64_tr_b16 v[84:85], v96 offset:61472
    v_lshlrev_b32 v18, 2, v18
    v_lshl_add_u32 v18, v244, 12, v18
    v_mfma_f32_16x16x32_bf16 v[216:219], v[92:95], a[108:111], v[216:219]
    ds_read_b64_tr_b16 v[86:87], v96 offset:62752
    v_add_u32 v245, s33, v245
    v_lshrrev_b32 v20, 4, v247
    s_waitcnt lgkmcnt(8)
    v_mfma_f32_16x16x32_bf16 v[160:163], v[64:67], a[96:99], 0
    ds_read_b64_tr_b16 v[88:89], v96 offset:56384
    v_mul_u32_u24 v20, 3, v20
    v_lshrrev_b32 v244, 3, v245
    v_mfma_f32_16x16x32_bf16 v[220:223], v[64:67], a[104:107], 0
    ds_read_b64_tr_b16 v[90:91], v96 offset:57664
    v_add_u32 v20, v20, v244
    v_lshlrev_b32 v20, 10, v20
    v_mfma_f32_16x16x32_bf16 v[160:163], v[68:71], a[100:103], v[160:163]
    ds_read_b64_tr_b16 v[92:93], v96 offset:61504
    v_and_b32 v244, 3, v245
    v_lshl_add_u32 v20, v244, 8, v20
    v_mfma_f32_16x16x32_bf16 v[220:223], v[68:71], a[108:111], v[220:223]
    ds_read_b64_tr_b16 v[94:95], v96 offset:62784
    v_and_b32 v244, 15, v247
    v_lshl_add_u32 v20, v244, 4, v20
    s_waitcnt lgkmcnt(8)
    v_mfma_f32_16x16x32_bf16 v[144:147], v[72:75], a[112:115], v[144:147]
    ds_read_b64_tr_b16 v[64:65], v96 offset:56416
    v_bfe_u32 v244, v245, 2, 1
    v_lshl_add_u32 v20, v244, 3, v20
    v_mfma_f32_16x16x32_bf16 v[204:207], v[72:75], a[120:123], v[204:207]
    ds_read_b64_tr_b16 v[66:67], v96 offset:57696
    v_add_u32 v20, 55296, v20
    v_add_u32 v244, 64, v1
    v_mfma_f32_16x16x32_bf16 v[144:147], v[76:79], a[116:119], v[144:147]
    ds_read_b64_tr_b16 v[68:69], v96 offset:61536
    v_min_u32 v244, 119, v244
    v_mul_u32_u24 v245, 52429, v244
    v_mfma_f32_16x16x32_bf16 v[204:207], v[76:79], a[124:127], v[204:207]
    ds_read_b64_tr_b16 v[70:71], v96 offset:62816
    v_lshrrev_b32 v245, 20, v245
    v_mul_u32_u24 v246, 20, v245
    s_waitcnt lgkmcnt(8)
    v_mfma_f32_16x16x32_bf16 v[148:151], v[80:83], a[112:115], v[148:151]
    ds_read_b64_tr_b16 v[72:73], v96 offset:56448
    v_sub_u32 v246, v244, v246
    v_add_u32 v247, s35, v246
    v_mfma_f32_16x16x32_bf16 v[208:211], v[80:83], a[120:123], v[208:211]
    ds_read_b64_tr_b16 v[74:75], v96 offset:57728
    v_cmp_lt_u32 vcc, 99, v244
    v_lshrrev_b32 v248, 2, v246
    v_mfma_f32_16x16x32_bf16 v[148:151], v[84:87], a[116:119], v[148:151]
    ds_read_b64_tr_b16 v[76:77], v96 offset:61568
    v_cndmask_b32 v245, v245, v248, vcc
    v_and_b32 v248, 3, v246
    v_mfma_f32_16x16x32_bf16 v[208:211], v[84:87], a[124:127], v[208:211]
    ds_read_b64_tr_b16 v[78:79], v96 offset:62848
    v_lshlrev_b32 v248, 2, v248
    v_add3_u32 v248, v248, s20, 64
    s_waitcnt lgkmcnt(8)
    v_mfma_f32_16x16x32_bf16 v[152:155], v[88:91], a[112:115], v[152:155]
    ds_read_b64_tr_b16 v[80:81], v99 offset:0
    v_add_u32 v248, 16, v248
    v_cndmask_b32 v247, v247, v248, vcc
    v_mfma_f32_16x16x32_bf16 v[212:215], v[88:91], a[120:123], v[212:215]
    ds_read_b64_tr_b16 v[82:83], v99 offset:1280
    v_cndmask_b32 v246, v246, 20, vcc
    v_mul_u32_u24 v19, 21, v245
    v_mfma_f32_16x16x32_bf16 v[152:155], v[92:95], a[116:119], v[152:155]
    ds_read_b64_tr_b16 v[84:85], v99 offset:5120
    v_add3_u32 v19, v19, v246, s32
    v_lshrrev_b32 v244, 8, v19
    v_mfma_f32_16x16x32_bf16 v[212:215], v[92:95], a[124:127], v[212:215]
    ds_read_b64_tr_b16 v[86:87], v99 offset:6400
    v_and_b32 v19, 255, v19
    v_lshlrev_b32 v19, 2, v19
    s_waitcnt lgkmcnt(8)
    v_mfma_f32_16x16x32_bf16 v[156:159], v[64:67], a[112:115], v[156:159]
    ds_read_b64_tr_b16 v[88:89], v99 offset:32
    v_lshl_add_u32 v19, v244, 12, v19
    v_add_u32 v245, s33, v245
    v_mfma_f32_16x16x32_bf16 v[216:219], v[64:67], a[120:123], v[216:219]
    ds_read_b64_tr_b16 v[90:91], v99 offset:1312
    v_lshrrev_b32 v21, 4, v247
    v_mul_u32_u24 v21, 3, v21
    v_mfma_f32_16x16x32_bf16 v[156:159], v[68:71], a[116:119], v[156:159]
    ds_read_b64_tr_b16 v[92:93], v99 offset:5152
    v_lshrrev_b32 v244, 3, v245
    v_add_u32 v21, v21, v244
    v_mfma_f32_16x16x32_bf16 v[216:219], v[68:71], a[124:127], v[216:219]
    ds_read_b64_tr_b16 v[94:95], v99 offset:6432
    v_lshlrev_b32 v21, 10, v21
    v_and_b32 v244, 3, v245
    s_waitcnt lgkmcnt(8)
    v_mfma_f32_16x16x32_bf16 v[160:163], v[72:75], a[112:115], v[160:163]
    ds_read_b64_tr_b16 v[64:65], v99 offset:64
    v_lshl_add_u32 v21, v244, 8, v21
    v_and_b32 v244, 15, v247
    v_mfma_f32_16x16x32_bf16 v[220:223], v[72:75], a[120:123], v[220:223]
    ds_read_b64_tr_b16 v[66:67], v99 offset:1344
    v_lshl_add_u32 v21, v244, 4, v21
    v_bfe_u32 v244, v245, 2, 1
    v_mfma_f32_16x16x32_bf16 v[160:163], v[76:79], a[116:119], v[160:163]
    ds_read_b64_tr_b16 v[68:69], v99 offset:5184
    v_lshl_add_u32 v21, v244, 3, v21
    v_add_u32 v21, 55296, v21
    v_mfma_f32_16x16x32_bf16 v[220:223], v[76:79], a[124:127], v[220:223]
    ds_read_b64_tr_b16 v[70:71], v99 offset:6464
    s_add_u32 s12, s76, 0x00d80000
    s_addc_u32 s13, s77, 0
    s_mov_b32 s14, 0x000d4000
    s_mov_b32 s15, 0x00020000
    s_mov_b32 s49, 0
    s_waitcnt vmcnt(0)
    s_barrier
    s_cmp_lg_u32 s20, 0
    s_cbranch_scc1 W0_24
    v_mov_b32 v24, 1
    s_mov_b64 exec, 1
    buffer_store_dword v24, off, s[80:83], s58 sc1
    s_mov_b64 exec, -1
W0_24:
    s_add_u32 s44, s44, 491520
    s_cmp_ge_u32 s44, 2457600
    s_cselect_b32 s3, 2457600, 0
    s_sub_u32 s44, s44, s3
    s_add_u32 m0, s34, 0
    s_nop 0
    buffer_load_dwordx4 v10, s[8:11], s44 offen offset:0 lds
    buffer_load_dwordx4 v11, s[8:11], s44 offen offset:1024 lds
    buffer_load_dwordx4 v12, s[8:11], s44 offen offset:2048 lds
    buffer_load_dwordx4 v13, s[8:11], s44 offen offset:3072 lds
    s_add_u32 m0, s34, 4096
    s_nop 0
    buffer_load_dwordx4 v14, s[8:11], s44 offen offset:0 lds
    s_waitcnt lgkmcnt(8)
    v_mfma_f32_16x16x32_bf16 v[144:147], v[80:83], a[128:131], v[144:147]
    ds_read_b64_tr_b16 v[72:73], v99 offset:96
    s_add_u32 s8, s76, 0x01000000
    s_addc_u32 s9, s77, 0
    v_mfma_f32_16x16x32_bf16 v[204:207], v[80:83], a[136:139], v[204:207]
    ds_read_b64_tr_b16 v[74:75], v99 offset:1376
    s_mov_b32 s10, 0x00280000
    s_mov_b32 s11, 0x00020000
    v_mfma_f32_16x16x32_bf16 v[144:147], v[84:87], a[132:135], v[144:147]
    ds_read_b64_tr_b16 v[76:77], v99 offset:5216
    s_add_u32 s16, s76, 0x00500000
    s_addc_u32 s17, s77, 0
    v_mfma_f32_16x16x32_bf16 v[204:207], v[84:87], a[140:143], v[204:207]
    ds_read_b64_tr_b16 v[78:79], v99 offset:6496
    s_mov_b32 s18, 0x00280000
    s_mov_b32 s19, 0x00020000
    s_waitcnt lgkmcnt(8)
    v_mfma_f32_16x16x32_bf16 v[148:151], v[88:91], a[128:131], v[148:151]
    ds_read_b64_tr_b16 v[80:81], v99 offset:128
    s_mov_b32 s40, s72
    s_mov_b32 s41, s73
    v_mfma_f32_16x16x32_bf16 v[208:211], v[88:91], a[136:139], v[208:211]
    ds_read_b64_tr_b16 v[82:83], v99 offset:1408
    s_mov_b32 s42, 0x00280000
    s_mov_b32 s43, 0x00020000
    v_mfma_f32_16x16x32_bf16 v[148:151], v[92:95], a[132:135], v[148:151]
    ds_read_b64_tr_b16 v[84:85], v99 offset:5248
    s_and_b32 s34, s57, 0xffffffe0
    v_and_b32 v17, 7, v1
    v_mfma_f32_16x16x32_bf16 v[208:211], v[92:95], a[140:143], v[208:211]
    ds_read_b64_tr_b16 v[86:87], v99 offset:6528
    v_lshl_add_u32 v17, v17, 2, s34
    s_add_u32 s34, s57, 32
    s_waitcnt lgkmcnt(8)
    v_mfma_f32_16x16x32_bf16 v[152:155], v[64:67], a[128:131], v[152:155]
    ds_read_b64_tr_b16 v[88:89], v99 offset:10240
    v_mov_b32 v16, s34
    v_cmp_lt_u32 vcc, 7, v1
    v_mfma_f32_16x16x32_bf16 v[212:215], v[64:67], a[136:139], v[212:215]
    ds_read_b64_tr_b16 v[90:91], v99 offset:11520
    v_cndmask_b32 v17, v17, v16, vcc
    s_mul_i32 s32, s23, 20480
    v_mfma_f32_16x16x32_bf16 v[152:155], v[68:71], a[132:135], v[152:155]
    ds_read_b64_tr_b16 v[92:93], v99 offset:15360
    v_add_u32 v6, s32, v30
    v_add_u32 v7, 20480, v6
    v_mfma_f32_16x16x32_bf16 v[212:215], v[68:71], a[140:143], v[212:215]
    ds_read_b64_tr_b16 v[94:95], v99 offset:16640
    v_add_u32 v26, 4096, v6
    v_add_u32 v27, 4096, v7
    s_waitcnt lgkmcnt(8)
    v_mfma_f32_16x16x32_bf16 v[156:159], v[72:75], a[128:131], v[156:159]
    ds_read_b64_tr_b16 v[64:65], v99 offset:10272
    s_lshl_b32 s32, s21, 3
    s_add_u32 s32, s32, s61
    v_mfma_f32_16x16x32_bf16 v[216:219], v[72:75], a[136:139], v[216:219]
    ds_read_b64_tr_b16 v[66:67], v99 offset:11552
    s_lshl_b32 s32, s32, 2
    s_add_u32 s32, s32, s20
    v_mfma_f32_16x16x32_bf16 v[156:159], v[76:79], a[132:135], v[156:159]
    ds_read_b64_tr_b16 v[68:69], v99 offset:15392
    s_mul_i32 s32, s32, 5120
    v_add_u32 v8, s32, v30
    v_mfma_f32_16x16x32_bf16 v[216:219], v[76:79], a[140:143], v[216:219]
    ds_read_b64_tr_b16 v[70:71], v99 offset:16672
    v_add_u32 v9, 4096, v8
    s_mul_i32 s32, s61, 160
    s_waitcnt lgkmcnt(8)
    v_mfma_f32_16x16x32_bf16 v[160:163], v[80:83], a[128:131], v[160:163]
    ds_read_b64_tr_b16 v[72:73], v99 offset:10304
    s_lshl_b32 s33, s23, 4
    v_add_u32 v12, s33, v3
    v_mfma_f32_16x16x32_bf16 v[220:223], v[80:83], a[136:139], v[220:223]
    ds_read_b64_tr_b16 v[74:75], v99 offset:11584
    v_mul_u32_u24 v12, 1280, v12
    v_add_u32 v12, s32, v12
    v_mfma_f32_16x16x32_bf16 v[160:163], v[84:87], a[132:135], v[160:163]
    ds_read_b64_tr_b16 v[76:77], v99 offset:15424
    v_lshrrev_b32 v13, 1, v2
    v_lshl_add_u32 v12, v13, 4, v12
    v_mfma_f32_16x16x32_bf16 v[220:223], v[84:87], a[140:143], v[220:223]
    ds_read_b64_tr_b16 v[78:79], v99 offset:16704
    v_and_b32 v13, 1, v2
    v_mul_u32_u24 v14, 20480, v13
    s_waitcnt lgkmcnt(8)
    v_mfma_f32_16x16x32_bf16 v[144:147], v[88:91], a[144:147], v[144:147]
    ds_read_b64_tr_b16 v[80:81], v99 offset:10336
    v_add3_u32 v14, v14, v12, 64
    v_add_u32 v14, 64, v14
    v_mfma_f32_16x16x32_bf16 v[204:207], v[88:91], a[152:155], v[204:207]
    ds_read_b64_tr_b16 v[82:83], v99 offset:11616
    v_lshl_add_u32 v12, v13, 5, v12
    v_add_u32 v13, 20480, v12
    v_mfma_f32_16x16x32_bf16 v[144:147], v[92:95], a[148:151], v[144:147]
    ds_read_b64_tr_b16 v[84:85], v99 offset:15456
    s_mul_i32 s32, s23, 20480
    s_lshr_b32 s33, s22, 1
    v_mfma_f32_16x16x32_bf16 v[204:207], v[92:95], a[156:159], v[204:207]
    ds_read_b64_tr_b16 v[86:87], v99 offset:16736
    s_mul_i32 s33, s33, 5120
    s_add_u32 s32, s32, s33
    s_waitcnt lgkmcnt(8)
    v_mfma_f32_16x16x32_bf16 v[148:151], v[64:67], a[144:147], v[148:151]
    ds_read_b64_tr_b16 v[88:89], v99 offset:10368
    v_add_u32 v22, s32, v30
    v_add_u32 v23, 20480, v22
    v_mfma_f32_16x16x32_bf16 v[208:211], v[64:67], a[152:155], v[208:211]
    ds_read_b64_tr_b16 v[90:91], v99 offset:11648
    v_add_u32 v31, 55296, v30
    s_bitcmp1_b32 s22, 0
    s_cselect_b32 s54, 3072, 0
    s_cselect_b32 s55, 8, 0
    v_mfma_f32_16x16x32_bf16 v[148:151], v[68:71], a[148:151], v[148:151]
    ds_read_b64_tr_b16 v[92:93], v99 offset:15488
    v_cmp_gt_u32 s[92:93], 1, v2
    v_cmp_gt_u32 s[94:95], 2, v2
    v_mfma_f32_16x16x32_bf16 v[208:211], v[68:71], a[156:159], v[208:211]
    ds_read_b64_tr_b16 v[94:95], v99 offset:16768
    v_cmp_gt_u32 s[96:97], 3, v2
    v_lshlrev_b32 v24, 4, v2
    s_waitcnt lgkmcnt(8)
    v_mfma_f32_16x16x32_bf16 v[152:155], v[72:75], a[144:147], v[152:155]
    ds_read_b64_tr_b16 v[64:65], v96 offset:0
    v_add_u32 v24, 160768, v24
    v_mfma_f32_16x16x32_bf16 v[212:215], v[72:75], a[152:155], v[212:215]
    ds_read_b64_tr_b16 v[66:67], v96 offset:1280
    v_mfma_f32_16x16x32_bf16 v[152:155], v[76:79], a[148:151], v[152:155]
    ds_read_b64_tr_b16 v[68:69], v96 offset:5120
    v_mfma_f32_16x16x32_bf16 v[212:215], v[76:79], a[156:159], v[212:215]
    ds_read_b64_tr_b16 v[70:71], v96 offset:6400
    s_waitcnt lgkmcnt(8)
    v_mfma_f32_16x16x32_bf16 v[156:159], v[80:83], a[144:147], v[156:159]
    ds_read_b64_tr_b16 v[72:73], v96 offset:32
    buffer_load_dwordx4 a[0:3], v12, s[88:91], 0 offen offset:0
    v_mfma_f32_16x16x32_bf16 v[216:219], v[80:83], a[152:155], v[216:219]
    ds_read_b64_tr_b16 v[74:75], v96 offset:1312
    v_mfma_f32_16x16x32_bf16 v[156:159], v[84:87], a[148:151], v[156:159]
    ds_read_b64_tr_b16 v[76:77], v96 offset:5152
    buffer_load_dwordx4 a[4:7], v12, s[88:91], 0 offen offset:64
    v_mfma_f32_16x16x32_bf16 v[216:219], v[84:87], a[156:159], v[216:219]
    ds_read_b64_tr_b16 v[78:79], v96 offset:6432
    s_waitcnt lgkmcnt(8)
    v_mfma_f32_16x16x32_bf16 v[160:163], v[88:91], a[144:147], v[160:163]
    ds_read_b64_tr_b16 v[80:81], v96 offset:64
    buffer_load_dwordx4 a[8:11], v13, s[88:91], 0 offen offset:0
    v_mfma_f32_16x16x32_bf16 v[220:223], v[88:91], a[152:155], v[220:223]
    ds_read_b64_tr_b16 v[82:83], v96 offset:1344
    v_mfma_f32_16x16x32_bf16 v[160:163], v[92:95], a[148:151], v[160:163]
    ds_read_b64_tr_b16 v[84:85], v96 offset:5184
    buffer_load_dwordx4 a[12:15], v13, s[88:91], 0 offen offset:64
    v_mfma_f32_16x16x32_bf16 v[220:223], v[92:95], a[156:159], v[220:223]
    ds_read_b64_tr_b16 v[86:87], v96 offset:6464
    s_waitcnt lgkmcnt(8)
    v_mfma_f32_16x16x32_bf16 v[144:147], v[64:67], a[160:163], v[144:147]
    ds_read_b64_tr_b16 v[88:89], v96 offset:96
    buffer_load_dwordx4 a[16:19], v14, s[88:91], 0 offen offset:0
    v_mfma_f32_16x16x32_bf16 v[204:207], v[64:67], a[168:171], v[204:207]
    ds_read_b64_tr_b16 v[90:91], v96 offset:1376
    v_mfma_f32_16x16x32_bf16 v[144:147], v[68:71], a[164:167], v[144:147]
    ds_read_b64_tr_b16 v[92:93], v96 offset:5216
    v_mfma_f32_16x16x32_bf16 v[204:207], v[68:71], a[172:175], v[204:207]
    ds_read_b64_tr_b16 v[94:95], v96 offset:6496
    s_waitcnt lgkmcnt(8)
    v_mfma_f32_16x16x32_bf16 v[148:151], v[72:75], a[160:163], v[148:151]
    ds_read_b64_tr_b16 v[64:65], v96 offset:128
    v_mfma_f32_16x16x32_bf16 v[208:211], v[72:75], a[168:171], v[208:211]
    ds_read_b64_tr_b16 v[66:67], v96 offset:1408
    v_mfma_f32_16x16x32_bf16 v[148:151], v[76:79], a[164:167], v[148:151]
    ds_read_b64_tr_b16 v[68:69], v96 offset:5248
    v_mfma_f32_16x16x32_bf16 v[208:211], v[76:79], a[172:175], v[208:211]
    ds_read_b64_tr_b16 v[70:71], v96 offset:6528
    s_waitcnt lgkmcnt(8)
    v_mfma_f32_16x16x32_bf16 v[152:155], v[80:83], a[160:163], v[152:155]
    ds_read_b64_tr_b16 v[72:73], v96 offset:10240
    v_mfma_f32_16x16x32_bf16 v[212:215], v[80:83], a[168:171], v[212:215]
    ds_read_b64_tr_b16 v[74:75], v96 offset:11520
    v_mfma_f32_16x16x32_bf16 v[152:155], v[84:87], a[164:167], v[152:155]
    ds_read_b64_tr_b16 v[76:77], v96 offset:15360
    v_mfma_f32_16x16x32_bf16 v[212:215], v[84:87], a[172:175], v[212:215]
    ds_read_b64_tr_b16 v[78:79], v96 offset:16640
    s_waitcnt lgkmcnt(8)
    v_mfma_f32_16x16x32_bf16 v[156:159], v[88:91], a[160:163], v[156:159]
    ds_read_b64_tr_b16 v[80:81], v96 offset:10272
    v_mfma_f32_16x16x32_bf16 v[216:219], v[88:91], a[168:171], v[216:219]
    ds_read_b64_tr_b16 v[82:83], v96 offset:11552
    v_mfma_f32_16x16x32_bf16 v[156:159], v[92:95], a[164:167], v[156:159]
    ds_read_b64_tr_b16 v[84:85], v96 offset:15392
    v_mfma_f32_16x16x32_bf16 v[216:219], v[92:95], a[172:175], v[216:219]
    ds_read_b64_tr_b16 v[86:87], v96 offset:16672
    s_waitcnt lgkmcnt(8)
    v_mfma_f32_16x16x32_bf16 v[160:163], v[64:67], a[160:163], v[160:163]
    ds_read_b64_tr_b16 v[88:89], v96 offset:10304
    v_mfma_f32_16x16x32_bf16 v[220:223], v[64:67], a[168:171], v[220:223]
    ds_read_b64_tr_b16 v[90:91], v96 offset:11584
    v_mfma_f32_16x16x32_bf16 v[160:163], v[68:71], a[164:167], v[160:163]
    ds_read_b64_tr_b16 v[92:93], v96 offset:15424
    v_mfma_f32_16x16x32_bf16 v[220:223], v[68:71], a[172:175], v[220:223]
    ds_read_b64_tr_b16 v[94:95], v96 offset:16704
    s_waitcnt lgkmcnt(8)
    v_mfma_f32_16x16x32_bf16 v[144:147], v[72:75], a[176:179], v[144:147]
    ds_read_b64_tr_b16 v[64:65], v96 offset:10336
    v_mfma_f32_16x16x32_bf16 v[204:207], v[72:75], a[184:187], v[204:207]
    ds_read_b64_tr_b16 v[66:67], v96 offset:11616
    v_mfma_f32_16x16x32_bf16 v[144:147], v[76:79], a[180:183], v[144:147]
    ds_read_b64_tr_b16 v[68:69], v96 offset:15456
    v_mfma_f32_16x16x32_bf16 v[204:207], v[76:79], a[188:191], v[204:207]
    ds_read_b64_tr_b16 v[70:71], v96 offset:16736
    s_waitcnt lgkmcnt(8)
    v_mfma_f32_16x16x32_bf16 v[148:151], v[80:83], a[176:179], v[148:151]
    ds_read_b64_tr_b16 v[72:73], v96 offset:10368
    v_mfma_f32_16x16x32_bf16 v[208:211], v[80:83], a[184:187], v[208:211]
    ds_read_b64_tr_b16 v[74:75], v96 offset:11648
    v_mfma_f32_16x16x32_bf16 v[148:151], v[84:87], a[180:183], v[148:151]
    ds_read_b64_tr_b16 v[76:77], v96 offset:15488
    v_mfma_f32_16x16x32_bf16 v[208:211], v[84:87], a[188:191], v[208:211]
    ds_read_b64_tr_b16 v[78:79], v96 offset:16768
    s_waitcnt lgkmcnt(8)
    v_mfma_f32_16x16x32_bf16 v[152:155], v[88:91], a[176:179], v[152:155]
    ds_read_b64_tr_b16 v[80:81], v96 offset:20480
    v_mfma_f32_16x16x32_bf16 v[212:215], v[88:91], a[184:187], v[212:215]
    ds_read_b64_tr_b16 v[82:83], v96 offset:21760
    v_mfma_f32_16x16x32_bf16 v[152:155], v[92:95], a[180:183], v[152:155]
    ds_read_b64_tr_b16 v[84:85], v96 offset:25600
    v_mfma_f32_16x16x32_bf16 v[212:215], v[92:95], a[188:191], v[212:215]
    ds_read_b64_tr_b16 v[86:87], v96 offset:26880
    s_waitcnt lgkmcnt(8)
    v_mfma_f32_16x16x32_bf16 v[156:159], v[64:67], a[176:179], v[156:159]
    ds_read_b64_tr_b16 v[88:89], v96 offset:20512
    v_mfma_f32_16x16x32_bf16 v[216:219], v[64:67], a[184:187], v[216:219]
    ds_read_b64_tr_b16 v[90:91], v96 offset:21792
    v_mfma_f32_16x16x32_bf16 v[156:159], v[68:71], a[180:183], v[156:159]
    ds_read_b64_tr_b16 v[92:93], v96 offset:25632
    v_mfma_f32_16x16x32_bf16 v[216:219], v[68:71], a[188:191], v[216:219]
    ds_read_b64_tr_b16 v[94:95], v96 offset:26912
    s_waitcnt lgkmcnt(8)
    v_mfma_f32_16x16x32_bf16 v[160:163], v[72:75], a[176:179], v[160:163]
    ds_read_b64_tr_b16 v[64:65], v96 offset:20544
    v_mfma_f32_16x16x32_bf16 v[220:223], v[72:75], a[184:187], v[220:223]
    ds_read_b64_tr_b16 v[66:67], v96 offset:21824
    v_mfma_f32_16x16x32_bf16 v[160:163], v[76:79], a[180:183], v[160:163]
    ds_read_b64_tr_b16 v[68:69], v96 offset:25664
    v_mfma_f32_16x16x32_bf16 v[220:223], v[76:79], a[188:191], v[220:223]
    ds_read_b64_tr_b16 v[70:71], v96 offset:26944
    s_waitcnt lgkmcnt(8)
    v_mfma_f32_16x16x32_bf16 v[144:147], v[80:83], a[192:195], v[144:147]
    ds_read_b64_tr_b16 v[72:73], v96 offset:20576
    v_mfma_f32_16x16x32_bf16 v[204:207], v[80:83], a[200:203], v[204:207]
    ds_read_b64_tr_b16 v[74:75], v96 offset:21856
    v_mfma_f32_16x16x32_bf16 v[144:147], v[84:87], a[196:199], v[144:147]
    ds_read_b64_tr_b16 v[76:77], v96 offset:25696
    v_mfma_f32_16x16x32_bf16 v[204:207], v[84:87], a[204:207], v[204:207]
    ds_read_b64_tr_b16 v[78:79], v96 offset:26976
    s_waitcnt lgkmcnt(8)
    v_mfma_f32_16x16x32_bf16 v[148:151], v[88:91], a[192:195], v[148:151]
    ds_read_b64_tr_b16 v[80:81], v96 offset:20608
    v_mfma_f32_16x16x32_bf16 v[208:211], v[88:91], a[200:203], v[208:211]
    ds_read_b64_tr_b16 v[82:83], v96 offset:21888
    v_mfma_f32_16x16x32_bf16 v[148:151], v[92:95], a[196:199], v[148:151]
    ds_read_b64_tr_b16 v[84:85], v96 offset:25728
    v_mfma_f32_16x16x32_bf16 v[208:211], v[92:95], a[204:207], v[208:211]
    ds_read_b64_tr_b16 v[86:87], v96 offset:27008
    s_waitcnt lgkmcnt(8)
    v_mfma_f32_16x16x32_bf16 v[152:155], v[64:67], a[192:195], v[152:155]
    ds_read_b64_tr_b16 v[88:89], v96 offset:30720
    v_mfma_f32_16x16x32_bf16 v[212:215], v[64:67], a[200:203], v[212:215]
    ds_read_b64_tr_b16 v[90:91], v96 offset:32000
    v_mfma_f32_16x16x32_bf16 v[152:155], v[68:71], a[196:199], v[152:155]
    ds_read_b64_tr_b16 v[92:93], v96 offset:35840
    v_mfma_f32_16x16x32_bf16 v[212:215], v[68:71], a[204:207], v[212:215]
    ds_read_b64_tr_b16 v[94:95], v96 offset:37120
    s_waitcnt lgkmcnt(8)
    v_mfma_f32_16x16x32_bf16 v[156:159], v[72:75], a[192:195], v[156:159]
    ds_read_b64_tr_b16 v[64:65], v96 offset:30752
    v_mfma_f32_16x16x32_bf16 v[216:219], v[72:75], a[200:203], v[216:219]
    ds_read_b64_tr_b16 v[66:67], v96 offset:32032
    v_mfma_f32_16x16x32_bf16 v[156:159], v[76:79], a[196:199], v[156:159]
    ds_read_b64_tr_b16 v[68:69], v96 offset:35872
    v_mfma_f32_16x16x32_bf16 v[216:219], v[76:79], a[204:207], v[216:219]
    ds_read_b64_tr_b16 v[70:71], v96 offset:37152
    s_waitcnt lgkmcnt(8)
    v_mfma_f32_16x16x32_bf16 v[160:163], v[80:83], a[192:195], v[160:163]
    ds_read_b64_tr_b16 v[72:73], v96 offset:30784
    v_mfma_f32_16x16x32_bf16 v[220:223], v[80:83], a[200:203], v[220:223]
    ds_read_b64_tr_b16 v[74:75], v96 offset:32064
    v_mfma_f32_16x16x32_bf16 v[160:163], v[84:87], a[196:199], v[160:163]
    ds_read_b64_tr_b16 v[76:77], v96 offset:35904
    v_mfma_f32_16x16x32_bf16 v[220:223], v[84:87], a[204:207], v[220:223]
    ds_read_b64_tr_b16 v[78:79], v96 offset:37184
    s_waitcnt lgkmcnt(8)
    v_mfma_f32_16x16x32_bf16 v[144:147], v[88:91], a[208:211], v[144:147]
    ds_read_b64_tr_b16 v[80:81], v96 offset:30816
    v_mfma_f32_16x16x32_bf16 v[204:207], v[88:91], a[216:219], v[204:207]
    ds_read_b64_tr_b16 v[82:83], v96 offset:32096
    v_mfma_f32_16x16x32_bf16 v[144:147], v[92:95], a[212:215], v[144:147]
    ds_read_b64_tr_b16 v[84:85], v96 offset:35936
    v_mfma_f32_16x16x32_bf16 v[204:207], v[92:95], a[220:223], v[204:207]
    ds_read_b64_tr_b16 v[86:87], v96 offset:37216
    s_waitcnt lgkmcnt(8)
    v_mfma_f32_16x16x32_bf16 v[148:151], v[64:67], a[208:211], v[148:151]
    ds_read_b64_tr_b16 v[88:89], v96 offset:30848
    v_mfma_f32_16x16x32_bf16 v[208:211], v[64:67], a[216:219], v[208:211]
    ds_read_b64_tr_b16 v[90:91], v96 offset:32128
    v_mfma_f32_16x16x32_bf16 v[148:151], v[68:71], a[212:215], v[148:151]
    ds_read_b64_tr_b16 v[92:93], v96 offset:35968
    v_mfma_f32_16x16x32_bf16 v[208:211], v[68:71], a[220:223], v[208:211]
    ds_read_b64_tr_b16 v[94:95], v96 offset:37248
    s_waitcnt vmcnt(5)
    s_barrier
    buffer_load_dword v25, v15, s[80:83], s52 offen sc1
    s_waitcnt lgkmcnt(8)
    v_mov_b32 v244, -1
    v_mov_b32 v245, -1
    v_mov_b32 v246, -1
    v_mov_b32 v247, -1
    v_mfma_f32_16x16x32_bf16 v[152:155], v[72:75], a[208:211], v[152:155]
    ds_read_b64_tr_b16 v[64:65], v28 offset:0
    buffer_store_dwordx4 v[244:247], v8, s[16:19], 0 offen offset:0 sc1
    v_mfma_f32_16x16x32_bf16 v[212:215], v[72:75], a[216:219], v[212:215]
    ds_read_b64_tr_b16 v[66:67], v28 offset:1280
    v_mfma_f32_16x16x32_bf16 v[152:155], v[76:79], a[212:215], v[152:155]
    ds_read_b64_tr_b16 v[68:69], v28 offset:5120
    buffer_store_dwordx4 v[244:247], v8, s[16:19], 0 offen offset:1024 sc1
    v_mfma_f32_16x16x32_bf16 v[212:215], v[76:79], a[220:223], v[212:215]
    ds_read_b64_tr_b16 v[70:71], v28 offset:6400
    s_waitcnt lgkmcnt(8)
    v_mfma_f32_16x16x32_bf16 v[156:159], v[80:83], a[208:211], v[156:159]
    ds_read_b64_tr_b16 v[72:73], v28 offset:32
    buffer_store_dwordx4 v[244:247], v8, s[16:19], 0 offen offset:2048 sc1
    v_mfma_f32_16x16x32_bf16 v[216:219], v[80:83], a[216:219], v[216:219]
    ds_read_b64_tr_b16 v[74:75], v28 offset:1312
    v_mfma_f32_16x16x32_bf16 v[156:159], v[84:87], a[212:215], v[156:159]
    ds_read_b64_tr_b16 v[76:77], v28 offset:5152
    buffer_store_dwordx4 v[244:247], v8, s[16:19], 0 offen offset:3072 sc1
    v_mfma_f32_16x16x32_bf16 v[216:219], v[84:87], a[220:223], v[216:219]
    ds_read_b64_tr_b16 v[78:79], v28 offset:6432
    s_waitcnt lgkmcnt(8)
    v_mfma_f32_16x16x32_bf16 v[160:163], v[88:91], a[208:211], v[160:163]
    ds_read_b64_tr_b16 v[80:81], v28 offset:64
    buffer_store_dwordx4 v[244:247], v9, s[16:19], 0 offen offset:0 sc1
    v_mfma_f32_16x16x32_bf16 v[220:223], v[88:91], a[216:219], v[220:223]
    ds_read_b64_tr_b16 v[82:83], v28 offset:1344
    v_mfma_f32_16x16x32_bf16 v[160:163], v[92:95], a[212:215], v[160:163]
    ds_read_b64_tr_b16 v[84:85], v28 offset:5184
    v_mfma_f32_16x16x32_bf16 v[220:223], v[92:95], a[220:223], v[220:223]
    ds_read_b64_tr_b16 v[86:87], v28 offset:6464
    s_waitcnt lgkmcnt(8)
    v_mfma_f32_16x16x32_bf16 v[144:147], v[64:67], a[224:227], v[144:147]
    ds_read_b64_tr_b16 v[88:89], v28 offset:96
    v_mfma_f32_16x16x32_bf16 v[204:207], v[64:67], a[232:235], v[204:207]
    ds_read_b64_tr_b16 v[90:91], v28 offset:1376
    v_mfma_f32_16x16x32_bf16 v[144:147], v[68:71], a[228:231], v[144:147]
    ds_read_b64_tr_b16 v[92:93], v28 offset:5216
    v_mfma_f32_16x16x32_bf16 v[204:207], v[68:71], a[236:239], v[204:207]
    ds_read_b64_tr_b16 v[94:95], v28 offset:6496
    s_waitcnt lgkmcnt(8)
    v_mfma_f32_16x16x32_bf16 v[148:151], v[72:75], a[224:227], v[148:151]
    ds_read_b64_tr_b16 v[64:65], v28 offset:128
    v_mfma_f32_16x16x32_bf16 v[208:211], v[72:75], a[232:235], v[208:211]
    ds_read_b64_tr_b16 v[66:67], v28 offset:1408
    v_mfma_f32_16x16x32_bf16 v[148:151], v[76:79], a[228:231], v[148:151]
    ds_read_b64_tr_b16 v[68:69], v28 offset:5248
    v_mfma_f32_16x16x32_bf16 v[208:211], v[76:79], a[236:239], v[208:211]
    ds_read_b64_tr_b16 v[70:71], v28 offset:6528
    s_waitcnt lgkmcnt(8)
    v_mfma_f32_16x16x32_bf16 v[152:155], v[80:83], a[224:227], v[152:155]
    ds_read_b64_tr_b16 v[72:73], v28 offset:10240
    v_mfma_f32_16x16x32_bf16 v[212:215], v[80:83], a[232:235], v[212:215]
    ds_read_b64_tr_b16 v[74:75], v28 offset:11520
    v_mfma_f32_16x16x32_bf16 v[152:155], v[84:87], a[228:231], v[152:155]
    ds_read_b64_tr_b16 v[76:77], v28 offset:15360
    v_mfma_f32_16x16x32_bf16 v[212:215], v[84:87], a[236:239], v[212:215]
    ds_read_b64_tr_b16 v[78:79], v28 offset:16640
    s_waitcnt lgkmcnt(8)
    v_mfma_f32_16x16x32_bf16 v[156:159], v[88:91], a[224:227], v[156:159]
    ds_read_b64_tr_b16 v[80:81], v28 offset:10272
    v_mfma_f32_16x16x32_bf16 v[216:219], v[88:91], a[232:235], v[216:219]
    ds_read_b64_tr_b16 v[82:83], v28 offset:11552
    v_mfma_f32_16x16x32_bf16 v[156:159], v[92:95], a[228:231], v[156:159]
    ds_read_b64_tr_b16 v[84:85], v28 offset:15392
    v_mfma_f32_16x16x32_bf16 v[216:219], v[92:95], a[236:239], v[216:219]
    ds_read_b64_tr_b16 v[86:87], v28 offset:16672
    s_waitcnt lgkmcnt(8)
    v_mfma_f32_16x16x32_bf16 v[160:163], v[64:67], a[224:227], v[160:163]
    ds_read_b64_tr_b16 v[88:89], v28 offset:10304
    v_mfma_f32_16x16x32_bf16 v[220:223], v[64:67], a[232:235], v[220:223]
    ds_read_b64_tr_b16 v[90:91], v28 offset:11584
    v_mfma_f32_16x16x32_bf16 v[160:163], v[68:71], a[228:231], v[160:163]
    ds_read_b64_tr_b16 v[92:93], v28 offset:15424
    v_mfma_f32_16x16x32_bf16 v[220:223], v[68:71], a[236:239], v[220:223]
    ds_read_b64_tr_b16 v[94:95], v28 offset:16704
    s_waitcnt lgkmcnt(8)
    v_mfma_f32_16x16x32_bf16 v[144:147], v[72:75], a[240:243], v[144:147]
    ds_read_b64_tr_b16 v[64:65], v28 offset:10336
    v_mfma_f32_16x16x32_bf16 v[204:207], v[72:75], a[248:251], v[204:207]
    ds_read_b64_tr_b16 v[66:67], v28 offset:11616
    v_mfma_f32_16x16x32_bf16 v[144:147], v[76:79], a[244:247], v[144:147]
    ds_read_b64_tr_b16 v[68:69], v28 offset:15456
    v_mfma_f32_16x16x32_bf16 v[204:207], v[76:79], a[252:255], v[204:207]
    ds_read_b64_tr_b16 v[70:71], v28 offset:16736
    s_waitcnt lgkmcnt(8)
    v_mfma_f32_16x16x32_bf16 v[148:151], v[80:83], a[240:243], v[148:151]
    ds_read_b64_tr_b16 v[72:73], v28 offset:10368
    v_mfma_f32_16x16x32_bf16 v[208:211], v[80:83], a[248:251], v[208:211]
    ds_read_b64_tr_b16 v[74:75], v28 offset:11648
    v_mfma_f32_16x16x32_bf16 v[148:151], v[84:87], a[244:247], v[148:151]
    ds_read_b64_tr_b16 v[76:77], v28 offset:15488
    v_mfma_f32_16x16x32_bf16 v[208:211], v[84:87], a[252:255], v[208:211]
    ds_read_b64_tr_b16 v[78:79], v28 offset:16768
    s_waitcnt lgkmcnt(8)
    v_mfma_f32_16x16x32_bf16 v[152:155], v[88:91], a[240:243], v[152:155]
    v_mfma_f32_16x16x32_bf16 v[212:215], v[88:91], a[248:251], v[212:215]
    v_mfma_f32_16x16x32_bf16 v[152:155], v[92:95], a[244:247], v[152:155]
    v_mfma_f32_16x16x32_bf16 v[212:215], v[92:95], a[252:255], v[212:215]
    s_waitcnt lgkmcnt(4)
    v_mfma_f32_16x16x32_bf16 v[156:159], v[64:67], a[240:243], v[156:159]
    v_mfma_f32_16x16x32_bf16 v[216:219], v[64:67], a[248:251], v[216:219]
    v_mfma_f32_16x16x32_bf16 v[156:159], v[68:71], a[244:247], v[156:159]
    v_mfma_f32_16x16x32_bf16 v[216:219], v[68:71], a[252:255], v[216:219]
    s_waitcnt lgkmcnt(0)
    v_mfma_f32_16x16x32_bf16 v[160:163], v[72:75], a[240:243], v[160:163]
    v_mfma_f32_16x16x32_bf16 v[220:223], v[72:75], a[248:251], v[220:223]
    v_mfma_f32_16x16x32_bf16 v[160:163], v[76:79], a[244:247], v[160:163]
    v_mfma_f32_16x16x32_bf16 v[220:223], v[76:79], a[252:255], v[220:223]
    s_cmp_eq_u32 s49, 0xffff
    s_cbranch_scc1 GC_25
    s_waitcnt vmcnt(5)
    v_cmp_eq_u32 vcc, 1, v25
    s_nop 3
    s_cmp_lg_u32 vcc_lo, -1
    s_cbranch_scc1 GS_26
    s_mov_b32 s49, 0xffff
    buffer_load_dword v32, v18, s[12:15], s39 offen offset:0 sc1
    buffer_load_dword v33, v18, s[12:15], s39 offen offset:1024 sc1
    buffer_load_dword v34, v18, s[12:15], s39 offen offset:2048 sc1
    buffer_load_dword v35, v18, s[12:15], s39 offen offset:3072 sc1
    buffer_load_dword v36, v19, s[12:15], s39 offen offset:0 sc1
    buffer_load_dword v37, v19, s[12:15], s39 offen offset:1024 sc1
    buffer_load_dword v38, v19, s[12:15], s39 offen offset:2048 sc1
    buffer_load_dword v39, v19, s[12:15], s39 offen offset:3072 sc1
GS_26:
    buffer_load_dword v25, v15, s[80:83], s52 offen sc1
GC_25:
    s_mov_b32 s48, s49
    ds_read_b128 v[64:67], v24 offset:768
    ds_read_b128 v[68:71], v24 offset:832
    ds_read_b128 v[72:75], v24 offset:896
    ds_read_b128 v[76:79], v24 offset:960
    ds_read_b128 v[80:83], v24 offset:1024
    s_mov_b32 s34, 0x3fb8aa3b
    s_mov_b32 s35, 0x3fb8aa3b
    v_mov_b32 v94, 0x358637bd
    v_mov_b32 v95, 0x358637bd
    v_mov_b32 v24, 0x358637bd
    s_waitcnt lgkmcnt(4)
    v_pk_fma_f32 v[86:87], v[64:65], v[242:243], v[94:95] op_sel:[0,0,0] op_sel_hi:[1,0,1]
    v_pk_fma_f32 v[88:89], v[66:67], v[242:243], v[94:95] op_sel:[0,0,0] op_sel_hi:[1,0,1]
    v_pk_fma_f32 v[144:145], v[144:145], v[240:241], v[86:87] op_sel:[0,0,0] op_sel_hi:[1,0,1]
    v_pk_fma_f32 v[146:147], v[146:147], v[240:241], v[88:89] op_sel:[0,0,0] op_sel_hi:[1,0,1]
    v_pk_mul_f32 v[86:87], v[144:145], s[34:35]
    v_pk_mul_f32 v[88:89], v[146:147], s[34:35]
    v_exp_f32 v86, v86 clamp
    v_exp_f32 v87, v87 clamp
    v_exp_f32 v88, v88 clamp
    v_exp_f32 v89, v89 clamp
    v_max_f32 v144, v144, v94
    v_max_f32 v145, v145, v94
    v_max_f32 v146, v146, v94
    v_max_f32 v147, v147, v94
    v_pk_add_f32 v[144:145], v[144:145], v[86:87]
    v_pk_add_f32 v[146:147], v[146:147], v[88:89]
    v_cvt_pk_bf16_f32 v144, v144, v145
    v_cvt_pk_bf16_f32 v145, v146, v147
    s_mov_b32 s51, 0
    s_add_u32 m0, s53, 20480
    s_nop 0
    buffer_load_dwordx4 v29, s[4:7], s51 offen offset:0 lds
    buffer_load_dwordx4 v29, s[4:7], s51 offen offset:1024 lds
    s_waitcnt lgkmcnt(3)
    v_pk_fma_f32 v[90:91], v[68:69], v[242:243], v[94:95] op_sel:[0,0,0] op_sel_hi:[1,0,1]
    v_pk_fma_f32 v[92:93], v[70:71], v[242:243], v[94:95] op_sel:[0,0,0] op_sel_hi:[1,0,1]
    v_pk_fma_f32 v[148:149], v[148:149], v[240:241], v[90:91] op_sel:[0,0,0] op_sel_hi:[1,0,1]
    v_pk_fma_f32 v[150:151], v[150:151], v[240:241], v[92:93] op_sel:[0,0,0] op_sel_hi:[1,0,1]
    v_pk_mul_f32 v[90:91], v[148:149], s[34:35]
    v_pk_mul_f32 v[92:93], v[150:151], s[34:35]
    v_exp_f32 v90, v90 clamp
    v_exp_f32 v91, v91 clamp
    v_exp_f32 v92, v92 clamp
    v_exp_f32 v93, v93 clamp
    v_max_f32 v148, v148, v94
    v_max_f32 v149, v149, v94
    v_max_f32 v150, v150, v94
    v_max_f32 v151, v151, v94
    v_pk_add_f32 v[148:149], v[148:149], v[90:91]
    v_pk_add_f32 v[150:151], v[150:151], v[92:93]
    v_cvt_pk_bf16_f32 v146, v148, v149
    v_cvt_pk_bf16_f32 v147, v150, v151
    buffer_load_dwordx4 v29, s[4:7], s51 offen offset:2048 lds
    buffer_load_dwordx4 v29, s[4:7], s51 offen offset:3072 lds
    s_waitcnt lgkmcnt(2)
    v_pk_fma_f32 v[86:87], v[72:73], v[242:243], v[94:95] op_sel:[0,0,0] op_sel_hi:[1,0,1]
    v_pk_fma_f32 v[88:89], v[74:75], v[242:243], v[94:95] op_sel:[0,0,0] op_sel_hi:[1,0,1]
    v_pk_fma_f32 v[152:153], v[152:153], v[240:241], v[86:87] op_sel:[0,0,0] op_sel_hi:[1,0,1]
    v_pk_fma_f32 v[154:155], v[154:155], v[240:241], v[88:89] op_sel:[0,0,0] op_sel_hi:[1,0,1]
    v_pk_mul_f32 v[86:87], v[152:153], s[34:35]
    v_pk_mul_f32 v[88:89], v[154:155], s[34:35]
    v_exp_f32 v86, v86 clamp
    v_exp_f32 v87, v87 clamp
    v_exp_f32 v88, v88 clamp
    v_exp_f32 v89, v89 clamp
    v_max_f32 v152, v152, v94
    v_max_f32 v153, v153, v94
    v_max_f32 v154, v154, v94
    v_max_f32 v155, v155, v94
    v_pk_add_f32 v[152:153], v[152:153], v[86:87]
    v_pk_add_f32 v[154:155], v[154:155], v[88:89]
    v_cvt_pk_bf16_f32 v152, v152, v153
    v_cvt_pk_bf16_f32 v153, v154, v155
    s_mov_b32 s51, 4096
    s_add_u32 m0, s53, 24576
    s_nop 0
    buffer_load_dwordx4 v29, s[4:7], s51 offen offset:0 lds
    s_add_u32 s51, s46, 0
    s_add_u32 m0, s47, 40960
    s_nop 0
    buffer_load_dwordx4 v29, s[4:7], s51 offen offset:0 lds
    s_waitcnt lgkmcnt(1)
    v_pk_fma_f32 v[90:91], v[76:77], v[242:243], v[94:95] op_sel:[0,0,0] op_sel_hi:[1,0,1]
    v_pk_fma_f32 v[92:93], v[78:79], v[242:243], v[94:95] op_sel:[0,0,0] op_sel_hi:[1,0,1]
    v_pk_fma_f32 v[156:157], v[156:157], v[240:241], v[90:91] op_sel:[0,0,0] op_sel_hi:[1,0,1]
    v_pk_fma_f32 v[158:159], v[158:159], v[240:241], v[92:93] op_sel:[0,0,0] op_sel_hi:[1,0,1]
    v_pk_mul_f32 v[90:91], v[156:157], s[34:35]
    v_pk_mul_f32 v[92:93], v[158:159], s[34:35]
    v_exp_f32 v90, v90 clamp
    v_exp_f32 v91, v91 clamp
    v_exp_f32 v92, v92 clamp
    v_exp_f32 v93, v93 clamp
    v_max_f32 v156, v156, v94
    v_max_f32 v157, v157, v94
    v_max_f32 v158, v158, v94
    v_max_f32 v159, v159, v94
    v_pk_add_f32 v[156:157], v[156:157], v[90:91]
    v_pk_add_f32 v[158:159], v[158:159], v[92:93]
    v_cvt_pk_bf16_f32 v154, v156, v157
    v_cvt_pk_bf16_f32 v155, v158, v159
    s_add_u32 s51, s56, 0
    s_mov_b32 m0, 45056
    s_mov_b64 exec, s[36:37]
    buffer_load_dwordx4 v29, s[4:7], s51 offen offset:0 lds
    s_mov_b64 exec, -1
    s_mov_b32 s51, 25600
    s_add_u32 m0, s53, 114688
    s_nop 0
    buffer_load_dwordx4 v29, s[4:7], s51 offen offset:0 lds
    s_waitcnt lgkmcnt(0)
    v_pk_fma_f32 v[86:87], v[80:81], v[242:243], v[94:95] op_sel:[0,0,0] op_sel_hi:[1,0,1]
    v_pk_fma_f32 v[88:89], v[82:83], v[242:243], v[94:95] op_sel:[0,0,0] op_sel_hi:[1,0,1]
    v_pk_fma_f32 v[160:161], v[160:161], v[240:241], v[86:87] op_sel:[0,0,0] op_sel_hi:[1,0,1]
    v_pk_fma_f32 v[162:163], v[162:163], v[240:241], v[88:89] op_sel:[0,0,0] op_sel_hi:[1,0,1]
    v_pk_mul_f32 v[86:87], v[160:161], s[34:35]
    v_pk_mul_f32 v[88:89], v[162:163], s[34:35]
    v_exp_f32 v86, v86 clamp
    v_exp_f32 v87, v87 clamp
    v_exp_f32 v88, v88 clamp
    v_exp_f32 v89, v89 clamp
    v_max_f32 v160, v160, v94
    v_max_f32 v161, v161, v94
    v_max_f32 v162, v162, v94
    v_max_f32 v163, v163, v94
    v_pk_add_f32 v[160:161], v[160:161], v[86:87]
    v_pk_add_f32 v[162:163], v[162:163], v[88:89]
    v_cvt_pk_bf16_f32 v160, v160, v161
    v_cvt_pk_bf16_f32 v161, v162, v163
    buffer_load_dwordx4 v29, s[4:7], s51 offen offset:1024 lds
    buffer_load_dwordx4 v29, s[4:7], s51 offen offset:2048 lds
    v_mov_b32 v162, 0
    v_mov_b32 v163, 0
    s_cmp_eq_u32 s49, 0xffff
    s_cbranch_scc1 GC_27
    s_waitcnt vmcnt(10)
    v_cmp_eq_u32 vcc, 1, v25
    s_nop 3
    s_cmp_lg_u32 vcc_lo, -1
    s_cbranch_scc1 GS_28
    s_mov_b32 s49, 0xffff
    buffer_load_dword v32, v18, s[12:15], s39 offen offset:0 sc1
    buffer_load_dword v33, v18, s[12:15], s39 offen offset:1024 sc1
    buffer_load_dword v34, v18, s[12:15], s39 offen offset:2048 sc1
    buffer_load_dword v35, v18, s[12:15], s39 offen offset:3072 sc1
    buffer_load_dword v36, v19, s[12:15], s39 offen offset:0 sc1
    buffer_load_dword v37, v19, s[12:15], s39 offen offset:1024 sc1
    buffer_load_dword v38, v19, s[12:15], s39 offen offset:2048 sc1
    buffer_load_dword v39, v19, s[12:15], s39 offen offset:3072 sc1
GS_28:
    buffer_load_dword v25, v15, s[80:83], s52 offen sc1
GC_27:
    v_pk_fma_f32 v[86:87], v[64:65], v[242:243], v[94:95] op_sel:[0,1,0] op_sel_hi:[1,1,1]
    v_pk_fma_f32 v[88:89], v[66:67], v[242:243], v[94:95] op_sel:[0,1,0] op_sel_hi:[1,1,1]
    v_pk_fma_f32 v[204:205], v[204:205], v[240:241], v[86:87] op_sel:[0,1,0] op_sel_hi:[1,1,1]
    v_pk_fma_f32 v[206:207], v[206:207], v[240:241], v[88:89] op_sel:[0,1,0] op_sel_hi:[1,1,1]
    v_pk_mul_f32 v[86:87], v[204:205], s[34:35]
    v_pk_mul_f32 v[88:89], v[206:207], s[34:35]
    v_exp_f32 v86, v86 clamp
    v_exp_f32 v87, v87 clamp
    v_exp_f32 v88, v88 clamp
    v_exp_f32 v89, v89 clamp
    v_max_f32 v204, v204, v94
    v_max_f32 v205, v205, v94
    v_max_f32 v206, v206, v94
    v_max_f32 v207, v207, v94
    v_pk_add_f32 v[204:205], v[204:205], v[86:87]
    v_pk_add_f32 v[206:207], v[206:207], v[88:89]
    v_cvt_pk_bf16_f32 v204, v204, v205
    v_cvt_pk_bf16_f32 v205, v206, v207
    buffer_load_dwordx4 v29, s[4:7], s51 offen offset:3072 lds
    s_mov_b32 s51, 29696
    s_add_u32 m0, s53, 118784
    s_nop 0
    buffer_load_dwordx4 v29, s[4:7], s51 offen offset:0 lds
    v_pk_fma_f32 v[90:91], v[68:69], v[242:243], v[94:95] op_sel:[0,1,0] op_sel_hi:[1,1,1]
    v_pk_fma_f32 v[92:93], v[70:71], v[242:243], v[94:95] op_sel:[0,1,0] op_sel_hi:[1,1,1]
    v_pk_fma_f32 v[208:209], v[208:209], v[240:241], v[90:91] op_sel:[0,1,0] op_sel_hi:[1,1,1]
    v_pk_fma_f32 v[210:211], v[210:211], v[240:241], v[92:93] op_sel:[0,1,0] op_sel_hi:[1,1,1]
    v_pk_mul_f32 v[90:91], v[208:209], s[34:35]
    v_pk_mul_f32 v[92:93], v[210:211], s[34:35]
    v_exp_f32 v90, v90 clamp
    v_exp_f32 v91, v91 clamp
    v_exp_f32 v92, v92 clamp
    v_exp_f32 v93, v93 clamp
    v_max_f32 v208, v208, v94
    v_max_f32 v209, v209, v94
    v_max_f32 v210, v210, v94
    v_max_f32 v211, v211, v94
    v_pk_add_f32 v[208:209], v[208:209], v[90:91]
    v_pk_add_f32 v[210:211], v[210:211], v[92:93]
    v_cvt_pk_bf16_f32 v206, v208, v209
    v_cvt_pk_bf16_f32 v207, v210, v211
    s_add_u32 s51, s46, 25600
    s_add_u32 m0, s47, 135168
    s_nop 0
    buffer_load_dwordx4 v29, s[4:7], s51 offen offset:0 lds
    s_add_u32 s51, s56, 25600
    s_mov_b32 m0, 139264
    s_mov_b64 exec, s[36:37]
    buffer_load_dwordx4 v29, s[4:7], s51 offen offset:0 lds
    s_mov_b64 exec, -1
    v_pk_fma_f32 v[86:87], v[72:73], v[242:243], v[94:95] op_sel:[0,1,0] op_sel_hi:[1,1,1]
    v_pk_fma_f32 v[88:89], v[74:75], v[242:243], v[94:95] op_sel:[0,1,0] op_sel_hi:[1,1,1]
    v_pk_fma_f32 v[212:213], v[212:213], v[240:241], v[86:87] op_sel:[0,1,0] op_sel_hi:[1,1,1]
    v_pk_fma_f32 v[214:215], v[214:215], v[240:241], v[88:89] op_sel:[0,1,0] op_sel_hi:[1,1,1]
    v_pk_mul_f32 v[86:87], v[212:213], s[34:35]
    v_pk_mul_f32 v[88:89], v[214:215], s[34:35]
    v_exp_f32 v86, v86 clamp
    v_exp_f32 v87, v87 clamp
    v_exp_f32 v88, v88 clamp
    v_exp_f32 v89, v89 clamp
    v_max_f32 v212, v212, v94
    v_max_f32 v213, v213, v94
    v_max_f32 v214, v214, v94
    v_max_f32 v215, v215, v94
    v_pk_add_f32 v[212:213], v[212:213], v[86:87]
    v_pk_add_f32 v[214:215], v[214:215], v[88:89]
    v_cvt_pk_bf16_f32 v212, v212, v213
    v_cvt_pk_bf16_f32 v213, v214, v215
    s_mov_b32 s51, 51200
    s_add_u32 m0, s53, 140288
    s_nop 0
    buffer_load_dwordx4 v29, s[4:7], s51 offen offset:0 lds
    buffer_load_dwordx4 v29, s[4:7], s51 offen offset:1024 lds
    v_pk_fma_f32 v[90:91], v[76:77], v[242:243], v[94:95] op_sel:[0,1,0] op_sel_hi:[1,1,1]
    v_pk_fma_f32 v[92:93], v[78:79], v[242:243], v[94:95] op_sel:[0,1,0] op_sel_hi:[1,1,1]
    v_pk_fma_f32 v[216:217], v[216:217], v[240:241], v[90:91] op_sel:[0,1,0] op_sel_hi:[1,1,1]
    v_pk_fma_f32 v[218:219], v[218:219], v[240:241], v[92:93] op_sel:[0,1,0] op_sel_hi:[1,1,1]
    v_pk_mul_f32 v[90:91], v[216:217], s[34:35]
    v_pk_mul_f32 v[92:93], v[218:219], s[34:35]
    v_exp_f32 v90, v90 clamp
    v_exp_f32 v91, v91 clamp
    v_exp_f32 v92, v92 clamp
    v_exp_f32 v93, v93 clamp
    v_max_f32 v216, v216, v94
    v_max_f32 v217, v217, v94
    v_max_f32 v218, v218, v94
    v_max_f32 v219, v219, v94
    v_pk_add_f32 v[216:217], v[216:217], v[90:91]
    v_pk_add_f32 v[218:219], v[218:219], v[92:93]
    v_cvt_pk_bf16_f32 v214, v216, v217
    v_cvt_pk_bf16_f32 v215, v218, v219
    buffer_load_dwordx4 v29, s[4:7], s51 offen offset:2048 lds
    buffer_load_dwordx4 v29, s[4:7], s51 offen offset:3072 lds
    v_pk_fma_f32 v[86:87], v[80:81], v[242:243], v[94:95] op_sel:[0,1,0] op_sel_hi:[1,1,1]
    v_pk_fma_f32 v[88:89], v[82:83], v[242:243], v[94:95] op_sel:[0,1,0] op_sel_hi:[1,1,1]
    v_pk_fma_f32 v[220:221], v[220:221], v[240:241], v[86:87] op_sel:[0,1,0] op_sel_hi:[1,1,1]
    v_pk_fma_f32 v[222:223], v[222:223], v[240:241], v[88:89] op_sel:[0,1,0] op_sel_hi:[1,1,1]
    v_pk_mul_f32 v[86:87], v[220:221], s[34:35]
    v_pk_mul_f32 v[88:89], v[222:223], s[34:35]
    v_exp_f32 v86, v86 clamp
    v_exp_f32 v87, v87 clamp
    v_exp_f32 v88, v88 clamp
    v_exp_f32 v89, v89 clamp
    v_max_f32 v220, v220, v94
    v_max_f32 v221, v221, v94
    v_max_f32 v222, v222, v94
    v_max_f32 v223, v223, v94
    v_pk_add_f32 v[220:221], v[220:221], v[86:87]
    v_pk_add_f32 v[222:223], v[222:223], v[88:89]
    v_cvt_pk_bf16_f32 v220, v220, v221
    v_cvt_pk_bf16_f32 v221, v222, v223
    s_mov_b32 s51, 55296
    s_add_u32 m0, s53, 144384
    s_nop 0
    buffer_load_dwordx4 v29, s[4:7], s51 offen offset:0 lds
    s_add_u32 s51, s46, 51200
    s_add_u32 m0, s47, 46080
    s_nop 0
    buffer_load_dwordx4 v29, s[4:7], s51 offen offset:0 lds
    v_mov_b32 v222, 0
    v_mov_b32 v223, 0
    s_mov_b32 s98, 0
    s_waitcnt vmcnt(20)
    s_cmp_eq_u32 s48, 0xffff
    s_cbranch_scc1 GE
    s_cmp_eq_u32 s49, 0xffff
    s_cbranch_scc1 GD
GL:
    s_waitcnt vmcnt(0)
    v_cmp_eq_u32 vcc, 1, v25
    s_nop 3
    s_cmp_lg_u32 vcc_lo, -1
    s_cbranch_scc1 GS_29
    s_mov_b32 s49, 0xffff
    buffer_load_dword v32, v18, s[12:15], s39 offen offset:0 sc1
    buffer_load_dword v33, v18, s[12:15], s39 offen offset:1024 sc1
    buffer_load_dword v34, v18, s[12:15], s39 offen offset:2048 sc1
    buffer_load_dword v35, v18, s[12:15], s39 offen offset:3072 sc1
    buffer_load_dword v36, v19, s[12:15], s39 offen offset:0 sc1
    buffer_load_dword v37, v19, s[12:15], s39 offen offset:1024 sc1
    buffer_load_dword v38, v19, s[12:15], s39 offen offset:2048 sc1
    buffer_load_dword v39, v19, s[12:15], s39 offen offset:3072 sc1
GS_29:
    s_cmp_eq_u32 s49, 0xffff
    s_cbranch_scc1 GD
    s_add_u32 s98, s98, 1
    s_cmp_ge_u32 s98, 0x40000
    s_cbranch_scc1 GD
    s_sleep 2
    buffer_load_dword v25, v15, s[80:83], s52 offen sc1
    s_branch GL
GD:
    s_waitcnt vmcnt(0)
GE:
    v_cvt_pk_bf16_f32 v32, v32, v33
    v_cvt_pk_bf16_f32 v33, v34, v35
    ds_write_b64 v20, v[32:33]
    v_cvt_pk_bf16_f32 v36, v36, v37
    v_cvt_pk_bf16_f32 v37, v38, v39
    ds_write_b64 v21, v[36:37]
    s_add_u32 s51, s56, 51200
    s_mov_b32 m0, 50176
    s_mov_b64 exec, s[36:37]
    buffer_load_dwordx4 v29, s[4:7], s51 offen offset:0 lds
    s_mov_b64 exec, -1
    s_mov_b32 s51, 76800
    s_add_u32 m0, s53, 73728
    s_nop 0
    buffer_load_dwordx4 v29, s[4:7], s51 offen offset:0 lds
    s_waitcnt lgkmcnt(0)
    s_barrier
    ds_read_b128 v[32:35], v31 offset:15360
    ds_read_b128 v[36:39], v31 offset:16384
    ds_read_b128 v[40:43], v31 offset:17408
    ds_read_b128 v[44:47], v31 offset:0
    ds_read_b128 v[48:51], v31 offset:3072
    ds_read_b128 v[52:55], v31 offset:4096
    ds_read_b128 v[56:59], v31 offset:6144
    ds_read_b128 v[60:63], v31 offset:7168
    ds_read_b128 v[64:67], v31 offset:10240
    ds_read_b128 v[68:71], v31 offset:11264
    ds_read_b128 v[72:75], v31 offset:13312
    ds_read_b128 v[76:79], v31 offset:14336
    s_waitcnt lgkmcnt(11)
    v_mfma_f32_16x16x32_bf16 v[116:119], v[32:35], v[144:147], 0
    v_mfma_f32_16x16x32_bf16 v[140:143], v[32:35], v[204:207], 0
    buffer_load_dwordx4 v29, s[4:7], s51 offen offset:1024 lds
    s_waitcnt lgkmcnt(10)
    v_mfma_f32_16x16x32_bf16 v[116:119], v[36:39], v[152:155], v[116:119]
    v_mfma_f32_16x16x32_bf16 v[140:143], v[36:39], v[212:215], v[140:143]
    buffer_load_dwordx4 v29, s[4:7], s51 offen offset:2048 lds
    s_waitcnt lgkmcnt(9)
    v_mfma_f32_16x16x32_bf16 v[116:119], v[40:43], v[160:163], v[116:119]
    v_mfma_f32_16x16x32_bf16 v[140:143], v[40:43], v[220:223], v[140:143]
    buffer_load_dwordx4 v29, s[4:7], s51 offen offset:3072 lds
    s_waitcnt lgkmcnt(8)
    v_mfma_f32_16x16x32_bf16 v[96:99], v[44:47], v[144:147], 0
    v_mfma_f32_16x16x32_bf16 v[120:123], v[44:47], v[204:207], 0
    s_mov_b32 s51, 80896
    s_add_u32 m0, s53, 77824
    s_nop 0
    buffer_load_dwordx4 v29, s[4:7], s51 offen offset:0 lds
    s_waitcnt lgkmcnt(7)
    v_mfma_f32_16x16x32_bf16 v[100:103], v[48:51], v[144:147], 0
    v_mfma_f32_16x16x32_bf16 v[124:127], v[48:51], v[204:207], 0
    s_add_u32 s51, s46, 76800
    s_add_u32 m0, s47, 94208
    s_nop 0
    buffer_load_dwordx4 v29, s[4:7], s51 offen offset:0 lds
    s_waitcnt lgkmcnt(6)
    v_mfma_f32_16x16x32_bf16 v[100:103], v[52:55], v[152:155], v[100:103]
    v_mfma_f32_16x16x32_bf16 v[124:127], v[52:55], v[212:215], v[124:127]
    s_add_u32 s51, s56, 76800
    s_mov_b32 m0, 98304
    s_mov_b64 exec, s[36:37]
    buffer_load_dwordx4 v29, s[4:7], s51 offen offset:0 lds
    s_mov_b64 exec, -1
    s_waitcnt lgkmcnt(5)
    v_mfma_f32_16x16x32_bf16 v[104:107], v[56:59], v[144:147], 0
    v_mfma_f32_16x16x32_bf16 v[128:131], v[56:59], v[204:207], 0
    v_cvt_pk_bf16_f32 v116, v116, v117
    v_cvt_pk_bf16_f32 v118, v118, v119
    v_and_b32 v117, 0xffff0000, v116
    v_lshlrev_b32 v116, 16, v116
    v_and_b32 v119, 0xffff0000, v118
    v_lshlrev_b32 v118, 16, v118
    v_add_f32 v116, v24, v116
    v_add_f32 v117, v24, v117
    v_add_f32 v118, v24, v118
    v_add_f32 v119, v24, v119
    v_cvt_pk_bf16_f32 v116, v116, v117
    v_cvt_pk_bf16_f32 v118, v118, v119
    v_and_b32 v117, 0xffff0000, v116
    v_lshlrev_b32 v116, 16, v116
    v_and_b32 v119, 0xffff0000, v118
    v_lshlrev_b32 v118, 16, v118
    v_rcp_f32 v116, v116
    v_rcp_f32 v117, v117
    v_rcp_f32 v118, v118
    v_rcp_f32 v119, v119
    v_cvt_pk_bf16_f32 v140, v140, v141
    v_cvt_pk_bf16_f32 v142, v142, v143
    v_and_b32 v141, 0xffff0000, v140
    v_lshlrev_b32 v140, 16, v140
    v_and_b32 v143, 0xffff0000, v142
    v_lshlrev_b32 v142, 16, v142
    v_add_f32 v140, v24, v140
    v_add_f32 v141, v24, v141
    v_add_f32 v142, v24, v142
    v_add_f32 v143, v24, v143
    v_cvt_pk_bf16_f32 v140, v140, v141
    v_cvt_pk_bf16_f32 v142, v142, v143
    v_and_b32 v141, 0xffff0000, v140
    v_lshlrev_b32 v140, 16, v140
    v_and_b32 v143, 0xffff0000, v142
    v_lshlrev_b32 v142, 16, v142
    v_rcp_f32 v140, v140
    v_rcp_f32 v141, v141
    v_rcp_f32 v142, v142
    v_rcp_f32 v143, v143
    s_waitcnt lgkmcnt(4)
    v_mfma_f32_16x16x32_bf16 v[104:107], v[60:63], v[152:155], v[104:107]
    v_mfma_f32_16x16x32_bf16 v[128:131], v[60:63], v[212:215], v[128:131]
    s_waitcnt lgkmcnt(3)
    v_mfma_f32_16x16x32_bf16 v[108:111], v[64:67], v[152:155], 0
    v_mfma_f32_16x16x32_bf16 v[132:135], v[64:67], v[212:215], 0
    s_waitcnt lgkmcnt(2)
    v_mfma_f32_16x16x32_bf16 v[108:111], v[68:71], v[160:163], v[108:111]
    v_mfma_f32_16x16x32_bf16 v[132:135], v[68:71], v[220:223], v[132:135]
    s_waitcnt lgkmcnt(1)
    v_mfma_f32_16x16x32_bf16 v[112:115], v[72:75], v[152:155], 0
    v_mfma_f32_16x16x32_bf16 v[136:139], v[72:75], v[212:215], 0
    s_waitcnt lgkmcnt(0)
    v_mfma_f32_16x16x32_bf16 v[112:115], v[76:79], v[160:163], v[112:115]
    v_mfma_f32_16x16x32_bf16 v[136:139], v[76:79], v[220:223], v[136:139]
    v_cndmask_b32 v240, v117, v116, s[92:93]
    v_cndmask_b32 v241, v118, v117, s[94:95]
    v_cndmask_b32 v242, v119, v118, s[96:97]
    v_pk_mul_f32 v[96:97], v[96:97], v[116:117] op_sel:[0,0] op_sel_hi:[1,0]
    v_pk_mul_f32 v[98:99], v[98:99], v[116:117] op_sel:[0,0] op_sel_hi:[1,0]
    v_cvt_pk_bf16_f32 v144, v96, v97
    v_cvt_pk_bf16_f32 v145, v98, v99
    v_pk_mul_f32 v[100:101], v[100:101], v[240:241] op_sel:[0,0] op_sel_hi:[1,0]
    v_pk_mul_f32 v[102:103], v[102:103], v[240:241] op_sel:[0,0] op_sel_hi:[1,0]
    v_cvt_pk_bf16_f32 v146, v100, v101
    v_cvt_pk_bf16_f32 v147, v102, v103
    buffer_store_dwordx4 v[144:147], v22, s[8:11], s54 offen offset:0
    v_pk_mul_f32 v[104:105], v[104:105], v[240:241] op_sel:[0,1] op_sel_hi:[1,1]
    v_pk_mul_f32 v[106:107], v[106:107], v[240:241] op_sel:[0,1] op_sel_hi:[1,1]
    v_cvt_pk_bf16_f32 v152, v104, v105
    v_cvt_pk_bf16_f32 v153, v106, v107
    v_pk_mul_f32 v[108:109], v[108:109], v[242:243] op_sel:[0,0] op_sel_hi:[1,0]
    v_pk_mul_f32 v[110:111], v[110:111], v[242:243] op_sel:[0,0] op_sel_hi:[1,0]
    v_cvt_pk_bf16_f32 v154, v108, v109
    v_cvt_pk_bf16_f32 v155, v110, v111
    buffer_store_dwordx4 v[152:155], v22, s[8:11], s54 offen offset:1024
    v_pk_mul_f32 v[112:113], v[112:113], v[118:119] op_sel:[0,1] op_sel_hi:[1,1]
    v_pk_mul_f32 v[114:115], v[114:115], v[118:119] op_sel:[0,1] op_sel_hi:[1,1]
    v_cvt_pk_bf16_f32 v160, v112, v113
    v_cvt_pk_bf16_f32 v161, v114, v115
    buffer_store_dwordx2 v[160:161], v22, s[8:11], s55 offen offset:2048
    v_cndmask_b32 v244, v141, v140, s[92:93]
    v_cndmask_b32 v245, v142, v141, s[94:95]
    v_cndmask_b32 v246, v143, v142, s[96:97]
    v_pk_mul_f32 v[120:121], v[120:121], v[140:141] op_sel:[0,0] op_sel_hi:[1,0]
    v_pk_mul_f32 v[122:123], v[122:123], v[140:141] op_sel:[0,0] op_sel_hi:[1,0]
    v_cvt_pk_bf16_f32 v204, v120, v121
    v_cvt_pk_bf16_f32 v205, v122, v123
    v_pk_mul_f32 v[124:125], v[124:125], v[244:245] op_sel:[0,0] op_sel_hi:[1,0]
    v_pk_mul_f32 v[126:127], v[126:127], v[244:245] op_sel:[0,0] op_sel_hi:[1,0]
    v_cvt_pk_bf16_f32 v206, v124, v125
    v_cvt_pk_bf16_f32 v207, v126, v127
    buffer_store_dwordx4 v[204:207], v23, s[8:11], s54 offen offset:0
    v_pk_mul_f32 v[128:129], v[128:129], v[244:245] op_sel:[0,1] op_sel_hi:[1,1]
    v_pk_mul_f32 v[130:131], v[130:131], v[244:245] op_sel:[0,1] op_sel_hi:[1,1]
    v_cvt_pk_bf16_f32 v212, v128, v129
    v_cvt_pk_bf16_f32 v213, v130, v131
    v_pk_mul_f32 v[132:133], v[132:133], v[246:247] op_sel:[0,0] op_sel_hi:[1,0]
    v_pk_mul_f32 v[134:135], v[134:135], v[246:247] op_sel:[0,0] op_sel_hi:[1,0]
    v_cvt_pk_bf16_f32 v214, v132, v133
    v_cvt_pk_bf16_f32 v215, v134, v135
    buffer_store_dwordx4 v[212:215], v23, s[8:11], s54 offen offset:1024
    v_pk_mul_f32 v[136:137], v[136:137], v[142:143] op_sel:[0,1] op_sel_hi:[1,1]
    v_pk_mul_f32 v[138:139], v[138:139], v[142:143] op_sel:[0,1] op_sel_hi:[1,1]
    v_cvt_pk_bf16_f32 v220, v136, v137
    v_cvt_pk_bf16_f32 v221, v138, v139
    buffer_store_dwordx2 v[220:221], v23, s[8:11], s55 offen offset:2048
    buffer_load_dword v16, v17, s[80:83], 0 offen sc1
    s_waitcnt vmcnt(7)
    v_accvgpr_read_b32 v232, a0
    v_accvgpr_read_b32 v233, a1
    v_accvgpr_read_b32 v234, a2
    v_accvgpr_read_b32 v235, a3
    v_accvgpr_read_b32 v236, a4
    v_accvgpr_read_b32 v237, a5
    v_accvgpr_read_b32 v238, a6
    v_accvgpr_read_b32 v239, a7
    v_accvgpr_read_b32 v240, a8
    v_accvgpr_read_b32 v241, a9
    v_accvgpr_read_b32 v242, a10
    v_accvgpr_read_b32 v243, a11
    v_accvgpr_read_b32 v244, a12
    v_accvgpr_read_b32 v245, a13
    v_accvgpr_read_b32 v246, a14
    v_accvgpr_read_b32 v247, a15
    v_accvgpr_read_b32 v248, a16
    v_accvgpr_read_b32 v249, a17
    v_accvgpr_read_b32 v250, a18
    v_accvgpr_read_b32 v251, a19
    v_permlane16_swap_b32 v232, v234
    v_permlane16_swap_b32 v233, v235
    v_permlane16_swap_b32 v236, v238
    v_permlane16_swap_b32 v237, v239
    v_permlane16_swap_b32 v240, v242
    v_permlane16_swap_b32 v241, v243
    v_permlane16_swap_b32 v244, v246
    v_permlane16_swap_b32 v245, v247
    v_permlane16_swap_b32 v248, v250
    v_permlane16_swap_b32 v249, v251
    v_lshlrev_b32 v192, 16, v232
    v_and_b32 v193, 0xffff0000, v232
    v_lshlrev_b32 v196, 16, v234
    v_and_b32 v197, 0xffff0000, v234
    v_lshlrev_b32 v194, 16, v233
    v_and_b32 v195, 0xffff0000, v233
    v_lshlrev_b32 v198, 16, v235
    v_and_b32 v199, 0xffff0000, v235
    v_lshlrev_b32 v200, 16, v236
    v_and_b32 v201, 0xffff0000, v236
    v_lshlrev_b32 v204, 16, v238
    v_and_b32 v205, 0xffff0000, v238
    v_lshlrev_b32 v202, 16, v237
    v_and_b32 v203, 0xffff0000, v237
    v_lshlrev_b32 v206, 16, v239
    v_and_b32 v207, 0xffff0000, v239
    v_lshlrev_b32 v212, 16, v240
    v_and_b32 v213, 0xffff0000, v240
    v_lshlrev_b32 v216, 16, v242
    v_and_b32 v217, 0xffff0000, v242
    v_lshlrev_b32 v214, 16, v241
    v_and_b32 v215, 0xffff0000, v241
    v_lshlrev_b32 v218, 16, v243
    v_and_b32 v219, 0xffff0000, v243
    v_lshlrev_b32 v220, 16, v244
    v_and_b32 v221, 0xffff0000, v244
    v_lshlrev_b32 v224, 16, v246
    v_and_b32 v225, 0xffff0000, v246
    v_lshlrev_b32 v222, 16, v245
    v_and_b32 v223, 0xffff0000, v245
    v_lshlrev_b32 v226, 16, v247
    v_and_b32 v227, 0xffff0000, v247
    v_lshlrev_b32 v208, 16, v248
    v_and_b32 v209, 0xffff0000, v248
    v_lshlrev_b32 v228, 16, v250
    v_and_b32 v229, 0xffff0000, v250
    v_lshlrev_b32 v210, 16, v249
    v_and_b32 v211, 0xffff0000, v249
    v_lshlrev_b32 v230, 16, v251
    v_and_b32 v231, 0xffff0000, v251
    v_mov_b32 v18, 1
    v_mov_b32 v19, 0
    s_mov_b32 s49, 0
    s_mov_b32 s48, 0
    s_mov_b32 s98, 0
    v_and_b32 v20, 1, v5
    v_lshlrev_b32 v20, 4, v20
    v_mov_b32 v21, 0x3f80
    v_lshlrev_b32 v20, v20, v21
    v_cmp_eq_u32 vcc, v2, v4
    s_nop 1
    v_cndmask_b32 v20, 0, v20, vcc
    v_cmp_gt_u32 vcc, 2, v5
    s_nop 1
    v_cndmask_b32 v22, 0, v20, vcc
    v_cndmask_b32 v23, v20, 0, vcc
    v_mov_b32 v20, 0
    v_mov_b32 v21, 0
    v_mov_b32 v24, 0
    v_mov_b32 v25, 0
    s_waitcnt vmcnt(1)
    buffer_store_dword v18, v19, s[80:83], s57 offen
    s_barrier
SP_30:
    s_waitcnt vmcnt(1)
    v_cmp_eq_u32 vcc, 1, v16
    s_add_u32 s98, s98, 1
    s_cmp_ge_u32 s98, 0x40000
    s_cselect_b32 s48, -1, 0
    s_lshr_b32 s50, vcc_lo, 1
    s_and_b32 s50, s50, vcc_lo
    s_or_b32 s48, s48, s50
    s_andn2_b32 s50, s48, s49
    s_and_b32 s50, s50, 0x55
    s_cbranch_scc1 SD_31
    s_sleep 2
    buffer_load_dword v16, v17, s[80:83], 0 offen sc1
    s_waitcnt vmcnt(0)
    s_branch SP_30
SD_31:
    s_ff1_i32_b32 s47, s50
    s_bitset1_b32 s49, s47
    s_mul_i32 s46, s47, 2560
    s_lshl_b32 s47, s47, 2
    s_or_b32 s47, s47, 0x80000
    s_bfe_u32 s34, 0x48897014, s47
    s_bfe_u32 s35, 0x48197014, s47
    v_lshl_add_u32 v10, s34, 10, v30
    v_lshl_add_u32 v11, s35, 10, v30
    buffer_load_dword v16, v17, s[80:83], 0 offen sc1
    buffer_load_dwordx4 v[32:35], v6, s[8:11], s46 offen offset:0 sc1
    buffer_load_dwordx4 v[36:39], v7, s[8:11], s46 offen offset:0 sc1
    buffer_load_dwordx4 v[40:43], v6, s[8:11], s46 offen offset:1024 sc1
    buffer_load_dwordx4 v[44:47], v7, s[8:11], s46 offen offset:1024 sc1
    buffer_load_dwordx4 v[48:51], v6, s[8:11], s46 offen offset:2048 sc1
    buffer_load_dwordx4 v[52:55], v7, s[8:11], s46 offen offset:2048 sc1
    buffer_load_dwordx4 v[56:59], v6, s[8:11], s46 offen offset:3072 sc1
    buffer_load_dwordx4 v[60:63], v7, s[8:11], s46 offen offset:3072 sc1
    buffer_load_dwordx4 v[64:67], v26, s[8:11], s46 offen offset:0 sc1
    buffer_load_dwordx4 v[68:71], v27, s[8:11], s46 offen offset:0 sc1
    ds_read_b128 a[0:3], v10 offset:0
    ds_read_b128 a[4:7], v10 offset:1024
    ds_read_b128 a[8:11], v10 offset:2048
    ds_read_b128 a[12:15], v10 offset:3072
    ds_read_b128 a[16:19], v10 offset:4096
    ds_read_b128 a[20:23], v10 offset:5120
    ds_read_b128 a[24:27], v10 offset:6144
    ds_read_b128 a[28:31], v10 offset:7168
    ds_read_b128 a[32:35], v10 offset:8192
    ds_read_b128 a[36:39], v10 offset:9216
    ds_read_b128 a[40:43], v10 offset:10240
    ds_read_b128 a[44:47], v10 offset:11264
    ds_read_b128 a[48:51], v10 offset:12288
    ds_read_b128 a[52:55], v10 offset:13312
    ds_read_b128 a[56:59], v10 offset:14336
    ds_read_b128 a[60:63], v10 offset:15360
    ds_read_b128 a[64:67], v10 offset:16384
    ds_read_b128 a[68:71], v10 offset:17408
    ds_read_b128 a[72:75], v10 offset:18432
    ds_read_b128 a[76:79], v10 offset:19456
    ds_read_b128 a[80:83], v11 offset:20480
    ds_read_b128 a[84:87], v11 offset:21504
    ds_read_b128 a[88:91], v11 offset:22528
    ds_read_b128 a[92:95], v11 offset:23552
    ds_read_b128 a[96:99], v11 offset:24576
    s_andn2_b32 s50, s48, s49
    s_and_b32 s50, s50, 0x55
    s_cbranch_scc1 QK_32
    s_waitcnt vmcnt(10)
    v_cmp_eq_u32 vcc, 1, v16
    s_add_u32 s98, s98, 1
    s_cmp_ge_u32 s98, 0x40000
    s_cselect_b32 s48, -1, 0
    s_lshr_b32 s50, vcc_lo, 1
    s_and_b32 s50, s50, vcc_lo
    s_or_b32 s48, s48, s50
    s_andn2_b32 s50, s48, s49
    s_and_b32 s50, s50, 0x55
QK_32:
    s_mov_b32 s45, s50
    s_cbranch_scc0 QN_33
    s_ff1_i32_b32 s47, s50
    s_bitset1_b32 s49, s47
    s_mul_i32 s46, s47, 2560
    s_lshl_b32 s47, s47, 2
    s_or_b32 s47, s47, 0x80000
    s_bfe_u32 s34, 0x48897014, s47
    s_bfe_u32 s35, 0x48197014, s47
    v_lshl_add_u32 v10, s34, 10, v30
    v_lshl_add_u32 v11, s35, 10, v30
QN_33:
    s_waitcnt lgkmcnt(0)
    s_waitcnt vmcnt(8)
    v_mfma_f32_16x16x32_bf16 v[192:195], a[0:3], v[32:35], v[192:195]
    ds_read_b128 a[100:103], v10 offset:0
    v_mfma_f32_16x16x32_bf16 v[212:215], a[0:3], v[36:39], v[212:215]
    buffer_load_dword v16, v17, s[80:83], 0 offen sc1
    v_mfma_f32_16x16x32_bf16 v[196:199], a[4:7], v[32:35], v[196:199]
    ds_read_b128 a[104:107], v10 offset:1024
    v_mfma_f32_16x16x32_bf16 v[216:219], a[4:7], v[36:39], v[216:219]
    v_mfma_f32_16x16x32_bf16 v[200:203], a[8:11], v[32:35], v[200:203]
    ds_read_b128 a[108:111], v10 offset:2048
    buffer_load_dwordx4 v[72:75], v6, s[8:11], s46 offen offset:0 sc1
    v_mfma_f32_16x16x32_bf16 v[220:223], a[8:11], v[36:39], v[220:223]
    v_mfma_f32_16x16x32_bf16 v[204:207], a[12:15], v[32:35], v[204:207]
    ds_read_b128 a[112:115], v10 offset:3072
    v_mfma_f32_16x16x32_bf16 v[224:227], a[12:15], v[36:39], v[224:227]
    buffer_load_dwordx4 v[76:79], v7, s[8:11], s46 offen offset:0 sc1
    v_mfma_f32_16x16x32_bf16 v[208:211], a[16:19], v[32:35], v[208:211]
    ds_read_b128 a[116:119], v10 offset:4096
    v_mfma_f32_16x16x32_bf16 v[228:231], a[16:19], v[36:39], v[228:231]
    s_waitcnt vmcnt(9)
    v_mfma_f32_16x16x32_bf16 v[192:195], a[20:23], v[40:43], v[192:195]
    ds_read_b128 a[120:123], v10 offset:5120
    buffer_load_dwordx4 v[80:83], v6, s[8:11], s46 offen offset:1024 sc1
    v_mfma_f32_16x16x32_bf16 v[212:215], a[20:23], v[44:47], v[212:215]
    v_mfma_f32_16x16x32_bf16 v[196:199], a[24:27], v[40:43], v[196:199]
    ds_read_b128 a[124:127], v10 offset:6144
    v_mfma_f32_16x16x32_bf16 v[216:219], a[24:27], v[44:47], v[216:219]
    buffer_load_dwordx4 v[84:87], v7, s[8:11], s46 offen offset:1024 sc1
    v_mfma_f32_16x16x32_bf16 v[200:203], a[28:31], v[40:43], v[200:203]
    ds_read_b128 a[128:131], v10 offset:7168
    v_mfma_f32_16x16x32_bf16 v[220:223], a[28:31], v[44:47], v[220:223]
    v_mfma_f32_16x16x32_bf16 v[204:207], a[32:35], v[40:43], v[204:207]
    ds_read_b128 a[132:135], v10 offset:8192
    buffer_load_dwordx4 v[88:91], v6, s[8:11], s46 offen offset:2048 sc1
    v_mfma_f32_16x16x32_bf16 v[224:227], a[32:35], v[44:47], v[224:227]
    v_mfma_f32_16x16x32_bf16 v[208:211], a[36:39], v[40:43], v[208:211]
    ds_read_b128 a[136:139], v10 offset:9216
    v_mfma_f32_16x16x32_bf16 v[228:231], a[36:39], v[44:47], v[228:231]
    buffer_load_dwordx4 v[92:95], v7, s[8:11], s46 offen offset:2048 sc1
    s_waitcnt vmcnt(11)
    v_mfma_f32_16x16x32_bf16 v[192:195], a[40:43], v[48:51], v[192:195]
    ds_read_b128 a[140:143], v10 offset:10240
    v_mfma_f32_16x16x32_bf16 v[212:215], a[40:43], v[52:55], v[212:215]
    v_mfma_f32_16x16x32_bf16 v[196:199], a[44:47], v[48:51], v[196:199]
    ds_read_b128 a[144:147], v10 offset:11264
    buffer_load_dwordx4 v[96:99], v6, s[8:11], s46 offen offset:3072 sc1
    v_mfma_f32_16x16x32_bf16 v[216:219], a[44:47], v[52:55], v[216:219]
    v_mfma_f32_16x16x32_bf16 v[200:203], a[48:51], v[48:51], v[200:203]
    ds_read_b128 a[148:151], v10 offset:12288
    v_mfma_f32_16x16x32_bf16 v[220:223], a[48:51], v[52:55], v[220:223]
    buffer_load_dwordx4 v[100:103], v7, s[8:11], s46 offen offset:3072 sc1
    v_mfma_f32_16x16x32_bf16 v[204:207], a[52:55], v[48:51], v[204:207]
    ds_read_b128 a[152:155], v10 offset:13312
    v_mfma_f32_16x16x32_bf16 v[224:227], a[52:55], v[52:55], v[224:227]
    v_mfma_f32_16x16x32_bf16 v[208:211], a[56:59], v[48:51], v[208:211]
    ds_read_b128 a[156:159], v10 offset:14336
    buffer_load_dwordx4 v[104:107], v26, s[8:11], s46 offen offset:0 sc1
    v_mfma_f32_16x16x32_bf16 v[228:231], a[56:59], v[52:55], v[228:231]
    s_waitcnt vmcnt(12)
    v_mfma_f32_16x16x32_bf16 v[192:195], a[60:63], v[56:59], v[192:195]
    ds_read_b128 a[160:163], v10 offset:15360
    v_mfma_f32_16x16x32_bf16 v[212:215], a[60:63], v[60:63], v[212:215]
    buffer_load_dwordx4 v[108:111], v27, s[8:11], s46 offen offset:0 sc1
    v_mfma_f32_16x16x32_bf16 v[196:199], a[64:67], v[56:59], v[196:199]
    ds_read_b128 a[164:167], v10 offset:16384
    v_mfma_f32_16x16x32_bf16 v[216:219], a[64:67], v[60:63], v[216:219]
    v_mfma_f32_16x16x32_bf16 v[200:203], a[68:71], v[56:59], v[200:203]
    ds_read_b128 a[168:171], v10 offset:17408
    v_mfma_f32_16x16x32_bf16 v[220:223], a[68:71], v[60:63], v[220:223]
    v_mfma_f32_16x16x32_bf16 v[204:207], a[72:75], v[56:59], v[204:207]
    ds_read_b128 a[172:175], v10 offset:18432
    v_mfma_f32_16x16x32_bf16 v[224:227], a[72:75], v[60:63], v[224:227]
    v_mfma_f32_16x16x32_bf16 v[208:211], a[76:79], v[56:59], v[208:211]
    ds_read_b128 a[176:179], v10 offset:19456
    v_mfma_f32_16x16x32_bf16 v[228:231], a[76:79], v[60:63], v[228:231]
    s_waitcnt vmcnt(11)
    v_mfma_f32_16x16x32_bf16 v[192:195], a[80:83], v[64:67], v[192:195]
    ds_read_b128 a[180:183], v11 offset:20480
    v_mfma_f32_16x16x32_bf16 v[212:215], a[80:83], v[68:71], v[212:215]
    v_mfma_f32_16x16x32_bf16 v[196:199], a[84:87], v[64:67], v[196:199]
    ds_read_b128 a[184:187], v11 offset:21504
    v_mfma_f32_16x16x32_bf16 v[216:219], a[84:87], v[68:71], v[216:219]
    v_mfma_f32_16x16x32_bf16 v[200:203], a[88:91], v[64:67], v[200:203]
    ds_read_b128 a[188:191], v11 offset:22528
    v_mfma_f32_16x16x32_bf16 v[220:223], a[88:91], v[68:71], v[220:223]
    v_mfma_f32_16x16x32_bf16 v[204:207], a[92:95], v[64:67], v[204:207]
    ds_read_b128 a[192:195], v11 offset:23552
    v_mfma_f32_16x16x32_bf16 v[224:227], a[92:95], v[68:71], v[224:227]
    v_mfma_f32_16x16x32_bf16 v[208:211], a[96:99], v[64:67], v[208:211]
    ds_read_b128 a[196:199], v11 offset:24576
    v_mfma_f32_16x16x32_bf16 v[228:231], a[96:99], v[68:71], v[228:231]
    s_cmp_lg_u32 s45, 0
    s_cbranch_scc1 QE_34
    s_waitcnt lgkmcnt(0)
SP_35:
    s_waitcnt vmcnt(0)
    v_cmp_eq_u32 vcc, 1, v16
    s_add_u32 s98, s98, 1
    s_cmp_ge_u32 s98, 0x40000
    s_cselect_b32 s48, -1, 0
    s_lshr_b32 s50, vcc_lo, 1
    s_and_b32 s50, s50, vcc_lo
    s_or_b32 s48, s48, s50
    s_andn2_b32 s50, s48, s49
    s_and_b32 s50, s50, 0x55
    s_cbranch_scc1 SD_36
    s_sleep 2
    buffer_load_dword v16, v17, s[80:83], 0 offen sc1
    s_waitcnt vmcnt(0)
    s_branch SP_35
SD_36:
    s_ff1_i32_b32 s47, s50
    s_bitset1_b32 s49, s47
    s_mul_i32 s46, s47, 2560
    s_lshl_b32 s47, s47, 2
    s_or_b32 s47, s47, 0x80000
    s_bfe_u32 s34, 0x48897014, s47
    s_bfe_u32 s35, 0x48197014, s47
    v_lshl_add_u32 v10, s34, 10, v30
    v_lshl_add_u32 v11, s35, 10, v30
    buffer_load_dword v16, v17, s[80:83], 0 offen sc1
    buffer_load_dwordx4 v[72:75], v6, s[8:11], s46 offen offset:0 sc1
    buffer_load_dwordx4 v[76:79], v7, s[8:11], s46 offen offset:0 sc1
    buffer_load_dwordx4 v[80:83], v6, s[8:11], s46 offen offset:1024 sc1
    buffer_load_dwordx4 v[84:87], v7, s[8:11], s46 offen offset:1024 sc1
    buffer_load_dwordx4 v[88:91], v6, s[8:11], s46 offen offset:2048 sc1
    buffer_load_dwordx4 v[92:95], v7, s[8:11], s46 offen offset:2048 sc1
    buffer_load_dwordx4 v[96:99], v6, s[8:11], s46 offen offset:3072 sc1
    buffer_load_dwordx4 v[100:103], v7, s[8:11], s46 offen offset:3072 sc1
    buffer_load_dwordx4 v[104:107], v26, s[8:11], s46 offen offset:0 sc1
    buffer_load_dwordx4 v[108:111], v27, s[8:11], s46 offen offset:0 sc1
    ds_read_b128 a[100:103], v10 offset:0
    ds_read_b128 a[104:107], v10 offset:1024
    ds_read_b128 a[108:111], v10 offset:2048
    ds_read_b128 a[112:115], v10 offset:3072
    ds_read_b128 a[116:119], v10 offset:4096
    ds_read_b128 a[120:123], v10 offset:5120
    ds_read_b128 a[124:127], v10 offset:6144
    ds_read_b128 a[128:131], v10 offset:7168
    ds_read_b128 a[132:135], v10 offset:8192
    ds_read_b128 a[136:139], v10 offset:9216
    ds_read_b128 a[140:143], v10 offset:10240
    ds_read_b128 a[144:147], v10 offset:11264
    ds_read_b128 a[148:151], v10 offset:12288
    ds_read_b128 a[152:155], v10 offset:13312
    ds_read_b128 a[156:159], v10 offset:14336
    ds_read_b128 a[160:163], v10 offset:15360
    ds_read_b128 a[164:167], v10 offset:16384
    ds_read_b128 a[168:171], v10 offset:17408
    ds_read_b128 a[172:175], v10 offset:18432
    ds_read_b128 a[176:179], v10 offset:19456
    ds_read_b128 a[180:183], v11 offset:20480
    ds_read_b128 a[184:187], v11 offset:21504
    ds_read_b128 a[188:191], v11 offset:22528
    ds_read_b128 a[192:195], v11 offset:23552
    ds_read_b128 a[196:199], v11 offset:24576
QE_34:
    s_andn2_b32 s50, s48, s49
    s_and_b32 s50, s50, 0x55
    s_cbranch_scc1 QK_37
    s_waitcnt vmcnt(10)
    v_cmp_eq_u32 vcc, 1, v16
    s_add_u32 s98, s98, 1
    s_cmp_ge_u32 s98, 0x40000
    s_cselect_b32 s48, -1, 0
    s_lshr_b32 s50, vcc_lo, 1
    s_and_b32 s50, s50, vcc_lo
    s_or_b32 s48, s48, s50
    s_andn2_b32 s50, s48, s49
    s_and_b32 s50, s50, 0x55
QK_37:
    s_mov_b32 s45, s50
    s_cbranch_scc0 QN_38
    s_ff1_i32_b32 s47, s50
    s_bitset1_b32 s49, s47
    s_mul_i32 s46, s47, 2560
    s_lshl_b32 s47, s47, 2
    s_or_b32 s47, s47, 0x80000
    s_bfe_u32 s34, 0x48897014, s47
    s_bfe_u32 s35, 0x48197014, s47
    v_lshl_add_u32 v10, s34, 10, v30
    v_lshl_add_u32 v11, s35, 10, v30
QN_38:
    s_waitcnt lgkmcnt(0)
    s_waitcnt vmcnt(8)
    v_mfma_f32_16x16x32_bf16 v[192:195], a[100:103], v[72:75], v[192:195]
    ds_read_b128 a[0:3], v10 offset:0
    v_mfma_f32_16x16x32_bf16 v[212:215], a[100:103], v[76:79], v[212:215]
    buffer_load_dword v16, v17, s[80:83], 0 offen sc1
    v_mfma_f32_16x16x32_bf16 v[196:199], a[104:107], v[72:75], v[196:199]
    ds_read_b128 a[4:7], v10 offset:1024
    v_mfma_f32_16x16x32_bf16 v[216:219], a[104:107], v[76:79], v[216:219]
    v_mfma_f32_16x16x32_bf16 v[200:203], a[108:111], v[72:75], v[200:203]
    ds_read_b128 a[8:11], v10 offset:2048
    buffer_load_dwordx4 v[112:115], v6, s[8:11], s46 offen offset:0 sc1
    v_mfma_f32_16x16x32_bf16 v[220:223], a[108:111], v[76:79], v[220:223]
    v_mfma_f32_16x16x32_bf16 v[204:207], a[112:115], v[72:75], v[204:207]
    ds_read_b128 a[12:15], v10 offset:3072
    v_mfma_f32_16x16x32_bf16 v[224:227], a[112:115], v[76:79], v[224:227]
    buffer_load_dwordx4 v[116:119], v7, s[8:11], s46 offen offset:0 sc1
    v_mfma_f32_16x16x32_bf16 v[208:211], a[116:119], v[72:75], v[208:211]
    ds_read_b128 a[16:19], v10 offset:4096
    v_mfma_f32_16x16x32_bf16 v[228:231], a[116:119], v[76:79], v[228:231]
    s_waitcnt vmcnt(9)
    v_mfma_f32_16x16x32_bf16 v[192:195], a[120:123], v[80:83], v[192:195]
    ds_read_b128 a[20:23], v10 offset:5120
    buffer_load_dwordx4 v[120:123], v6, s[8:11], s46 offen offset:1024 sc1
    v_mfma_f32_16x16x32_bf16 v[212:215], a[120:123], v[84:87], v[212:215]
    v_mfma_f32_16x16x32_bf16 v[196:199], a[124:127], v[80:83], v[196:199]
    ds_read_b128 a[24:27], v10 offset:6144
    v_mfma_f32_16x16x32_bf16 v[216:219], a[124:127], v[84:87], v[216:219]
    buffer_load_dwordx4 v[124:127], v7, s[8:11], s46 offen offset:1024 sc1
    v_mfma_f32_16x16x32_bf16 v[200:203], a[128:131], v[80:83], v[200:203]
    ds_read_b128 a[28:31], v10 offset:7168
    v_mfma_f32_16x16x32_bf16 v[220:223], a[128:131], v[84:87], v[220:223]
    v_mfma_f32_16x16x32_bf16 v[204:207], a[132:135], v[80:83], v[204:207]
    ds_read_b128 a[32:35], v10 offset:8192
    buffer_load_dwordx4 v[128:131], v6, s[8:11], s46 offen offset:2048 sc1
    v_mfma_f32_16x16x32_bf16 v[224:227], a[132:135], v[84:87], v[224:227]
    v_mfma_f32_16x16x32_bf16 v[208:211], a[136:139], v[80:83], v[208:211]
    ds_read_b128 a[36:39], v10 offset:9216
    v_mfma_f32_16x16x32_bf16 v[228:231], a[136:139], v[84:87], v[228:231]
    buffer_load_dwordx4 v[132:135], v7, s[8:11], s46 offen offset:2048 sc1
    s_waitcnt vmcnt(11)
    v_mfma_f32_16x16x32_bf16 v[192:195], a[140:143], v[88:91], v[192:195]
    ds_read_b128 a[40:43], v10 offset:10240
    v_mfma_f32_16x16x32_bf16 v[212:215], a[140:143], v[92:95], v[212:215]
    v_mfma_f32_16x16x32_bf16 v[196:199], a[144:147], v[88:91], v[196:199]
    ds_read_b128 a[44:47], v10 offset:11264
    buffer_load_dwordx4 v[136:139], v6, s[8:11], s46 offen offset:3072 sc1
    v_mfma_f32_16x16x32_bf16 v[216:219], a[144:147], v[92:95], v[216:219]
    v_mfma_f32_16x16x32_bf16 v[200:203], a[148:151], v[88:91], v[200:203]
    ds_read_b128 a[48:51], v10 offset:12288
    v_mfma_f32_16x16x32_bf16 v[220:223], a[148:151], v[92:95], v[220:223]
    buffer_load_dwordx4 v[140:143], v7, s[8:11], s46 offen offset:3072 sc1
    v_mfma_f32_16x16x32_bf16 v[204:207], a[152:155], v[88:91], v[204:207]
    ds_read_b128 a[52:55], v10 offset:13312
    v_mfma_f32_16x16x32_bf16 v[224:227], a[152:155], v[92:95], v[224:227]
    v_mfma_f32_16x16x32_bf16 v[208:211], a[156:159], v[88:91], v[208:211]
    ds_read_b128 a[56:59], v10 offset:14336
    buffer_load_dwordx4 v[144:147], v26, s[8:11], s46 offen offset:0 sc1
    v_mfma_f32_16x16x32_bf16 v[228:231], a[156:159], v[92:95], v[228:231]
    s_waitcnt vmcnt(12)
    v_mfma_f32_16x16x32_bf16 v[192:195], a[160:163], v[96:99], v[192:195]
    ds_read_b128 a[60:63], v10 offset:15360
    v_mfma_f32_16x16x32_bf16 v[212:215], a[160:163], v[100:103], v[212:215]
    buffer_load_dwordx4 v[148:151], v27, s[8:11], s46 offen offset:0 sc1
    v_mfma_f32_16x16x32_bf16 v[196:199], a[164:167], v[96:99], v[196:199]
    ds_read_b128 a[64:67], v10 offset:16384
    v_mfma_f32_16x16x32_bf16 v[216:219], a[164:167], v[100:103], v[216:219]
    v_mfma_f32_16x16x32_bf16 v[200:203], a[168:171], v[96:99], v[200:203]
    ds_read_b128 a[68:71], v10 offset:17408
    v_mfma_f32_16x16x32_bf16 v[220:223], a[168:171], v[100:103], v[220:223]
    v_mfma_f32_16x16x32_bf16 v[204:207], a[172:175], v[96:99], v[204:207]
    ds_read_b128 a[72:75], v10 offset:18432
    v_mfma_f32_16x16x32_bf16 v[224:227], a[172:175], v[100:103], v[224:227]
    v_mfma_f32_16x16x32_bf16 v[208:211], a[176:179], v[96:99], v[208:211]
    ds_read_b128 a[76:79], v10 offset:19456
    v_mfma_f32_16x16x32_bf16 v[228:231], a[176:179], v[100:103], v[228:231]
    s_waitcnt vmcnt(11)
    v_mfma_f32_16x16x32_bf16 v[192:195], a[180:183], v[104:107], v[192:195]
    ds_read_b128 a[80:83], v11 offset:20480
    v_mfma_f32_16x16x32_bf16 v[212:215], a[180:183], v[108:111], v[212:215]
    v_mfma_f32_16x16x32_bf16 v[196:199], a[184:187], v[104:107], v[196:199]
    ds_read_b128 a[84:87], v11 offset:21504
    v_mfma_f32_16x16x32_bf16 v[216:219], a[184:187], v[108:111], v[216:219]
    v_mfma_f32_16x16x32_bf16 v[200:203], a[188:191], v[104:107], v[200:203]
    ds_read_b128 a[88:91], v11 offset:22528
    v_mfma_f32_16x16x32_bf16 v[220:223], a[188:191], v[108:111], v[220:223]
    v_mfma_f32_16x16x32_bf16 v[204:207], a[192:195], v[104:107], v[204:207]
    ds_read_b128 a[92:95], v11 offset:23552
    v_mfma_f32_16x16x32_bf16 v[224:227], a[192:195], v[108:111], v[224:227]
    v_mfma_f32_16x16x32_bf16 v[208:211], a[196:199], v[104:107], v[208:211]
    ds_read_b128 a[96:99], v11 offset:24576
    v_mfma_f32_16x16x32_bf16 v[228:231], a[196:199], v[108:111], v[228:231]
    s_cmp_lg_u32 s45, 0
    s_cbranch_scc1 QE_39
    s_waitcnt lgkmcnt(0)
SP_40:
    s_waitcnt vmcnt(0)
    v_cmp_eq_u32 vcc, 1, v16
    s_add_u32 s98, s98, 1
    s_cmp_ge_u32 s98, 0x40000
    s_cselect_b32 s48, -1, 0
    s_lshr_b32 s50, vcc_lo, 1
    s_and_b32 s50, s50, vcc_lo
    s_or_b32 s48, s48, s50
    s_andn2_b32 s50, s48, s49
    s_and_b32 s50, s50, 0x55
    s_cbranch_scc1 SD_41
    s_sleep 2
    buffer_load_dword v16, v17, s[80:83], 0 offen sc1
    s_waitcnt vmcnt(0)
    s_branch SP_40
SD_41:
    s_ff1_i32_b32 s47, s50
    s_bitset1_b32 s49, s47
    s_mul_i32 s46, s47, 2560
    s_lshl_b32 s47, s47, 2
    s_or_b32 s47, s47, 0x80000
    s_bfe_u32 s34, 0x48897014, s47
    s_bfe_u32 s35, 0x48197014, s47
    v_lshl_add_u32 v10, s34, 10, v30
    v_lshl_add_u32 v11, s35, 10, v30
    buffer_load_dword v16, v17, s[80:83], 0 offen sc1
    buffer_load_dwordx4 v[112:115], v6, s[8:11], s46 offen offset:0 sc1
    buffer_load_dwordx4 v[116:119], v7, s[8:11], s46 offen offset:0 sc1
    buffer_load_dwordx4 v[120:123], v6, s[8:11], s46 offen offset:1024 sc1
    buffer_load_dwordx4 v[124:127], v7, s[8:11], s46 offen offset:1024 sc1
    buffer_load_dwordx4 v[128:131], v6, s[8:11], s46 offen offset:2048 sc1
    buffer_load_dwordx4 v[132:135], v7, s[8:11], s46 offen offset:2048 sc1
    buffer_load_dwordx4 v[136:139], v6, s[8:11], s46 offen offset:3072 sc1
    buffer_load_dwordx4 v[140:143], v7, s[8:11], s46 offen offset:3072 sc1
    buffer_load_dwordx4 v[144:147], v26, s[8:11], s46 offen offset:0 sc1
    buffer_load_dwordx4 v[148:151], v27, s[8:11], s46 offen offset:0 sc1
    ds_read_b128 a[0:3], v10 offset:0
    ds_read_b128 a[4:7], v10 offset:1024
    ds_read_b128 a[8:11], v10 offset:2048
    ds_read_b128 a[12:15], v10 offset:3072
    ds_read_b128 a[16:19], v10 offset:4096
    ds_read_b128 a[20:23], v10 offset:5120
    ds_read_b128 a[24:27], v10 offset:6144
    ds_read_b128 a[28:31], v10 offset:7168
    ds_read_b128 a[32:35], v10 offset:8192
    ds_read_b128 a[36:39], v10 offset:9216
    ds_read_b128 a[40:43], v10 offset:10240
    ds_read_b128 a[44:47], v10 offset:11264
    ds_read_b128 a[48:51], v10 offset:12288
    ds_read_b128 a[52:55], v10 offset:13312
    ds_read_b128 a[56:59], v10 offset:14336
    ds_read_b128 a[60:63], v10 offset:15360
    ds_read_b128 a[64:67], v10 offset:16384
    ds_read_b128 a[68:71], v10 offset:17408
    ds_read_b128 a[72:75], v10 offset:18432
    ds_read_b128 a[76:79], v10 offset:19456
    ds_read_b128 a[80:83], v11 offset:20480
    ds_read_b128 a[84:87], v11 offset:21504
    ds_read_b128 a[88:91], v11 offset:22528
    ds_read_b128 a[92:95], v11 offset:23552
    ds_read_b128 a[96:99], v11 offset:24576
QE_39:
    s_andn2_b32 s50, s48, s49
    s_and_b32 s50, s50, 0x55
    s_cbranch_scc1 QK_42
    s_waitcnt vmcnt(10)
    v_cmp_eq_u32 vcc, 1, v16
    s_add_u32 s98, s98, 1
    s_cmp_ge_u32 s98, 0x40000
    s_cselect_b32 s48, -1, 0
    s_lshr_b32 s50, vcc_lo, 1
    s_and_b32 s50, s50, vcc_lo
    s_or_b32 s48, s48, s50
    s_andn2_b32 s50, s48, s49
    s_and_b32 s50, s50, 0x55
QK_42:
    s_mov_b32 s45, s50
    s_cbranch_scc0 QN_43
    s_ff1_i32_b32 s47, s50
    s_bitset1_b32 s49, s47
    s_mul_i32 s46, s47, 2560
    s_lshl_b32 s47, s47, 2
    s_or_b32 s47, s47, 0x80000
    s_bfe_u32 s34, 0x48897014, s47
    s_bfe_u32 s35, 0x48197014, s47
    v_lshl_add_u32 v10, s34, 10, v30
    v_lshl_add_u32 v11, s35, 10, v30
QN_43:
    s_waitcnt lgkmcnt(0)
    s_waitcnt vmcnt(8)
    v_mfma_f32_16x16x32_bf16 v[192:195], a[0:3], v[112:115], v[192:195]
    ds_read_b128 a[100:103], v10 offset:0
    v_mfma_f32_16x16x32_bf16 v[212:215], a[0:3], v[116:119], v[212:215]
    buffer_load_dword v16, v17, s[80:83], 0 offen sc1
    v_mfma_f32_16x16x32_bf16 v[196:199], a[4:7], v[112:115], v[196:199]
    ds_read_b128 a[104:107], v10 offset:1024
    v_mfma_f32_16x16x32_bf16 v[216:219], a[4:7], v[116:119], v[216:219]
    buffer_load_dwordx4 v[152:155], v6, s[8:11], s46 offen offset:0 sc1
    v_mfma_f32_16x16x32_bf16 v[200:203], a[8:11], v[112:115], v[200:203]
    ds_read_b128 a[108:111], v10 offset:2048
    v_mfma_f32_16x16x32_bf16 v[220:223], a[8:11], v[116:119], v[220:223]
    buffer_load_dwordx4 v[156:159], v7, s[8:11], s46 offen offset:0 sc1
    v_mfma_f32_16x16x32_bf16 v[204:207], a[12:15], v[112:115], v[204:207]
    ds_read_b128 a[112:115], v10 offset:3072
    v_mfma_f32_16x16x32_bf16 v[224:227], a[12:15], v[116:119], v[224:227]
    buffer_load_dwordx4 v[160:163], v6, s[8:11], s46 offen offset:1024 sc1
    v_mfma_f32_16x16x32_bf16 v[208:211], a[16:19], v[112:115], v[208:211]
    ds_read_b128 a[116:119], v10 offset:4096
    v_mfma_f32_16x16x32_bf16 v[228:231], a[16:19], v[116:119], v[228:231]
    buffer_load_dwordx4 v[164:167], v7, s[8:11], s46 offen offset:1024 sc1
    s_waitcnt vmcnt(11)
    v_mfma_f32_16x16x32_bf16 v[192:195], a[20:23], v[120:123], v[192:195]
    ds_read_b128 a[120:123], v10 offset:5120
    v_mfma_f32_16x16x32_bf16 v[212:215], a[20:23], v[124:127], v[212:215]
    buffer_load_dwordx4 v[168:171], v6, s[8:11], s46 offen offset:2048 sc1
    v_mfma_f32_16x16x32_bf16 v[196:199], a[24:27], v[120:123], v[196:199]
    ds_read_b128 a[124:127], v10 offset:6144
    v_mfma_f32_16x16x32_bf16 v[216:219], a[24:27], v[124:127], v[216:219]
    buffer_load_dwordx4 v[172:175], v7, s[8:11], s46 offen offset:2048 sc1
    v_mfma_f32_16x16x32_bf16 v[200:203], a[28:31], v[120:123], v[200:203]
    ds_read_b128 a[128:131], v10 offset:7168
    v_mfma_f32_16x16x32_bf16 v[220:223], a[28:31], v[124:127], v[220:223]
    buffer_load_dwordx4 v[176:179], v6, s[8:11], s46 offen offset:3072 sc1
    v_mfma_f32_16x16x32_bf16 v[204:207], a[32:35], v[120:123], v[204:207]
    ds_read_b128 a[132:135], v10 offset:8192
    v_mfma_f32_16x16x32_bf16 v[224:227], a[32:35], v[124:127], v[224:227]
    buffer_load_dwordx4 v[180:183], v7, s[8:11], s46 offen offset:3072 sc1
    v_mfma_f32_16x16x32_bf16 v[208:211], a[36:39], v[120:123], v[208:211]
    ds_read_b128 a[136:139], v10 offset:9216
    v_mfma_f32_16x16x32_bf16 v[228:231], a[36:39], v[124:127], v[228:231]
    buffer_load_dwordx4 v[184:187], v26, s[8:11], s46 offen offset:0 sc1
    s_waitcnt vmcnt(14)
    v_mfma_f32_16x16x32_bf16 v[192:195], a[40:43], v[128:131], v[192:195]
    ds_read_b128 a[140:143], v10 offset:10240
    v_mfma_f32_16x16x32_bf16 v[212:215], a[40:43], v[132:135], v[212:215]
    buffer_load_dwordx4 v[188:191], v27, s[8:11], s46 offen offset:0 sc1
    v_mfma_f32_16x16x32_bf16 v[196:199], a[44:47], v[128:131], v[196:199]
    ds_read_b128 a[144:147], v10 offset:11264
    v_mfma_f32_16x16x32_bf16 v[216:219], a[44:47], v[132:135], v[216:219]
    buffer_load_dwordx4 v[232:235], v8, s[16:19], 0 offen offset:0 sc1
    v_mfma_f32_16x16x32_bf16 v[200:203], a[48:51], v[128:131], v[200:203]
    ds_read_b128 a[148:151], v10 offset:12288
    v_mfma_f32_16x16x32_bf16 v[220:223], a[48:51], v[132:135], v[220:223]
    buffer_load_dwordx4 v[236:239], v8, s[16:19], 0 offen offset:1024 sc1
    v_mfma_f32_16x16x32_bf16 v[204:207], a[52:55], v[128:131], v[204:207]
    ds_read_b128 a[152:155], v10 offset:13312
    v_mfma_f32_16x16x32_bf16 v[224:227], a[52:55], v[132:135], v[224:227]
    buffer_load_dwordx4 v[240:243], v8, s[16:19], 0 offen offset:2048 sc1
    v_mfma_f32_16x16x32_bf16 v[208:211], a[56:59], v[128:131], v[208:211]
    ds_read_b128 a[156:159], v10 offset:14336
    v_mfma_f32_16x16x32_bf16 v[228:231], a[56:59], v[132:135], v[228:231]
    buffer_load_dwordx4 v[244:247], v8, s[16:19], 0 offen offset:3072 sc1
    s_waitcnt vmcnt(17)
    v_mfma_f32_16x16x32_bf16 v[192:195], a[60:63], v[136:139], v[192:195]
    ds_read_b128 a[160:163], v10 offset:15360
    v_mfma_f32_16x16x32_bf16 v[212:215], a[60:63], v[140:143], v[212:215]
    buffer_load_dwordx4 v[248:251], v9, s[16:19], 0 offen offset:0 sc1
    v_mfma_f32_16x16x32_bf16 v[196:199], a[64:67], v[136:139], v[196:199]
    ds_read_b128 a[164:167], v10 offset:16384
    v_mfma_f32_16x16x32_bf16 v[216:219], a[64:67], v[140:143], v[216:219]
    v_mfma_f32_16x16x32_bf16 v[200:203], a[68:71], v[136:139], v[200:203]
    ds_read_b128 a[168:171], v10 offset:17408
    v_mfma_f32_16x16x32_bf16 v[220:223], a[68:71], v[140:143], v[220:223]
    v_mfma_f32_16x16x32_bf16 v[204:207], a[72:75], v[136:139], v[204:207]
    ds_read_b128 a[172:175], v10 offset:18432
    v_mfma_f32_16x16x32_bf16 v[224:227], a[72:75], v[140:143], v[224:227]
    v_mfma_f32_16x16x32_bf16 v[208:211], a[76:79], v[136:139], v[208:211]
    ds_read_b128 a[176:179], v10 offset:19456
    v_mfma_f32_16x16x32_bf16 v[228:231], a[76:79], v[140:143], v[228:231]
    s_waitcnt vmcnt(16)
    v_mfma_f32_16x16x32_bf16 v[192:195], a[80:83], v[144:147], v[192:195]
    ds_read_b128 a[180:183], v11 offset:20480
    v_mfma_f32_16x16x32_bf16 v[212:215], a[80:83], v[148:151], v[212:215]
    v_mfma_f32_16x16x32_bf16 v[196:199], a[84:87], v[144:147], v[196:199]
    ds_read_b128 a[184:187], v11 offset:21504
    v_mfma_f32_16x16x32_bf16 v[216:219], a[84:87], v[148:151], v[216:219]
    v_mfma_f32_16x16x32_bf16 v[200:203], a[88:91], v[144:147], v[200:203]
    ds_read_b128 a[188:191], v11 offset:22528
    v_mfma_f32_16x16x32_bf16 v[220:223], a[88:91], v[148:151], v[220:223]
    v_mfma_f32_16x16x32_bf16 v[204:207], a[92:95], v[144:147], v[204:207]
    ds_read_b128 a[192:195], v11 offset:23552
    v_mfma_f32_16x16x32_bf16 v[224:227], a[92:95], v[148:151], v[224:227]
    v_mfma_f32_16x16x32_bf16 v[208:211], a[96:99], v[144:147], v[208:211]
    ds_read_b128 a[196:199], v11 offset:24576
    v_mfma_f32_16x16x32_bf16 v[228:231], a[96:99], v[148:151], v[228:231]
    s_cmp_lg_u32 s45, 0
    s_cbranch_scc1 QE_44
    s_waitcnt lgkmcnt(0)
SP_45:
    s_waitcnt vmcnt(0)
    v_cmp_eq_u32 vcc, 1, v16
    s_add_u32 s98, s98, 1
    s_cmp_ge_u32 s98, 0x40000
    s_cselect_b32 s48, -1, 0
    s_lshr_b32 s50, vcc_lo, 1
    s_and_b32 s50, s50, vcc_lo
    s_or_b32 s48, s48, s50
    s_andn2_b32 s50, s48, s49
    s_and_b32 s50, s50, 0x55
    s_cbranch_scc1 SD_46
    s_sleep 2
    buffer_load_dword v16, v17, s[80:83], 0 offen sc1
    s_waitcnt vmcnt(0)
    s_branch SP_45
SD_46:
    s_ff1_i32_b32 s47, s50
    s_bitset1_b32 s49, s47
    s_mul_i32 s46, s47, 2560
    s_lshl_b32 s47, s47, 2
    s_or_b32 s47, s47, 0x80000
    s_bfe_u32 s34, 0x48897014, s47
    s_bfe_u32 s35, 0x48197014, s47
    v_lshl_add_u32 v10, s34, 10, v30
    v_lshl_add_u32 v11, s35, 10, v30
    buffer_load_dword v16, v17, s[80:83], 0 offen sc1
    buffer_load_dwordx4 v[152:155], v6, s[8:11], s46 offen offset:0 sc1
    buffer_load_dwordx4 v[156:159], v7, s[8:11], s46 offen offset:0 sc1
    buffer_load_dwordx4 v[160:163], v6, s[8:11], s46 offen offset:1024 sc1
    buffer_load_dwordx4 v[164:167], v7, s[8:11], s46 offen offset:1024 sc1
    buffer_load_dwordx4 v[168:171], v6, s[8:11], s46 offen offset:2048 sc1
    buffer_load_dwordx4 v[172:175], v7, s[8:11], s46 offen offset:2048 sc1
    buffer_load_dwordx4 v[176:179], v6, s[8:11], s46 offen offset:3072 sc1
    buffer_load_dwordx4 v[180:183], v7, s[8:11], s46 offen offset:3072 sc1
    buffer_load_dwordx4 v[184:187], v26, s[8:11], s46 offen offset:0 sc1
    buffer_load_dwordx4 v[188:191], v27, s[8:11], s46 offen offset:0 sc1
    buffer_load_dwordx4 v[232:235], v8, s[16:19], 0 offen offset:0 sc1
    buffer_load_dwordx4 v[236:239], v8, s[16:19], 0 offen offset:1024 sc1
    buffer_load_dwordx4 v[240:243], v8, s[16:19], 0 offen offset:2048 sc1
    buffer_load_dwordx4 v[244:247], v8, s[16:19], 0 offen offset:3072 sc1
    buffer_load_dwordx4 v[248:251], v9, s[16:19], 0 offen offset:0 sc1
    ds_read_b128 a[100:103], v10 offset:0
    ds_read_b128 a[104:107], v10 offset:1024
    ds_read_b128 a[108:111], v10 offset:2048
    ds_read_b128 a[112:115], v10 offset:3072
    ds_read_b128 a[116:119], v10 offset:4096
    ds_read_b128 a[120:123], v10 offset:5120
    ds_read_b128 a[124:127], v10 offset:6144
    ds_read_b128 a[128:131], v10 offset:7168
    ds_read_b128 a[132:135], v10 offset:8192
    ds_read_b128 a[136:139], v10 offset:9216
    ds_read_b128 a[140:143], v10 offset:10240
    ds_read_b128 a[144:147], v10 offset:11264
    ds_read_b128 a[148:151], v10 offset:12288
    ds_read_b128 a[152:155], v10 offset:13312
    ds_read_b128 a[156:159], v10 offset:14336
    ds_read_b128 a[160:163], v10 offset:15360
    ds_read_b128 a[164:167], v10 offset:16384
    ds_read_b128 a[168:171], v10 offset:17408
    ds_read_b128 a[172:175], v10 offset:18432
    ds_read_b128 a[176:179], v10 offset:19456
    ds_read_b128 a[180:183], v11 offset:20480
    ds_read_b128 a[184:187], v11 offset:21504
    ds_read_b128 a[188:191], v11 offset:22528
    ds_read_b128 a[192:195], v11 offset:23552
    ds_read_b128 a[196:199], v11 offset:24576
QE_44:
    s_waitcnt lgkmcnt(0)
    s_waitcnt vmcnt(13)
    v_mfma_f32_16x16x32_bf16 v[192:195], a[100:103], v[152:155], v[192:195]
    v_mfma_f32_16x16x32_bf16 v[212:215], a[100:103], v[156:159], v[212:215]
    v_mfma_f32_16x16x32_bf16 v[196:199], a[104:107], v[152:155], v[196:199]
    v_mfma_f32_16x16x32_bf16 v[216:219], a[104:107], v[156:159], v[216:219]
    v_mfma_f32_16x16x32_bf16 v[200:203], a[108:111], v[152:155], v[200:203]
    v_mfma_f32_16x16x32_bf16 v[220:223], a[108:111], v[156:159], v[220:223]
    v_mfma_f32_16x16x32_bf16 v[204:207], a[112:115], v[152:155], v[204:207]
    v_mfma_f32_16x16x32_bf16 v[224:227], a[112:115], v[156:159], v[224:227]
    v_mfma_f32_16x16x32_bf16 v[208:211], a[116:119], v[152:155], v[208:211]
    v_mfma_f32_16x16x32_bf16 v[228:231], a[116:119], v[156:159], v[228:231]
    s_waitcnt vmcnt(11)
    v_mfma_f32_16x16x32_bf16 v[192:195], a[120:123], v[160:163], v[192:195]
    v_mfma_f32_16x16x32_bf16 v[212:215], a[120:123], v[164:167], v[212:215]
    v_mfma_f32_16x16x32_bf16 v[196:199], a[124:127], v[160:163], v[196:199]
    v_mfma_f32_16x16x32_bf16 v[216:219], a[124:127], v[164:167], v[216:219]
    v_mfma_f32_16x16x32_bf16 v[200:203], a[128:131], v[160:163], v[200:203]
    v_mfma_f32_16x16x32_bf16 v[220:223], a[128:131], v[164:167], v[220:223]
    v_mfma_f32_16x16x32_bf16 v[204:207], a[132:135], v[160:163], v[204:207]
    v_mfma_f32_16x16x32_bf16 v[224:227], a[132:135], v[164:167], v[224:227]
    v_mfma_f32_16x16x32_bf16 v[208:211], a[136:139], v[160:163], v[208:211]
    v_mfma_f32_16x16x32_bf16 v[228:231], a[136:139], v[164:167], v[228:231]
    s_waitcnt vmcnt(9)
    v_mfma_f32_16x16x32_bf16 v[192:195], a[140:143], v[168:171], v[192:195]
    v_mfma_f32_16x16x32_bf16 v[212:215], a[140:143], v[172:175], v[212:215]
    v_mfma_f32_16x16x32_bf16 v[196:199], a[144:147], v[168:171], v[196:199]
    v_mfma_f32_16x16x32_bf16 v[216:219], a[144:147], v[172:175], v[216:219]
    s_waitcnt vmcnt(0)
    v_mfma_f32_16x16x32_bf16 v[200:203], a[148:151], v[168:171], v[200:203]
    v_max3_u32 v18, v232, v233, v234
    v_max3_u32 v19, v235, v236, v237
    v_mfma_f32_16x16x32_bf16 v[220:223], a[148:151], v[172:175], v[220:223]
    v_max3_u32 v15, v238, v239, v240
    v_max3_u32 v18, v241, v242, v18
    v_mfma_f32_16x16x32_bf16 v[204:207], a[152:155], v[168:171], v[204:207]
    v_max3_u32 v19, v243, v244, v19
    v_max3_u32 v15, v245, v246, v15
    v_mfma_f32_16x16x32_bf16 v[224:227], a[152:155], v[172:175], v[224:227]
    v_max3_u32 v18, v247, v248, v18
    v_max3_u32 v19, v249, v250, v19
    v_mfma_f32_16x16x32_bf16 v[208:211], a[156:159], v[168:171], v[208:211]
    v_max_u32 v15, v251, v15
    v_max3_u32 v18, v18, v19, v15
    v_mfma_f32_16x16x32_bf16 v[228:231], a[156:159], v[172:175], v[228:231]
    v_cmp_eq_u32 vcc, -1, v18
    s_cbranch_vccz QE_49
    s_branch QS_C
QS_50:
    s_waitcnt vmcnt(0)
    v_max3_u32 v18, v232, v233, v234
    v_max3_u32 v19, v235, v236, v237
    v_max3_u32 v15, v238, v239, v240
    v_max3_u32 v18, v241, v242, v18
    v_max3_u32 v19, v243, v244, v19
    v_max3_u32 v15, v245, v246, v15
    v_max3_u32 v18, v247, v248, v18
    v_max3_u32 v19, v249, v250, v19
    v_max_u32 v15, v251, v15
    v_max3_u32 v18, v18, v19, v15
    v_cmp_eq_u32 vcc, -1, v18
QS_C:
    s_cbranch_vccz QE_49
    v_cmp_eq_u32 vcc, 1, v16
    s_add_u32 s98, s98, 1
    s_cmp_ge_u32 s98, 0x40000
    s_cselect_b32 s48, -1, 0
    s_lshr_b32 s50, vcc_lo, 1
    s_and_b32 s50, s50, vcc_lo
    s_or_b32 s48, s48, s50
    s_andn2_b32 s50, s48, s49
    s_and_b32 s50, s50, 0x100
    buffer_load_dword v16, v17, s[80:83], 0 offen sc1
    buffer_load_dwordx4 v[232:235], v8, s[16:19], 0 offen offset:0 sc1
    buffer_load_dwordx4 v[236:239], v8, s[16:19], 0 offen offset:1024 sc1
    buffer_load_dwordx4 v[240:243], v8, s[16:19], 0 offen offset:2048 sc1
    buffer_load_dwordx4 v[244:247], v8, s[16:19], 0 offen offset:3072 sc1
    buffer_load_dwordx4 v[248:251], v9, s[16:19], 0 offen offset:0 sc1
    s_cbranch_scc0 QS_50
QE_49:
    s_waitcnt vmcnt(0)
    v_mfma_f32_16x16x32_bf16 v[192:195], a[160:163], v[176:179], v[192:195]
    v_mfma_f32_16x16x32_bf16 v[196:199], a[164:167], v[176:179], v[196:199]
    v_mfma_f32_16x16x32_bf16 v[192:195], a[180:183], v[184:187], v[192:195]
    v_mfma_f32_16x16x32_bf16 v[196:199], a[184:187], v[184:187], v[196:199]
    v_mfma_f32_16x16x32_bf16 v[192:195], v[22:25], v[232:235], v[192:195]
    v_mfma_f32_16x16x32_bf16 v[196:199], v[20:23], v[232:235], v[196:199]
    v_mfma_f32_16x16x32_bf16 v[200:203], a[168:171], v[176:179], v[200:203]
    v_mfma_f32_16x16x32_bf16 v[204:207], a[172:175], v[176:179], v[204:207]
    v_mfma_f32_16x16x32_bf16 v[200:203], a[188:191], v[184:187], v[200:203]
    v_mfma_f32_16x16x32_bf16 v[204:207], a[192:195], v[184:187], v[204:207]
    s_nop 1
    s_nop 0
    v_cvt_pk_bf16_f32 v32, v192, v193
    v_cvt_pk_bf16_f32 v33, v194, v195
    v_cvt_pk_bf16_f32 v34, v196, v197
    v_cvt_pk_bf16_f32 v35, v198, v199
    s_nop 0
    v_permlane16_swap_b32 v32, v34
    v_permlane16_swap_b32 v33, v35
    buffer_store_dwordx4 v[32:35], v12, s[40:43], 0 offen offset:0
    v_mfma_f32_16x16x32_bf16 v[200:203], v[22:25], v[236:239], v[200:203]
    v_mfma_f32_16x16x32_bf16 v[204:207], v[20:23], v[236:239], v[204:207]
    v_mfma_f32_16x16x32_bf16 v[212:215], a[160:163], v[180:183], v[212:215]
    v_mfma_f32_16x16x32_bf16 v[216:219], a[164:167], v[180:183], v[216:219]
    v_mfma_f32_16x16x32_bf16 v[212:215], a[180:183], v[188:191], v[212:215]
    v_mfma_f32_16x16x32_bf16 v[216:219], a[184:187], v[188:191], v[216:219]
    s_nop 1
    s_nop 0
    v_cvt_pk_bf16_f32 v36, v200, v201
    v_cvt_pk_bf16_f32 v37, v202, v203
    v_cvt_pk_bf16_f32 v38, v204, v205
    v_cvt_pk_bf16_f32 v39, v206, v207
    s_nop 0
    v_permlane16_swap_b32 v36, v38
    v_permlane16_swap_b32 v37, v39
    buffer_store_dwordx4 v[36:39], v12, s[40:43], 0 offen offset:64
    v_mfma_f32_16x16x32_bf16 v[212:215], v[22:25], v[240:243], v[212:215]
    v_mfma_f32_16x16x32_bf16 v[216:219], v[20:23], v[240:243], v[216:219]
    v_mfma_f32_16x16x32_bf16 v[220:223], a[168:171], v[180:183], v[220:223]
    v_mfma_f32_16x16x32_bf16 v[224:227], a[172:175], v[180:183], v[224:227]
    v_mfma_f32_16x16x32_bf16 v[220:223], a[188:191], v[188:191], v[220:223]
    v_mfma_f32_16x16x32_bf16 v[224:227], a[192:195], v[188:191], v[224:227]
    s_nop 1
    s_nop 0
    v_cvt_pk_bf16_f32 v40, v212, v213
    v_cvt_pk_bf16_f32 v41, v214, v215
    v_cvt_pk_bf16_f32 v42, v216, v217
    v_cvt_pk_bf16_f32 v43, v218, v219
    s_nop 0
    v_permlane16_swap_b32 v40, v42
    v_permlane16_swap_b32 v41, v43
    buffer_store_dwordx4 v[40:43], v13, s[40:43], 0 offen offset:0
    v_mfma_f32_16x16x32_bf16 v[220:223], v[22:25], v[244:247], v[220:223]
    v_mfma_f32_16x16x32_bf16 v[224:227], v[20:23], v[244:247], v[224:227]
    v_mfma_f32_16x16x32_bf16 v[208:211], a[176:179], v[176:179], v[208:211]
    v_mfma_f32_16x16x32_bf16 v[228:231], a[176:179], v[180:183], v[228:231]
    v_mfma_f32_16x16x32_bf16 v[208:211], a[196:199], v[184:187], v[208:211]
    v_mfma_f32_16x16x32_bf16 v[228:231], a[196:199], v[188:191], v[228:231]
    s_nop 1
    s_nop 0
    v_cvt_pk_bf16_f32 v44, v220, v221
    v_cvt_pk_bf16_f32 v45, v222, v223
    v_cvt_pk_bf16_f32 v46, v224, v225
    v_cvt_pk_bf16_f32 v47, v226, v227
    s_nop 0
    v_permlane16_swap_b32 v44, v46
    v_permlane16_swap_b32 v45, v47
    buffer_store_dwordx4 v[44:47], v13, s[40:43], 0 offen offset:64
    v_mfma_f32_16x16x32_bf16 v[208:211], v[22:25], v[248:251], v[208:211]
    v_mfma_f32_16x16x32_bf16 v[228:231], v[20:23], v[248:251], v[228:231]
    s_nop 7
    v_cvt_pk_bf16_f32 v48, v208, v209
    v_cvt_pk_bf16_f32 v49, v210, v211
    v_cvt_pk_bf16_f32 v50, v228, v229
    v_cvt_pk_bf16_f32 v51, v230, v231
    s_nop 0
    v_permlane16_swap_b32 v48, v50
    v_permlane16_swap_b32 v49, v51
    buffer_store_dwordx4 v[48:51], v14, s[40:43], 0 offen offset:0
    s_branch KF_END
K1_QH:
    s_lshl_b32 s23, s21, 3
    s_lshl_b32 s36, s20, 1
    s_add_u32 s23, s23, s36
    s_mul_i32 s36, s23, 20480
    v_lshrrev_b32 v24, 3, v1
    v_mul_u32_u24 v25, 1280, v24
    v_add_u32 v25, s36, v25
    v_and_b32 v26, 7, v1
    v_xor_b32 v26, v26, v2
    v_lshl_add_u32 v6, v26, 4, v25
    v_xor_b32 v26, 4, v26
    v_lshl_add_u32 v7, v26, 4, v25
    v_add_u32 v9, 27648, v7
    v_add_u32 v7, 9216, v7
    v_add_u32 v8, 18432, v6
    s_lshl_b32 s47, s20, 12
    s_add_u32 s47, s47, 73728
    s_add_u32 s32, s21, s22
    s_add_u32 s32, s32, 8
    s_cmp_ge_u32 s32, 20
    s_cselect_b32 s36, 20, 0
    s_sub_u32 s32, s32, s36
    s_cmp_ge_u32 s32, 10
    s_cselect_b32 s36, 10, 0
    s_sub_u32 s32, s32, s36
    s_mul_i32 s49, s22, 12800
    s_add_u32 s49, s49, 233472
    s_mul_i32 s50, s21, 10240
    s_add_u32 s50, s50, 360448
    s_mul_i32 s45, s32, 1280
    s_add_u32 s45, s45, s49
    s_lshl_b32 s46, s32, 10
    s_add_u32 s46, s46, s50
    s_lshl_b32 s32, s32, 7
    s_mul_i32 s35, s22, 384
    s_mul_i32 s36, s20, 384
    s_mul_i32 s34, s20, 6144
    s_waitcnt lgkmcnt(0)
    s_mov_b32 s88, s64
    s_mov_b32 s89, s65
    s_mov_b32 s90, 0x00280000
    s_mov_b32 s91, 0x00020000
    s_add_u32 m0, s47, 0
    s_nop 0
    buffer_load_dwordx4 v6, s[88:91], s32 offen offset:0 lds
    buffer_load_dwordx4 v7, s[88:91], s32 offen offset:1024 lds
    buffer_load_dwordx4 v8, s[88:91], s32 offen offset:2048 lds
    buffer_load_dwordx4 v9, s[88:91], s32 offen offset:3072 lds
    s_mov_b32 s40, s28
    s_mov_b32 s41, s29
    s_mov_b32 s42, 0x001e0000
    s_mov_b32 s43, 0x00020000
    v_add_u32 v24, s36, v1
    v_mul_u32_u24 v25, 43691, v24
    v_lshrrev_b32 v25, 20, v25
    v_mul_u32_u24 v26, 24, v25
    v_sub_u32 v26, v24, v26
    v_bfe_u32 v27, v25, 2, 1
    v_bfe_u32 v28, v25, 3, 1
    v_xor_b32 v27, v27, v28
    v_mul_u32_u24 v27, 12, v27
    v_xor_b32 v27, v27, v25
    v_mul_u32_u24 v10, 3072, v27
    v_bfe_u32 v28, v25, 1, 2
    v_lshlrev_b32 v28, 1, v28
    v_xor_b32 v26, v26, v28
    v_lshl_add_u32 v10, v26, 4, v10
    v_add_u32 v10, s35, v10
    s_mul_i32 s33, s32, 1536
    s_add_u32 m0, s34, 0
    s_nop 0
    buffer_load_dwordx4 v10, s[40:43], s33 offen offset:0 lds
    v_add_u32 v24, s36, v1
    v_add_u32 v24, 64, v24
    v_mul_u32_u24 v25, 43691, v24
    v_lshrrev_b32 v25, 20, v25
    v_mul_u32_u24 v26, 24, v25
    v_sub_u32 v26, v24, v26
    v_bfe_u32 v27, v25, 2, 1
    v_bfe_u32 v28, v25, 3, 1
    v_xor_b32 v27, v27, v28
    v_mul_u32_u24 v27, 12, v27
    v_xor_b32 v27, v27, v25
    v_mul_u32_u24 v11, 3072, v27
    v_bfe_u32 v28, v25, 1, 2
    v_lshlrev_b32 v28, 1, v28
    v_xor_b32 v26, v26, v28
    v_lshl_add_u32 v11, v26, 4, v11
    v_add_u32 v11, s35, v11
    v_subrev_u32 v11, 1024, v11
    buffer_load_dwordx4 v11, s[40:43], s33 offen offset:1024 lds
    v_add_u32 v24, s36, v1
    v_add_u32 v24, 128, v24
    v_mul_u32_u24 v25, 43691, v24
    v_lshrrev_b32 v25, 20, v25
    v_mul_u32_u24 v26, 24, v25
    v_sub_u32 v26, v24, v26
    v_bfe_u32 v27, v25, 2, 1
    v_bfe_u32 v28, v25, 3, 1
    v_xor_b32 v27, v27, v28
    v_mul_u32_u24 v27, 12, v27
    v_xor_b32 v27, v27, v25
    v_mul_u32_u24 v12, 3072, v27
    v_bfe_u32 v28, v25, 1, 2
    v_lshlrev_b32 v28, 1, v28
    v_xor_b32 v26, v26, v28
    v_lshl_add_u32 v12, v26, 4, v12
    v_add_u32 v12, s35, v12
    v_subrev_u32 v12, 2048, v12
    buffer_load_dwordx4 v12, s[40:43], s33 offen offset:2048 lds
    v_add_u32 v24, s36, v1
    v_add_u32 v24, 192, v24
    v_mul_u32_u24 v25, 43691, v24
    v_lshrrev_b32 v25, 20, v25
    v_mul_u32_u24 v26, 24, v25
    v_sub_u32 v26, v24, v26
    v_bfe_u32 v27, v25, 2, 1
    v_bfe_u32 v28, v25, 3, 1
    v_xor_b32 v27, v27, v28
    v_mul_u32_u24 v27, 12, v27
    v_xor_b32 v27, v27, v25
    v_mul_u32_u24 v13, 3072, v27
    v_bfe_u32 v28, v25, 1, 2
    v_lshlrev_b32 v28, 1, v28
    v_xor_b32 v26, v26, v28
    v_lshl_add_u32 v13, v26, 4, v13
    v_add_u32 v13, s35, v13
    v_subrev_u32 v13, 3072, v13
    buffer_load_dwordx4 v13, s[40:43], s33 offen offset:3072 lds
    v_add_u32 v24, s36, v1
    v_add_u32 v24, 256, v24
    v_mul_u32_u24 v25, 43691, v24
    v_lshrrev_b32 v25, 20, v25
    v_mul_u32_u24 v26, 24, v25
    v_sub_u32 v26, v24, v26
    v_bfe_u32 v27, v25, 2, 1
    v_bfe_u32 v28, v25, 3, 1
    v_xor_b32 v27, v27, v28
    v_mul_u32_u24 v27, 12, v27
    v_xor_b32 v27, v27, v25
    v_mul_u32_u24 v14, 3072, v27
    v_bfe_u32 v28, v25, 1, 2
    v_lshlrev_b32 v28, 1, v28
    v_xor_b32 v26, v26, v28
    v_lshl_add_u32 v14, v26, 4, v14
    v_add_u32 v14, s35, v14
    s_add_u32 m0, s34, 4096
    s_nop 0
    buffer_load_dwordx4 v14, s[40:43], s33 offen offset:0 lds
    v_add_u32 v24, s36, v1
    v_add_u32 v24, 320, v24
    v_mul_u32_u24 v25, 43691, v24
    v_lshrrev_b32 v25, 20, v25
    v_mul_u32_u24 v26, 24, v25
    v_sub_u32 v26, v24, v26
    v_bfe_u32 v27, v25, 2, 1
    v_bfe_u32 v28, v25, 3, 1
    v_xor_b32 v27, v27, v28
    v_mul_u32_u24 v27, 12, v27
    v_xor_b32 v27, v27, v25
    v_mul_u32_u24 v15, 3072, v27
    v_bfe_u32 v28, v25, 1, 2
    v_lshlrev_b32 v28, 1, v28
    v_xor_b32 v26, v26, v28
    v_lshl_add_u32 v15, v26, 4, v15
    v_add_u32 v15, s35, v15
    v_subrev_u32 v15, 1024, v15
    buffer_load_dwordx4 v15, s[40:43], s33 offen offset:1024 lds
    s_add_u32 s32, s32, 128
    s_cmpk_eq_u32 s32, 1280
    s_cselect_b32 s32, 0, s32
    s_add_u32 m0, s47, 16384
    s_nop 0
    buffer_load_dwordx4 v6, s[88:91], s32 offen offset:0 lds
    buffer_load_dwordx4 v7, s[88:91], s32 offen offset:1024 lds
    buffer_load_dwordx4 v8, s[88:91], s32 offen offset:2048 lds
    buffer_load_dwordx4 v9, s[88:91], s32 offen offset:3072 lds
    s_mov_b64 s[24:25], s[76:77]
    s_mov_b32 s84, s74
    s_mov_b32 s85, s75
    s_mov_b32 s86, 0x00000100
    s_mov_b32 s87, 0x00020000
    s_add_u32 s80, s76, 0x01400000
    s_addc_u32 s81, s77, 0
    s_mov_b32 s82, 0x00080000
    s_mov_b32 s83, 0x00020000
    s_mov_b32 s16, s30
    s_mov_b32 s17, s31
    s_mov_b32 s18, 0x00000c00
    s_mov_b32 s19, 0x00020000
    v_min_u32 v242, 95, v0
    v_lshlrev_b32 v242, 2, v242
    buffer_load_dword v240, v242, s[16:19], s35 offen
    v_lshlrev_b32 v24, 1, v242
    v_add_u32 v241, 161024, v24
    v_mov_b32 v96, 0x3f803f80
    v_accvgpr_write_b32 a48, v96
    v_accvgpr_write_b32 a49, v96
    v_accvgpr_write_b32 a50, v96
    v_accvgpr_write_b32 a51, v96
    s_lshl_b32 s57, s21, 9
    s_lshr_b32 s36, s22, 1
    s_lshl_b32 s36, s36, 7
    s_add_u32 s57, s57, s36
    s_and_b32 s36, s22, 1
    s_lshl_b32 s36, s36, 4
    s_add_u32 s57, s57, s36
    s_lshl_b32 s36, s20, 2
    s_add_u32 s57, s57, s36
    s_lshl_b32 s58, s2, 7
    s_add_u32 s58, s58, 65536
    v_lshrrev_b32 v24, 1, v2
    v_lshlrev_b32 v24, 4, v24
    v_and_b32 v25, 1, v2
    v_lshl_add_u32 v24, v25, 2, v24
    v_add_u32 v24, v24, v4
    s_mul_i32 s33, s32, 1536
    s_add_u32 m0, s34, 24576
    s_nop 0
    buffer_load_dwordx4 v10, s[40:43], s33 offen offset:0 lds
    v_mul_u32_u24 v24, 384, v24
    v_lshl_add_u32 v24, v5, 3, v24
    v_lshrrev_b32 v26, 1, v4
    v_lshl_or_b32 v25, v25, 1, v26
    v_xor_b32 v26, 0, v25
    v_subrev_u32 v26, 0, v26
    v_lshl_add_u32 v96, v26, 5, v24
    v_xor_b32 v26, 1, v25
    v_subrev_u32 v26, 1, v26
    v_lshl_add_u32 v97, v26, 5, v24
    v_xor_b32 v26, 2, v25
    v_subrev_u32 v26, 2, v26
    v_lshl_add_u32 v98, v26, 5, v24
    v_xor_b32 v26, 3, v25
    v_subrev_u32 v26, 3, v26
    v_lshl_add_u32 v99, v26, 5, v24
    v_lshrrev_b32 v24, 1, v3
    v_xor_b32 v24, v24, v2
    v_lshlrev_b32 v24, 4, v24
    v_lshl_add_u32 v24, v3, 7, v24
    v_add_u32 v22, s47, v24
    v_xor_b32 v24, 64, v24
    v_add_u32 v23, s47, v24
    v_lshlrev_b32 v30, 4, v1
    s_bfe_u32 s36, s2, 0x30004
    s_bfe_u32 s37, s2, 0x20002
    s_and_b32 s38, s2, 3
    buffer_load_dwordx4 v11, s[40:43], s33 offen offset:1024 lds
    s_mul_i32 s39, s37, 12
    s_mul_i32 s3, s38, 3
    s_add_u32 s39, s39, s3
    s_add_u32 s39, s39, s20
    s_lshl_b32 s92, s39, 5
    s_mul_i32 s93, s37, 160
    s_lshl_b32 s3, s38, 5
    s_add_u32 s93, s93, s3
    s_cmp_eq_u32 s38, 3
    s_cselect_b32 s3, 16, 0
    s_sub_u32 s93, s93, s3
    s_mul_i32 s94, s37, 5
    s_add_u32 s94, s94, s38
    s_add_u32 s94, s94, 48
    s_cmp_eq_u32 s38, 2
    s_cselect_b32 s95, 81920, 0
    s_cmp_eq_u32 s38, 0
    s_mov_b32 s3, 0x7f000000
    s_cselect_b32 s96, 143360, s3
    s_cselect_b32 s97, 20480, s3
    s_cmp_eq_u32 s20, 3
    s_cselect_b32 s92, s93, s92
    s_cselect_b32 s39, s94, s39
    s_cselect_b32 s95, s95, 0
    s_cselect_b32 s96, s96, 0x7f000000
    s_cselect_b32 s97, s97, 0x7f000000
    s_cselect_b32 s52, s66, s68
    s_cselect_b32 s53, s67, s69
    s_mov_b32 s54, 1966080
    s_cselect_b32 s54, 819200, s54
    s_mov_b32 s55, 0x00020000
    s_mov_b32 s44, 148480
    s_cselect_b32 s44, 143360, s44
    buffer_load_dwordx4 v12, s[40:43], s33 offen offset:2048 lds
    s_mul_i32 s92, s92, 1280
    s_mul_i32 s3, s36, 160
    s_add_u32 s92, s92, s3
    s_mul_i32 s36, s36, 68
    s_add_u32 s36, s36, s39
    s_mul_i32 s36, s36, 5120
    s_add_u32 s12, s24, 0x01500000
    s_addc_u32 s13, s25, 0
    s_mov_b32 s14, 0x002a8000
    s_mov_b32 s15, 0x00020000
    v_add_u32 v24, 0, v1
    v_mul_u32_u24 v25, 6554, v24
    v_lshrrev_b32 v25, 16, v25
    v_mul_u32_u24 v26, 10, v25
    v_sub_u32 v26, v24, v26
    v_mul_u32_u24 v212, 1280, v25
    v_lshl_add_u32 v212, v26, 4, v212
    v_add_u32 v212, s92, v212
    v_add_u32 v217, s96, v212
    v_add_u32 v24, 64, v1
    v_mul_u32_u24 v25, 6554, v24
    buffer_load_dwordx4 v13, s[40:43], s33 offen offset:3072 lds
    v_lshrrev_b32 v25, 16, v25
    v_mul_u32_u24 v26, 10, v25
    v_sub_u32 v26, v24, v26
    v_mul_u32_u24 v213, 1280, v25
    v_lshl_add_u32 v213, v26, 4, v213
    v_add_u32 v213, s92, v213
    v_subrev_u32 v213, 1024, v213
    v_add_u32 v218, s96, v213
    v_add_u32 v24, 128, v1
    v_mul_u32_u24 v25, 6554, v24
    v_lshrrev_b32 v25, 16, v25
    v_mul_u32_u24 v26, 10, v25
    v_sub_u32 v26, v24, v26
    v_mul_u32_u24 v214, 1280, v25
    v_lshl_add_u32 v214, v26, 4, v214
    v_add_u32 v214, s92, v214
    v_subrev_u32 v214, 2048, v214
    v_mov_b32 v24, s95
    v_cmp_lt_u32 vcc, 31, v1
    s_nop 1
    v_cndmask_b32 v24, 0, v24, vcc
    v_add_u32 v214, v24, v214
    v_add_u32 v219, s96, v214
    v_add_u32 v24, 192, v1
    v_mul_u32_u24 v25, 6554, v24
    v_lshrrev_b32 v25, 16, v25
    v_mul_u32_u24 v26, 10, v25
    v_sub_u32 v26, v24, v26
    s_add_u32 m0, s34, 28672
    s_nop 0
    buffer_load_dwordx4 v14, s[40:43], s33 offen offset:0 lds
    v_mul_u32_u24 v215, 1280, v25
    v_lshl_add_u32 v215, v26, 4, v215
    v_add_u32 v215, s92, v215
    v_subrev_u32 v215, 3072, v215
    v_add_u32 v215, s95, v215
    v_add_u32 v220, s96, v215
    v_add_u32 v24, 256, v1
    v_mul_u32_u24 v25, 6554, v24
    v_lshrrev_b32 v25, 16, v25
    v_mul_u32_u24 v26, 10, v25
    v_sub_u32 v26, v24, v26
    v_mul_u32_u24 v216, 1280, v25
    v_lshl_add_u32 v216, v26, 4, v216
    v_add_u32 v216, s92, v216
    v_add_u32 v216, s95, v216
    v_add_u32 v221, s96, v216
    s_mul_i32 s56, s20, 5120
    s_add_u32 s56, s56, 122880
    v_lshl_add_u32 v24, v2, 2, v4
    v_mul_u32_u24 v24, 160, v24
    v_lshl_add_u32 v24, v5, 3, v24
    v_add_u32 v200, s56, v24
    v_add_u32 v201, s44, v24
    v_add_u32 v202, s36, v30
    v_add_u32 v203, 4096, v202
    v_add_u32 v204, s97, v202
    v_add_u32 v205, s97, v203
    buffer_load_dwordx4 v15, s[40:43], s33 offen offset:1024 lds
    s_waitcnt vmcnt(11)
    s_barrier
    ds_read_b128 v[32:35], v22 offset:0
    ds_read_b128 v[36:39], v23 offset:0
    ds_read_b128 v[40:43], v22 offset:2048
    ds_read_b128 v[44:47], v23 offset:2048
    ds_read_b64_tr_b16 v[64:65], v96 offset:0
    ds_read_b64_tr_b16 v[66:67], v96 offset:3072
    ds_read_b64_tr_b16 v[68:69], v96 offset:12288
    ds_read_b64_tr_b16 v[70:71], v96 offset:15360
    ds_read_b64_tr_b16 v[72:73], v97 offset:32
    ds_read_b64_tr_b16 v[74:75], v97 offset:3104
    ds_read_b64_tr_b16 v[76:77], v97 offset:12320
    ds_read_b64_tr_b16 v[78:79], v97 offset:15392
    ds_read_b64_tr_b16 v[80:81], v98 offset:64
    ds_read_b64_tr_b16 v[82:83], v98 offset:3136
    ds_read_b64_tr_b16 v[84:85], v98 offset:12352
    ds_read_b64_tr_b16 v[86:87], v98 offset:15424
    s_lshl_b32 s3, s20, 2
    s_add_u32 s3, s3, s99
    s_cmp_ge_u32 s3, 4
    s_cbranch_scc1 ZS_51
    v_mov_b32 v24, 1
    s_mov_b64 exec, 1
    buffer_store_byte v24, off, s[84:87], s99 sc1
    s_mov_b64 exec, -1
ZS_51:
    s_waitcnt lgkmcnt(8)
    s_add_u32 s32, s32, 128
    s_cmpk_eq_u32 s32, 1280
    s_cselect_b32 s32, 0, s32
    s_add_u32 m0, s47, 32768
    v_mfma_f32_16x16x32_bf16 v[104:107], v[64:67], v[32:35], 0
    ds_read_b64_tr_b16 v[88:89], v99 offset:96
    buffer_load_dwordx4 v6, s[88:91], s32 offen offset:0 lds
    v_mfma_f32_16x16x32_bf16 v[152:155], v[64:67], v[40:43], 0
    ds_read_b64_tr_b16 v[90:91], v99 offset:3168
    v_mfma_f32_16x16x32_bf16 v[104:107], v[68:71], v[36:39], v[104:107]
    ds_read_b64_tr_b16 v[92:93], v99 offset:12384
    buffer_load_dwordx4 v7, s[88:91], s32 offen offset:1024 lds
    v_mfma_f32_16x16x32_bf16 v[152:155], v[68:71], v[44:47], v[152:155]
    ds_read_b64_tr_b16 v[94:95], v99 offset:15456
    s_cmp_lg_u32 s20, 0
    s_cbranch_scc1 SK_52
    v_mfma_f32_16x16x32_bf16 a[68:71], v[64:67], a[48:51], 0
    v_mfma_f32_16x16x32_bf16 a[68:71], v[68:71], a[48:51], a[68:71]
SK_52:
    s_waitcnt lgkmcnt(8)
    v_mfma_f32_16x16x32_bf16 v[108:111], v[72:75], v[32:35], 0
    ds_read_b64_tr_b16 v[64:65], v96 offset:128
    buffer_load_dwordx4 v8, s[88:91], s32 offen offset:2048 lds
    v_mfma_f32_16x16x32_bf16 v[156:159], v[72:75], v[40:43], 0
    ds_read_b64_tr_b16 v[66:67], v96 offset:3200
    v_mfma_f32_16x16x32_bf16 v[108:111], v[76:79], v[36:39], v[108:111]
    ds_read_b64_tr_b16 v[68:69], v96 offset:12416
    buffer_load_dwordx4 v9, s[88:91], s32 offen offset:3072 lds
    v_mfma_f32_16x16x32_bf16 v[156:159], v[76:79], v[44:47], v[156:159]
    ds_read_b64_tr_b16 v[70:71], v96 offset:15488
    v_mfma_f32_16x16x32_bf16 a[52:55], a[48:51], v[32:35], 0
    s_cmp_lg_u32 s20, 1
    s_cbranch_scc1 SK_53
    v_mfma_f32_16x16x32_bf16 a[68:71], v[72:75], a[48:51], 0
    v_mfma_f32_16x16x32_bf16 a[68:71], v[76:79], a[48:51], a[68:71]
SK_53:
    s_waitcnt lgkmcnt(8)
    s_mul_i32 s33, s32, 1536
    s_add_u32 m0, s34, 49152
    v_mfma_f32_16x16x32_bf16 v[112:115], v[80:83], v[32:35], 0
    ds_read_b64_tr_b16 v[72:73], v97 offset:160
    buffer_load_dwordx4 v10, s[40:43], s33 offen offset:0 lds
    v_mfma_f32_16x16x32_bf16 v[160:163], v[80:83], v[40:43], 0
    ds_read_b64_tr_b16 v[74:75], v97 offset:3232
    v_mfma_f32_16x16x32_bf16 v[112:115], v[84:87], v[36:39], v[112:115]
    ds_read_b64_tr_b16 v[76:77], v97 offset:12448
    buffer_load_dwordx4 v11, s[40:43], s33 offen offset:1024 lds
    v_mfma_f32_16x16x32_bf16 v[160:163], v[84:87], v[44:47], v[160:163]
    ds_read_b64_tr_b16 v[78:79], v97 offset:15520
    v_mfma_f32_16x16x32_bf16 a[56:59], a[48:51], v[40:43], 0
    s_cmp_lg_u32 s20, 2
    s_cbranch_scc1 SK_54
    v_mfma_f32_16x16x32_bf16 a[68:71], v[80:83], a[48:51], 0
    v_mfma_f32_16x16x32_bf16 a[68:71], v[84:87], a[48:51], a[68:71]
SK_54:
    s_waitcnt lgkmcnt(8)
    v_mfma_f32_16x16x32_bf16 v[116:119], v[88:91], v[32:35], 0
    ds_read_b64_tr_b16 v[80:81], v98 offset:192
    buffer_load_dwordx4 v12, s[40:43], s33 offen offset:2048 lds
    v_mfma_f32_16x16x32_bf16 v[164:167], v[88:91], v[40:43], 0
    ds_read_b64_tr_b16 v[82:83], v98 offset:3264
    v_mfma_f32_16x16x32_bf16 v[116:119], v[92:95], v[36:39], v[116:119]
    ds_read_b64_tr_b16 v[84:85], v98 offset:12480
    buffer_load_dwordx4 v13, s[40:43], s33 offen offset:3072 lds
    v_mfma_f32_16x16x32_bf16 v[164:167], v[92:95], v[44:47], v[164:167]
    ds_read_b64_tr_b16 v[86:87], v98 offset:15552
    v_mfma_f32_16x16x32_bf16 a[60:63], v[32:35], v[32:35], 0
    s_cmp_lg_u32 s20, 3
    s_cbranch_scc1 SK_55
    v_mfma_f32_16x16x32_bf16 a[68:71], v[88:91], a[48:51], 0
    v_mfma_f32_16x16x32_bf16 a[68:71], v[92:95], a[48:51], a[68:71]
SK_55:
    s_waitcnt lgkmcnt(8)
    s_add_u32 m0, s34, 53248
    v_mfma_f32_16x16x32_bf16 v[120:123], v[64:67], v[32:35], 0
    ds_read_b64_tr_b16 v[88:89], v99 offset:224
    buffer_load_dwordx4 v14, s[40:43], s33 offen offset:0 lds
    v_mfma_f32_16x16x32_bf16 v[168:171], v[64:67], v[40:43], 0
    ds_read_b64_tr_b16 v[90:91], v99 offset:3296
    v_mfma_f32_16x16x32_bf16 v[120:123], v[68:71], v[36:39], v[120:123]
    ds_read_b64_tr_b16 v[92:93], v99 offset:12512
    buffer_load_dwordx4 v15, s[40:43], s33 offen offset:1024 lds
    v_mfma_f32_16x16x32_bf16 v[168:171], v[68:71], v[44:47], v[168:171]
    ds_read_b64_tr_b16 v[94:95], v99 offset:15584
    v_mfma_f32_16x16x32_bf16 a[64:67], v[40:43], v[40:43], 0
    s_cmp_lg_u32 s20, 0
    s_cbranch_scc1 SK_56
    v_mfma_f32_16x16x32_bf16 a[72:75], v[64:67], a[48:51], 0
    v_mfma_f32_16x16x32_bf16 a[72:75], v[68:71], a[48:51], a[72:75]
SK_56:
    s_waitcnt lgkmcnt(8)
    s_mov_b32 m0, s56
    v_mfma_f32_16x16x32_bf16 v[124:127], v[72:75], v[32:35], 0
    ds_read_b64_tr_b16 v[64:65], v96 offset:256
    buffer_load_dwordx4 v212, s[52:55], 0 offen offset:0 lds
    v_mfma_f32_16x16x32_bf16 v[172:175], v[72:75], v[40:43], 0
    ds_read_b64_tr_b16 v[66:67], v96 offset:3328
    v_mfma_f32_16x16x32_bf16 v[124:127], v[76:79], v[36:39], v[124:127]
    ds_read_b64_tr_b16 v[68:69], v96 offset:12544
    buffer_load_dwordx4 v213, s[52:55], 0 offen offset:1024 lds
    v_mfma_f32_16x16x32_bf16 v[172:175], v[76:79], v[44:47], v[172:175]
    ds_read_b64_tr_b16 v[70:71], v96 offset:15616
    v_mfma_f32_16x16x32_bf16 a[52:55], a[48:51], v[36:39], a[52:55]
    s_cmp_lg_u32 s20, 1
    s_cbranch_scc1 SK_57
    v_mfma_f32_16x16x32_bf16 a[72:75], v[72:75], a[48:51], 0
    v_mfma_f32_16x16x32_bf16 a[72:75], v[76:79], a[48:51], a[72:75]
SK_57:
    s_waitcnt lgkmcnt(8)
    v_mfma_f32_16x16x32_bf16 v[128:131], v[80:83], v[32:35], 0
    ds_read_b64_tr_b16 v[72:73], v97 offset:288
    buffer_load_dwordx4 v214, s[52:55], 0 offen offset:2048 lds
    v_mfma_f32_16x16x32_bf16 v[176:179], v[80:83], v[40:43], 0
    ds_read_b64_tr_b16 v[74:75], v97 offset:3360
    v_mfma_f32_16x16x32_bf16 v[128:131], v[84:87], v[36:39], v[128:131]
    ds_read_b64_tr_b16 v[76:77], v97 offset:12576
    buffer_load_dwordx4 v215, s[52:55], 0 offen offset:3072 lds
    v_mfma_f32_16x16x32_bf16 v[176:179], v[84:87], v[44:47], v[176:179]
    ds_read_b64_tr_b16 v[78:79], v97 offset:15648
    v_mfma_f32_16x16x32_bf16 a[56:59], a[48:51], v[44:47], a[56:59]
    s_cmp_lg_u32 s20, 2
    s_cbranch_scc1 SK_58
    v_mfma_f32_16x16x32_bf16 a[72:75], v[80:83], a[48:51], 0
    v_mfma_f32_16x16x32_bf16 a[72:75], v[84:87], a[48:51], a[72:75]
SK_58:
    s_waitcnt lgkmcnt(8)
    s_add_u32 m0, s56, 4096
    v_mfma_f32_16x16x32_bf16 v[132:135], v[88:91], v[32:35], 0
    ds_read_b64_tr_b16 v[80:81], v98 offset:320
    buffer_load_dwordx4 v216, s[52:55], 0 offen offset:0 lds
    v_mfma_f32_16x16x32_bf16 v[180:183], v[88:91], v[40:43], 0
    ds_read_b64_tr_b16 v[82:83], v98 offset:3392
    s_bitcmp1_b32 s97, 30
    s_cbranch_scc1 SK_59
    s_mov_b32 m0, s44
    s_nop 0
    buffer_load_dwordx4 v217, s[52:55], 0 offen offset:0 lds
    buffer_load_dwordx4 v218, s[52:55], 0 offen offset:1024 lds
    buffer_load_dwordx4 v219, s[52:55], 0 offen offset:2048 lds
    buffer_load_dwordx4 v220, s[52:55], 0 offen offset:3072 lds
    s_add_u32 m0, s44, 4096
    s_nop 0
    buffer_load_dwordx4 v221, s[52:55], 0 offen offset:0 lds
SK_59:
    v_mfma_f32_16x16x32_bf16 v[132:135], v[92:95], v[36:39], v[132:135]
    ds_read_b64_tr_b16 v[84:85], v98 offset:12608
    v_mfma_f32_16x16x32_bf16 v[180:183], v[92:95], v[44:47], v[180:183]
    ds_read_b64_tr_b16 v[86:87], v98 offset:15680
    v_mfma_f32_16x16x32_bf16 a[60:63], v[36:39], v[36:39], a[60:63]
    s_cmp_lg_u32 s20, 3
    s_cbranch_scc1 SK_60
    v_mfma_f32_16x16x32_bf16 a[72:75], v[88:91], a[48:51], 0
    v_mfma_f32_16x16x32_bf16 a[72:75], v[92:95], a[48:51], a[72:75]
SK_60:
    s_waitcnt lgkmcnt(8)
    v_mfma_f32_16x16x32_bf16 v[136:139], v[64:67], v[32:35], 0
    ds_read_b64_tr_b16 v[88:89], v99 offset:352
    v_mfma_f32_16x16x32_bf16 v[184:187], v[64:67], v[40:43], 0
    ds_read_b64_tr_b16 v[90:91], v99 offset:3424
    v_mfma_f32_16x16x32_bf16 v[136:139], v[68:71], v[36:39], v[136:139]
    ds_read_b64_tr_b16 v[92:93], v99 offset:12640
    v_mfma_f32_16x16x32_bf16 v[184:187], v[68:71], v[44:47], v[184:187]
    ds_read_b64_tr_b16 v[94:95], v99 offset:15712
    v_mfma_f32_16x16x32_bf16 a[64:67], v[44:47], v[44:47], a[64:67]
    s_cmp_lg_u32 s20, 0
    s_cbranch_scc1 SK_61
    v_mfma_f32_16x16x32_bf16 a[76:79], v[64:67], a[48:51], 0
    v_mfma_f32_16x16x32_bf16 a[76:79], v[68:71], a[48:51], a[76:79]
SK_61:
    s_waitcnt lgkmcnt(8)
    v_mfma_f32_16x16x32_bf16 v[140:143], v[72:75], v[32:35], 0
    v_mfma_f32_16x16x32_bf16 v[188:191], v[72:75], v[40:43], 0
    v_mfma_f32_16x16x32_bf16 v[140:143], v[76:79], v[36:39], v[140:143]
    v_mfma_f32_16x16x32_bf16 v[188:191], v[76:79], v[44:47], v[188:191]
    s_cmp_lg_u32 s20, 1
    s_cbranch_scc1 SK_62
    v_mfma_f32_16x16x32_bf16 a[76:79], v[72:75], a[48:51], 0
    v_mfma_f32_16x16x32_bf16 a[76:79], v[76:79], a[48:51], a[76:79]
SK_62:
    s_waitcnt lgkmcnt(0)
    s_waitcnt vmcnt(15)
    s_barrier
    v_mfma_f32_16x16x32_bf16 v[144:147], v[80:83], v[32:35], 0
    ds_read_b128 v[48:51], v22 offset:16384
    ds_read_b64_tr_b16 v[64:65], v96 offset:24576
    v_mfma_f32_16x16x32_bf16 v[192:195], v[80:83], v[40:43], 0
    ds_read_b128 v[52:55], v23 offset:16384
    ds_read_b64_tr_b16 v[66:67], v96 offset:27648
    v_mfma_f32_16x16x32_bf16 v[144:147], v[84:87], v[36:39], v[144:147]
    ds_read_b128 v[56:59], v22 offset:18432
    ds_read_b64_tr_b16 v[68:69], v96 offset:36864
    v_mfma_f32_16x16x32_bf16 v[192:195], v[84:87], v[44:47], v[192:195]
    ds_read_b128 v[60:63], v23 offset:18432
    ds_read_b64_tr_b16 v[70:71], v96 offset:39936
    s_cmp_lg_u32 s20, 2
    s_cbranch_scc1 SK_63
    v_mfma_f32_16x16x32_bf16 a[76:79], v[80:83], a[48:51], 0
    v_mfma_f32_16x16x32_bf16 a[76:79], v[84:87], a[48:51], a[76:79]
SK_63:
    v_mfma_f32_16x16x32_bf16 v[148:151], v[88:91], v[32:35], 0
    ds_read_b64_tr_b16 v[72:73], v97 offset:24608
    ds_read_b64_tr_b16 v[80:81], v98 offset:24640
    v_mfma_f32_16x16x32_bf16 v[196:199], v[88:91], v[40:43], 0
    ds_read_b64_tr_b16 v[74:75], v97 offset:27680
    ds_read_b64_tr_b16 v[82:83], v98 offset:27712
    v_mfma_f32_16x16x32_bf16 v[148:151], v[92:95], v[36:39], v[148:151]
    ds_read_b64_tr_b16 v[76:77], v97 offset:36896
    ds_read_b64_tr_b16 v[84:85], v98 offset:36928
    v_mfma_f32_16x16x32_bf16 v[196:199], v[92:95], v[44:47], v[196:199]
    ds_read_b64_tr_b16 v[78:79], v97 offset:39968
    ds_read_b64_tr_b16 v[86:87], v98 offset:40000
    s_cmp_lg_u32 s20, 3
    s_cbranch_scc1 SK_64
    v_mfma_f32_16x16x32_bf16 a[76:79], v[88:91], a[48:51], 0
    v_mfma_f32_16x16x32_bf16 a[76:79], v[92:95], a[48:51], a[76:79]
SK_64:
    s_lshl_b32 s36, s20, 6
    v_lshl_add_u32 v102, v2, 4, s36
    s_lshl_b32 s36, s20, 8
    v_lshl_add_u32 v103, v3, 3, s36
    v_accvgpr_read_b32 v244, a52
    v_accvgpr_read_b32 v245, a60
    v_accvgpr_read_b32 v248, a61
    v_accvgpr_read_b32 v249, a62
    v_accvgpr_read_b32 v250, a63
    v_accvgpr_read_b32 v246, a56
    v_accvgpr_read_b32 v247, a64
    v_accvgpr_read_b32 v251, a65
    v_accvgpr_read_b32 v252, a66
    v_accvgpr_read_b32 v253, a67
    v_cmp_eq_u32 vcc, 1, v5
    s_nop 1
    v_cndmask_b32 v245, v245, v248, vcc
    v_cndmask_b32 v247, v247, v251, vcc
    v_cmp_eq_u32 vcc, 2, v5
    s_nop 1
    v_cndmask_b32 v245, v245, v249, vcc
    v_cndmask_b32 v247, v247, v252, vcc
    v_cmp_eq_u32 vcc, 3, v5
    s_nop 1
    v_cndmask_b32 v245, v245, v250, vcc
    v_cndmask_b32 v247, v247, v253, vcc
    s_mov_b32 exec_lo, 0x00010001
    s_mov_b32 exec_hi, 0x00010001
    buffer_store_dwordx4 a[68:71], v102, s[80:83], s45 offen offset:0 sc1
    buffer_store_dwordx4 a[72:75], v102, s[80:83], s45 offen offset:256 sc1
    buffer_store_dwordx4 a[76:79], v102, s[80:83], s45 offen offset:512 sc1
    s_mov_b32 exec_lo, 0x00f0000f
    s_mov_b32 exec_hi, 0xf0000f00
    buffer_store_dwordx2 v[244:245], v103, s[80:83], s46 offen offset:0
    buffer_store_dwordx2 v[246:247], v103, s[80:83], s46 offen offset:128
    s_mov_b64 exec, -1
    s_waitcnt lgkmcnt(8)
    s_add_u32 s32, s32, 128
    s_cmpk_eq_u32 s32, 1280
    s_cselect_b32 s32, 0, s32
    s_add_u32 m0, s47, 0
    v_mfma_f32_16x16x32_bf16 v[104:107], v[64:67], v[48:51], v[104:107]
    ds_read_b64_tr_b16 v[88:89], v99 offset:24672
    buffer_load_dwordx4 v6, s[88:91], s32 offen offset:0 lds
    v_mfma_f32_16x16x32_bf16 v[152:155], v[64:67], v[56:59], v[152:155]
    ds_read_b64_tr_b16 v[90:91], v99 offset:27744
    v_mfma_f32_16x16x32_bf16 v[104:107], v[68:71], v[52:55], v[104:107]
    ds_read_b64_tr_b16 v[92:93], v99 offset:36960
    v_mfma_f32_16x16x32_bf16 v[152:155], v[68:71], v[60:63], v[152:155]
    ds_read_b64_tr_b16 v[94:95], v99 offset:40032
    s_waitcnt lgkmcnt(5)
    v_mfma_f32_16x16x32_bf16 v[108:111], v[72:75], v[48:51], v[108:111]
    ds_read_b64_tr_b16 v[64:65], v96 offset:24704
    buffer_load_dwordx4 v7, s[88:91], s32 offen offset:1024 lds
    v_mfma_f32_16x16x32_bf16 v[156:159], v[72:75], v[56:59], v[156:159]
    ds_read_b64_tr_b16 v[66:67], v96 offset:27776
    v_mfma_f32_16x16x32_bf16 v[108:111], v[76:79], v[52:55], v[108:111]
    ds_read_b64_tr_b16 v[68:69], v96 offset:36992
    v_mfma_f32_16x16x32_bf16 v[156:159], v[76:79], v[60:63], v[156:159]
    ds_read_b64_tr_b16 v[70:71], v96 offset:40064
    s_waitcnt lgkmcnt(8)
    v_mfma_f32_16x16x32_bf16 v[112:115], v[80:83], v[48:51], v[112:115]
    ds_read_b64_tr_b16 v[72:73], v97 offset:24736
    buffer_load_dwordx4 v8, s[88:91], s32 offen offset:2048 lds
    v_mfma_f32_16x16x32_bf16 v[160:163], v[80:83], v[56:59], v[160:163]
    ds_read_b64_tr_b16 v[74:75], v97 offset:27808
    v_mfma_f32_16x16x32_bf16 v[112:115], v[84:87], v[52:55], v[112:115]
    ds_read_b64_tr_b16 v[76:77], v97 offset:37024
    v_mfma_f32_16x16x32_bf16 v[160:163], v[84:87], v[60:63], v[160:163]
    ds_read_b64_tr_b16 v[78:79], v97 offset:40096
    s_waitcnt lgkmcnt(8)
    v_mfma_f32_16x16x32_bf16 v[116:119], v[88:91], v[48:51], v[116:119]
    ds_read_b64_tr_b16 v[80:81], v98 offset:24768
    buffer_load_dwordx4 v9, s[88:91], s32 offen offset:3072 lds
    v_mfma_f32_16x16x32_bf16 v[164:167], v[88:91], v[56:59], v[164:167]
    ds_read_b64_tr_b16 v[82:83], v98 offset:27840
    v_mfma_f32_16x16x32_bf16 v[116:119], v[92:95], v[52:55], v[116:119]
    ds_read_b64_tr_b16 v[84:85], v98 offset:37056
    v_mfma_f32_16x16x32_bf16 v[164:167], v[92:95], v[60:63], v[164:167]
    ds_read_b64_tr_b16 v[86:87], v98 offset:40128
    s_waitcnt lgkmcnt(8)
    s_mul_i32 s33, s32, 1536
    s_add_u32 m0, s34, 0
    v_mfma_f32_16x16x32_bf16 v[120:123], v[64:67], v[48:51], v[120:123]
    ds_read_b64_tr_b16 v[88:89], v99 offset:24800
    buffer_load_dwordx4 v10, s[40:43], s33 offen offset:0 lds
    v_mfma_f32_16x16x32_bf16 v[168:171], v[64:67], v[56:59], v[168:171]
    ds_read_b64_tr_b16 v[90:91], v99 offset:27872
    v_mfma_f32_16x16x32_bf16 v[120:123], v[68:71], v[52:55], v[120:123]
    ds_read_b64_tr_b16 v[92:93], v99 offset:37088
    v_mfma_f32_16x16x32_bf16 v[168:171], v[68:71], v[60:63], v[168:171]
    ds_read_b64_tr_b16 v[94:95], v99 offset:40160
    s_waitcnt lgkmcnt(8)
    v_mfma_f32_16x16x32_bf16 v[124:127], v[72:75], v[48:51], v[124:127]
    ds_read_b64_tr_b16 v[64:65], v96 offset:24832
    buffer_load_dwordx4 v11, s[40:43], s33 offen offset:1024 lds
    v_mfma_f32_16x16x32_bf16 v[172:175], v[72:75], v[56:59], v[172:175]
    ds_read_b64_tr_b16 v[66:67], v96 offset:27904
    v_mfma_f32_16x16x32_bf16 v[124:127], v[76:79], v[52:55], v[124:127]
    ds_read_b64_tr_b16 v[68:69], v96 offset:37120
    v_mfma_f32_16x16x32_bf16 v[172:175], v[76:79], v[60:63], v[172:175]
    ds_read_b64_tr_b16 v[70:71], v96 offset:40192
    s_waitcnt lgkmcnt(8)
    v_mfma_f32_16x16x32_bf16 v[128:131], v[80:83], v[48:51], v[128:131]
    ds_read_b64_tr_b16 v[72:73], v97 offset:24864
    buffer_load_dwordx4 v12, s[40:43], s33 offen offset:2048 lds
    v_mfma_f32_16x16x32_bf16 v[176:179], v[80:83], v[56:59], v[176:179]
    ds_read_b64_tr_b16 v[74:75], v97 offset:27936
    v_mfma_f32_16x16x32_bf16 v[128:131], v[84:87], v[52:55], v[128:131]
    ds_read_b64_tr_b16 v[76:77], v97 offset:37152
    v_mfma_f32_16x16x32_bf16 v[176:179], v[84:87], v[60:63], v[176:179]
    ds_read_b64_tr_b16 v[78:79], v97 offset:40224
    s_waitcnt lgkmcnt(8)
    v_mfma_f32_16x16x32_bf16 v[132:135], v[88:91], v[48:51], v[132:135]
    ds_read_b64_tr_b16 v[80:81], v98 offset:24896
    buffer_load_dwordx4 v13, s[40:43], s33 offen offset:3072 lds
    v_mfma_f32_16x16x32_bf16 v[180:183], v[88:91], v[56:59], v[180:183]
    ds_read_b64_tr_b16 v[82:83], v98 offset:27968
    v_mfma_f32_16x16x32_bf16 v[132:135], v[92:95], v[52:55], v[132:135]
    ds_read_b64_tr_b16 v[84:85], v98 offset:37184
    v_mfma_f32_16x16x32_bf16 v[180:183], v[92:95], v[60:63], v[180:183]
    ds_read_b64_tr_b16 v[86:87], v98 offset:40256
    s_waitcnt lgkmcnt(8)
    s_add_u32 m0, s34, 4096
    v_mfma_f32_16x16x32_bf16 v[136:139], v[64:67], v[48:51], v[136:139]
    ds_read_b64_tr_b16 v[88:89], v99 offset:24928
    buffer_load_dwordx4 v14, s[40:43], s33 offen offset:0 lds
    v_mfma_f32_16x16x32_bf16 v[184:187], v[64:67], v[56:59], v[184:187]
    ds_read_b64_tr_b16 v[90:91], v99 offset:28000
    v_mfma_f32_16x16x32_bf16 v[136:139], v[68:71], v[52:55], v[136:139]
    ds_read_b64_tr_b16 v[92:93], v99 offset:37216
    v_mfma_f32_16x16x32_bf16 v[184:187], v[68:71], v[60:63], v[184:187]
    ds_read_b64_tr_b16 v[94:95], v99 offset:40288
    s_waitcnt lgkmcnt(8)
    v_mfma_f32_16x16x32_bf16 v[140:143], v[72:75], v[48:51], v[140:143]
    buffer_load_dwordx4 v15, s[40:43], s33 offen offset:1024 lds
    v_mfma_f32_16x16x32_bf16 v[188:191], v[72:75], v[56:59], v[188:191]
    v_mfma_f32_16x16x32_bf16 v[140:143], v[76:79], v[52:55], v[140:143]
    v_mfma_f32_16x16x32_bf16 v[188:191], v[76:79], v[60:63], v[188:191]
    v_lshlrev_b32 v242, 16, v240
    v_and_b32 v243, 0xffff0000, v240
    ds_write_b64 v241, v[242:243]
    s_waitcnt lgkmcnt(0)
    s_waitcnt vmcnt(15)
    s_barrier
    v_mfma_f32_16x16x32_bf16 v[144:147], v[80:83], v[48:51], v[144:147]
    ds_read_b128 v[32:35], v22 offset:32768
    ds_read_b64_tr_b16 v[64:65], v96 offset:49152
    v_mfma_f32_16x16x32_bf16 v[192:195], v[80:83], v[56:59], v[192:195]
    ds_read_b128 v[36:39], v23 offset:32768
    ds_read_b64_tr_b16 v[66:67], v96 offset:52224
    v_mfma_f32_16x16x32_bf16 v[144:147], v[84:87], v[52:55], v[144:147]
    ds_read_b128 v[40:43], v22 offset:34816
    ds_read_b64_tr_b16 v[68:69], v96 offset:61440
    v_mfma_f32_16x16x32_bf16 v[192:195], v[84:87], v[60:63], v[192:195]
    ds_read_b128 v[44:47], v23 offset:34816
    ds_read_b64_tr_b16 v[70:71], v96 offset:64512
    v_mfma_f32_16x16x32_bf16 v[148:151], v[88:91], v[48:51], v[148:151]
    ds_read_b64_tr_b16 v[72:73], v97 offset:49184
    ds_read_b64_tr_b16 v[80:81], v98 offset:49216
    v_mfma_f32_16x16x32_bf16 v[196:199], v[88:91], v[56:59], v[196:199]
    ds_read_b64_tr_b16 v[74:75], v97 offset:52256
    ds_read_b64_tr_b16 v[82:83], v98 offset:52288
    v_mfma_f32_16x16x32_bf16 v[148:151], v[92:95], v[52:55], v[148:151]
    ds_read_b64_tr_b16 v[76:77], v97 offset:61472
    ds_read_b64_tr_b16 v[84:85], v98 offset:61504
    v_mfma_f32_16x16x32_bf16 v[196:199], v[92:95], v[60:63], v[196:199]
    ds_read_b64_tr_b16 v[78:79], v97 offset:64544
    ds_read_b64_tr_b16 v[86:87], v98 offset:64576
    ds_read_b64_tr_b16 v[212:213], v200 offset:0
    ds_read_b64_tr_b16 v[214:215], v200 offset:2560
    ds_read_b64_tr_b16 v[216:217], v200 offset:32
    ds_read_b64_tr_b16 v[218:219], v200 offset:2592
    ds_read_b64_tr_b16 v[220:221], v200 offset:64
    ds_read_b64_tr_b16 v[222:223], v200 offset:2624
    ds_read_b64_tr_b16 v[224:225], v200 offset:96
    ds_read_b64_tr_b16 v[226:227], v200 offset:2656
    ds_read_b64_tr_b16 v[228:229], v200 offset:128
    ds_read_b64_tr_b16 v[230:231], v200 offset:2688
    s_cmp_lg_u32 s20, 0
    s_cbranch_scc1 W0_65
    buffer_load_dword v20, off, s[84:87], 0 sc1
W0_65:
    s_waitcnt lgkmcnt(15)
    s_add_u32 s32, s32, 128
    s_cmpk_eq_u32 s32, 1280
    s_cselect_b32 s32, 0, s32
    s_add_u32 m0, s47, 16384
    v_mfma_f32_16x16x32_bf16 v[104:107], v[64:67], v[32:35], v[104:107]
    ds_read_b64_tr_b16 v[88:89], v99 offset:49248
    buffer_load_dwordx4 v6, s[88:91], s32 offen offset:0 lds
    v_mfma_f32_16x16x32_bf16 v[152:155], v[64:67], v[40:43], v[152:155]
    ds_read_b64_tr_b16 v[90:91], v99 offset:52320
    v_mfma_f32_16x16x32_bf16 v[104:107], v[68:71], v[36:39], v[104:107]
    ds_read_b64_tr_b16 v[92:93], v99 offset:61536
    buffer_load_dwordx4 v7, s[88:91], s32 offen offset:1024 lds
    v_mfma_f32_16x16x32_bf16 v[152:155], v[68:71], v[44:47], v[152:155]
    ds_read_b64_tr_b16 v[94:95], v99 offset:64608
    s_waitcnt lgkmcnt(15)
    v_mfma_f32_16x16x32_bf16 v[108:111], v[72:75], v[32:35], v[108:111]
    ds_read_b64_tr_b16 v[64:65], v96 offset:49280
    buffer_load_dwordx4 v8, s[88:91], s32 offen offset:2048 lds
    v_mfma_f32_16x16x32_bf16 v[156:159], v[72:75], v[40:43], v[156:159]
    ds_read_b64_tr_b16 v[66:67], v96 offset:52352
    v_mfma_f32_16x16x32_bf16 v[108:111], v[76:79], v[36:39], v[108:111]
    ds_read_b64_tr_b16 v[68:69], v96 offset:61568
    buffer_load_dwordx4 v9, s[88:91], s32 offen offset:3072 lds
    v_mfma_f32_16x16x32_bf16 v[156:159], v[76:79], v[44:47], v[156:159]
    ds_read_b64_tr_b16 v[70:71], v96 offset:64640
    s_waitcnt lgkmcnt(15)
    s_mul_i32 s33, s32, 1536
    s_add_u32 m0, s34, 24576
    v_mfma_f32_16x16x32_bf16 v[112:115], v[80:83], v[32:35], v[112:115]
    ds_read_b64_tr_b16 v[72:73], v97 offset:49312
    buffer_load_dwordx4 v10, s[40:43], s33 offen offset:0 lds
    v_mfma_f32_16x16x32_bf16 v[160:163], v[80:83], v[40:43], v[160:163]
    ds_read_b64_tr_b16 v[74:75], v97 offset:52384
    v_mfma_f32_16x16x32_bf16 v[112:115], v[84:87], v[36:39], v[112:115]
    ds_read_b64_tr_b16 v[76:77], v97 offset:61600
    buffer_load_dwordx4 v11, s[40:43], s33 offen offset:1024 lds
    v_mfma_f32_16x16x32_bf16 v[160:163], v[84:87], v[44:47], v[160:163]
    ds_read_b64_tr_b16 v[78:79], v97 offset:64672
    s_waitcnt lgkmcnt(8)
    v_mfma_f32_16x16x32_bf16 v[116:119], v[88:91], v[32:35], v[116:119]
    ds_read_b64_tr_b16 v[80:81], v98 offset:49344
    buffer_load_dwordx4 v12, s[40:43], s33 offen offset:2048 lds
    v_mfma_f32_16x16x32_bf16 v[164:167], v[88:91], v[40:43], v[164:167]
    ds_read_b64_tr_b16 v[82:83], v98 offset:52416
    v_mfma_f32_16x16x32_bf16 v[116:119], v[92:95], v[36:39], v[116:119]
    ds_read_b64_tr_b16 v[84:85], v98 offset:61632
    buffer_load_dwordx4 v13, s[40:43], s33 offen offset:3072 lds
    v_mfma_f32_16x16x32_bf16 v[164:167], v[92:95], v[44:47], v[164:167]
    ds_read_b64_tr_b16 v[86:87], v98 offset:64704
    s_waitcnt lgkmcnt(8)
    s_add_u32 m0, s34, 28672
    v_mfma_f32_16x16x32_bf16 v[120:123], v[64:67], v[32:35], v[120:123]
    ds_read_b64_tr_b16 v[88:89], v99 offset:49376
    buffer_load_dwordx4 v14, s[40:43], s33 offen offset:0 lds
    v_mfma_f32_16x16x32_bf16 v[168:171], v[64:67], v[40:43], v[168:171]
    ds_read_b64_tr_b16 v[90:91], v99 offset:52448
    v_mfma_f32_16x16x32_bf16 v[120:123], v[68:71], v[36:39], v[120:123]
    ds_read_b64_tr_b16 v[92:93], v99 offset:61664
    buffer_load_dwordx4 v15, s[40:43], s33 offen offset:1024 lds
    v_mfma_f32_16x16x32_bf16 v[168:171], v[68:71], v[44:47], v[168:171]
    ds_read_b64_tr_b16 v[94:95], v99 offset:64736
    s_waitcnt lgkmcnt(8)
    v_mfma_f32_16x16x32_bf16 v[124:127], v[72:75], v[32:35], v[124:127]
    ds_read_b64_tr_b16 v[64:65], v96 offset:49408
    buffer_store_dwordx4 v[212:215], v202, s[12:15], 0 offen offset:0 sc1
    v_mfma_f32_16x16x32_bf16 v[172:175], v[72:75], v[40:43], v[172:175]
    ds_read_b64_tr_b16 v[66:67], v96 offset:52480
    v_mfma_f32_16x16x32_bf16 v[124:127], v[76:79], v[36:39], v[124:127]
    ds_read_b64_tr_b16 v[68:69], v96 offset:61696
    buffer_store_dwordx4 v[216:219], v202, s[12:15], 0 offen offset:1024 sc1
    v_mfma_f32_16x16x32_bf16 v[172:175], v[76:79], v[44:47], v[172:175]
    ds_read_b64_tr_b16 v[70:71], v96 offset:64768
    s_waitcnt lgkmcnt(8)
    v_mfma_f32_16x16x32_bf16 v[128:131], v[80:83], v[32:35], v[128:131]
    ds_read_b64_tr_b16 v[72:73], v97 offset:49440
    buffer_store_dwordx4 v[220:223], v202, s[12:15], 0 offen offset:2048 sc1
    v_mfma_f32_16x16x32_bf16 v[176:179], v[80:83], v[40:43], v[176:179]
    ds_read_b64_tr_b16 v[74:75], v97 offset:52512
    v_mfma_f32_16x16x32_bf16 v[128:131], v[84:87], v[36:39], v[128:131]
    ds_read_b64_tr_b16 v[76:77], v97 offset:61728
    buffer_store_dwordx4 v[224:227], v202, s[12:15], 0 offen offset:3072 sc1
    v_mfma_f32_16x16x32_bf16 v[176:179], v[84:87], v[44:47], v[176:179]
    ds_read_b64_tr_b16 v[78:79], v97 offset:64800
    s_waitcnt lgkmcnt(8)
    v_mfma_f32_16x16x32_bf16 v[132:135], v[88:91], v[32:35], v[132:135]
    ds_read_b64_tr_b16 v[80:81], v98 offset:49472
    buffer_store_dwordx4 v[228:231], v203, s[12:15], 0 offen offset:0 sc1
    v_mfma_f32_16x16x32_bf16 v[180:183], v[88:91], v[40:43], v[180:183]
    ds_read_b64_tr_b16 v[82:83], v98 offset:52544
    s_bitcmp1_b32 s97, 30
    s_cbranch_scc1 SK_66
    ds_read_b64_tr_b16 v[232:233], v201 offset:0
    ds_read_b64_tr_b16 v[234:235], v201 offset:2560
    ds_read_b64_tr_b16 v[236:237], v201 offset:32
    ds_read_b64_tr_b16 v[238:239], v201 offset:2592
    ds_read_b64_tr_b16 v[240:241], v201 offset:64
    ds_read_b64_tr_b16 v[242:243], v201 offset:2624
    ds_read_b64_tr_b16 v[244:245], v201 offset:96
    ds_read_b64_tr_b16 v[246:247], v201 offset:2656
    ds_read_b64_tr_b16 v[248:249], v201 offset:128
    ds_read_b64_tr_b16 v[250:251], v201 offset:2688
    s_waitcnt lgkmcnt(0)
    buffer_store_dwordx4 v[232:235], v204, s[12:15], 0 offen offset:0 sc1
    buffer_store_dwordx4 v[236:239], v204, s[12:15], 0 offen offset:1024 sc1
    buffer_store_dwordx4 v[240:243], v204, s[12:15], 0 offen offset:2048 sc1
    buffer_store_dwordx4 v[244:247], v204, s[12:15], 0 offen offset:3072 sc1
    buffer_store_dwordx4 v[248:251], v205, s[12:15], 0 offen offset:0 sc1
SK_66:
    v_mfma_f32_16x16x32_bf16 v[132:135], v[92:95], v[36:39], v[132:135]
    ds_read_b64_tr_b16 v[84:85], v98 offset:61760
    v_mfma_f32_16x16x32_bf16 v[180:183], v[92:95], v[44:47], v[180:183]
    ds_read_b64_tr_b16 v[86:87], v98 offset:64832
    s_waitcnt lgkmcnt(8)
    v_mfma_f32_16x16x32_bf16 v[136:139], v[64:67], v[32:35], v[136:139]
    ds_read_b64_tr_b16 v[88:89], v99 offset:49504
    v_mfma_f32_16x16x32_bf16 v[184:187], v[64:67], v[40:43], v[184:187]
    ds_read_b64_tr_b16 v[90:91], v99 offset:52576
    v_mfma_f32_16x16x32_bf16 v[136:139], v[68:71], v[36:39], v[136:139]
    ds_read_b64_tr_b16 v[92:93], v99 offset:61792
    v_mfma_f32_16x16x32_bf16 v[184:187], v[68:71], v[44:47], v[184:187]
    ds_read_b64_tr_b16 v[94:95], v99 offset:64864
    s_waitcnt lgkmcnt(8)
    v_mfma_f32_16x16x32_bf16 v[140:143], v[72:75], v[32:35], v[140:143]
    v_mfma_f32_16x16x32_bf16 v[188:191], v[72:75], v[40:43], v[188:191]
    v_mfma_f32_16x16x32_bf16 v[140:143], v[76:79], v[36:39], v[140:143]
    v_mfma_f32_16x16x32_bf16 v[188:191], v[76:79], v[44:47], v[188:191]
    s_waitcnt lgkmcnt(0)
    s_waitcnt vmcnt(15)
    s_cmp_lg_u32 s20, 0
    s_cbranch_scc1 W0_67
    s_mov_b32 s98, 0
PL_68:
    v_cmp_ne_u32 vcc, 0x01010101, v20
    s_cbranch_vccz PD_69
    s_add_u32 s98, s98, 1
    s_cmp_ge_u32 s98, 0x40000
    s_cbranch_scc1 PD_69
    s_sleep 0
    buffer_load_dword v20, off, s[84:87], 0 sc1
    s_waitcnt vmcnt(0)
    s_branch PL_68
PD_69:
W0_67:
    s_barrier
    s_cmp_lg_u32 s20, 0
    s_cbranch_scc1 W0_70
    s_lshl_b32 s36, s22, 4
    s_add_u32 s36, s36, s21
    s_lshl_b32 s36, s36, 7
    s_add_u32 s36, s36, 114688
    v_mov_b32 v24, 1
    s_mov_b64 exec, 1
    buffer_store_dword v24, off, s[80:83], s36 sc1
    s_mov_b64 exec, -1
W0_70:
    v_mfma_f32_16x16x32_bf16 v[144:147], v[80:83], v[32:35], v[144:147]
    ds_read_b128 v[48:51], v22 offset:0
    ds_read_b64_tr_b16 v[64:65], v96 offset:0
    v_mfma_f32_16x16x32_bf16 v[192:195], v[80:83], v[40:43], v[192:195]
    ds_read_b128 v[52:55], v23 offset:0
    ds_read_b64_tr_b16 v[66:67], v96 offset:3072
    v_mfma_f32_16x16x32_bf16 v[144:147], v[84:87], v[36:39], v[144:147]
    ds_read_b128 v[56:59], v22 offset:2048
    ds_read_b64_tr_b16 v[68:69], v96 offset:12288
    v_mfma_f32_16x16x32_bf16 v[192:195], v[84:87], v[44:47], v[192:195]
    ds_read_b128 v[60:63], v23 offset:2048
    ds_read_b64_tr_b16 v[70:71], v96 offset:15360
    v_mfma_f32_16x16x32_bf16 v[148:151], v[88:91], v[32:35], v[148:151]
    ds_read_b64_tr_b16 v[72:73], v97 offset:32
    ds_read_b64_tr_b16 v[80:81], v98 offset:64
    v_mfma_f32_16x16x32_bf16 v[196:199], v[88:91], v[40:43], v[196:199]
    ds_read_b64_tr_b16 v[74:75], v97 offset:3104
    ds_read_b64_tr_b16 v[82:83], v98 offset:3136
    v_mfma_f32_16x16x32_bf16 v[148:151], v[92:95], v[36:39], v[148:151]
    ds_read_b64_tr_b16 v[76:77], v97 offset:12320
    ds_read_b64_tr_b16 v[84:85], v98 offset:12352
    v_mfma_f32_16x16x32_bf16 v[196:199], v[92:95], v[44:47], v[196:199]
    ds_read_b64_tr_b16 v[78:79], v97 offset:15392
    ds_read_b64_tr_b16 v[86:87], v98 offset:15424
    s_waitcnt lgkmcnt(8)
    s_add_u32 s32, s32, 128
    s_cmpk_eq_u32 s32, 1280
    s_cselect_b32 s32, 0, s32
    s_add_u32 m0, s47, 32768
    v_mfma_f32_16x16x32_bf16 v[104:107], v[64:67], v[48:51], v[104:107]
    ds_read_b64_tr_b16 v[88:89], v99 offset:96
    buffer_load_dwordx4 v6, s[88:91], s32 offen offset:0 lds
    v_mfma_f32_16x16x32_bf16 v[152:155], v[64:67], v[56:59], v[152:155]
    ds_read_b64_tr_b16 v[90:91], v99 offset:3168
    v_mfma_f32_16x16x32_bf16 v[104:107], v[68:71], v[52:55], v[104:107]
    ds_read_b64_tr_b16 v[92:93], v99 offset:12384
    v_mfma_f32_16x16x32_bf16 v[152:155], v[68:71], v[60:63], v[152:155]
    ds_read_b64_tr_b16 v[94:95], v99 offset:15456
    s_waitcnt lgkmcnt(5)
    v_mfma_f32_16x16x32_bf16 v[108:111], v[72:75], v[48:51], v[108:111]
    ds_read_b64_tr_b16 v[64:65], v96 offset:128
    buffer_load_dwordx4 v7, s[88:91], s32 offen offset:1024 lds
    v_mfma_f32_16x16x32_bf16 v[156:159], v[72:75], v[56:59], v[156:159]
    ds_read_b64_tr_b16 v[66:67], v96 offset:3200
    v_mfma_f32_16x16x32_bf16 v[108:111], v[76:79], v[52:55], v[108:111]
    ds_read_b64_tr_b16 v[68:69], v96 offset:12416
    v_mfma_f32_16x16x32_bf16 v[156:159], v[76:79], v[60:63], v[156:159]
    ds_read_b64_tr_b16 v[70:71], v96 offset:15488
    s_waitcnt lgkmcnt(8)
    v_mfma_f32_16x16x32_bf16 v[112:115], v[80:83], v[48:51], v[112:115]
    ds_read_b64_tr_b16 v[72:73], v97 offset:160
    buffer_load_dwordx4 v8, s[88:91], s32 offen offset:2048 lds
    v_mfma_f32_16x16x32_bf16 v[160:163], v[80:83], v[56:59], v[160:163]
    ds_read_b64_tr_b16 v[74:75], v97 offset:3232
    v_mfma_f32_16x16x32_bf16 v[112:115], v[84:87], v[52:55], v[112:115]
    ds_read_b64_tr_b16 v[76:77], v97 offset:12448
    v_mfma_f32_16x16x32_bf16 v[160:163], v[84:87], v[60:63], v[160:163]
    ds_read_b64_tr_b16 v[78:79], v97 offset:15520
    s_waitcnt lgkmcnt(8)
    v_mfma_f32_16x16x32_bf16 v[116:119], v[88:91], v[48:51], v[116:119]
    ds_read_b64_tr_b16 v[80:81], v98 offset:192
    buffer_load_dwordx4 v9, s[88:91], s32 offen offset:3072 lds
    v_mfma_f32_16x16x32_bf16 v[164:167], v[88:91], v[56:59], v[164:167]
    ds_read_b64_tr_b16 v[82:83], v98 offset:3264
    v_mfma_f32_16x16x32_bf16 v[116:119], v[92:95], v[52:55], v[116:119]
    ds_read_b64_tr_b16 v[84:85], v98 offset:12480
    v_mfma_f32_16x16x32_bf16 v[164:167], v[92:95], v[60:63], v[164:167]
    ds_read_b64_tr_b16 v[86:87], v98 offset:15552
    s_waitcnt lgkmcnt(8)
    s_mul_i32 s33, s32, 1536
    s_add_u32 m0, s34, 49152
    v_mfma_f32_16x16x32_bf16 v[120:123], v[64:67], v[48:51], v[120:123]
    ds_read_b64_tr_b16 v[88:89], v99 offset:224
    buffer_load_dwordx4 v10, s[40:43], s33 offen offset:0 lds
    v_mfma_f32_16x16x32_bf16 v[168:171], v[64:67], v[56:59], v[168:171]
    ds_read_b64_tr_b16 v[90:91], v99 offset:3296
    v_mfma_f32_16x16x32_bf16 v[120:123], v[68:71], v[52:55], v[120:123]
    ds_read_b64_tr_b16 v[92:93], v99 offset:12512
    v_mfma_f32_16x16x32_bf16 v[168:171], v[68:71], v[60:63], v[168:171]
    ds_read_b64_tr_b16 v[94:95], v99 offset:15584
    s_waitcnt lgkmcnt(8)
    v_mfma_f32_16x16x32_bf16 v[124:127], v[72:75], v[48:51], v[124:127]
    ds_read_b64_tr_b16 v[64:65], v96 offset:256
    buffer_load_dwordx4 v11, s[40:43], s33 offen offset:1024 lds
    v_mfma_f32_16x16x32_bf16 v[172:175], v[72:75], v[56:59], v[172:175]
    ds_read_b64_tr_b16 v[66:67], v96 offset:3328
    v_mfma_f32_16x16x32_bf16 v[124:127], v[76:79], v[52:55], v[124:127]
    ds_read_b64_tr_b16 v[68:69], v96 offset:12544
    v_mfma_f32_16x16x32_bf16 v[172:175], v[76:79], v[60:63], v[172:175]
    ds_read_b64_tr_b16 v[70:71], v96 offset:15616
    s_waitcnt lgkmcnt(8)
    v_mfma_f32_16x16x32_bf16 v[128:131], v[80:83], v[48:51], v[128:131]
    ds_read_b64_tr_b16 v[72:73], v97 offset:288
    buffer_load_dwordx4 v12, s[40:43], s33 offen offset:2048 lds
    v_mfma_f32_16x16x32_bf16 v[176:179], v[80:83], v[56:59], v[176:179]
    ds_read_b64_tr_b16 v[74:75], v97 offset:3360
    v_mfma_f32_16x16x32_bf16 v[128:131], v[84:87], v[52:55], v[128:131]
    ds_read_b64_tr_b16 v[76:77], v97 offset:12576
    v_mfma_f32_16x16x32_bf16 v[176:179], v[84:87], v[60:63], v[176:179]
    ds_read_b64_tr_b16 v[78:79], v97 offset:15648
    s_waitcnt lgkmcnt(8)
    v_mfma_f32_16x16x32_bf16 v[132:135], v[88:91], v[48:51], v[132:135]
    ds_read_b64_tr_b16 v[80:81], v98 offset:320
    buffer_load_dwordx4 v13, s[40:43], s33 offen offset:3072 lds
    v_mfma_f32_16x16x32_bf16 v[180:183], v[88:91], v[56:59], v[180:183]
    ds_read_b64_tr_b16 v[82:83], v98 offset:3392
    v_mfma_f32_16x16x32_bf16 v[132:135], v[92:95], v[52:55], v[132:135]
    ds_read_b64_tr_b16 v[84:85], v98 offset:12608
    v_mfma_f32_16x16x32_bf16 v[180:183], v[92:95], v[60:63], v[180:183]
    ds_read_b64_tr_b16 v[86:87], v98 offset:15680
    s_waitcnt lgkmcnt(8)
    s_add_u32 m0, s34, 53248
    v_mfma_f32_16x16x32_bf16 v[136:139], v[64:67], v[48:51], v[136:139]
    ds_read_b64_tr_b16 v[88:89], v99 offset:352
    buffer_load_dwordx4 v14, s[40:43], s33 offen offset:0 lds
    v_mfma_f32_16x16x32_bf16 v[184:187], v[64:67], v[56:59], v[184:187]
    ds_read_b64_tr_b16 v[90:91], v99 offset:3424
    v_mfma_f32_16x16x32_bf16 v[136:139], v[68:71], v[52:55], v[136:139]
    ds_read_b64_tr_b16 v[92:93], v99 offset:12640
    v_mfma_f32_16x16x32_bf16 v[184:187], v[68:71], v[60:63], v[184:187]
    ds_read_b64_tr_b16 v[94:95], v99 offset:15712
    s_waitcnt lgkmcnt(8)
    v_mfma_f32_16x16x32_bf16 v[140:143], v[72:75], v[48:51], v[140:143]
    buffer_load_dwordx4 v15, s[40:43], s33 offen offset:1024 lds
    v_mfma_f32_16x16x32_bf16 v[188:191], v[72:75], v[56:59], v[188:191]
    v_mfma_f32_16x16x32_bf16 v[140:143], v[76:79], v[52:55], v[140:143]
    v_mfma_f32_16x16x32_bf16 v[188:191], v[76:79], v[60:63], v[188:191]
    s_waitcnt lgkmcnt(0)
    s_waitcnt vmcnt(10)
    s_barrier
    s_cmp_lg_u32 s20, 0
    s_cbranch_scc1 W0_71
    v_mov_b32 v24, 1
    s_mov_b64 exec, 1
    buffer_store_dword v24, off, s[80:83], s58 sc1
    s_mov_b64 exec, -1
W0_71:
    v_mfma_f32_16x16x32_bf16 v[144:147], v[80:83], v[48:51], v[144:147]
    ds_read_b128 v[32:35], v22 offset:16384
    ds_read_b64_tr_b16 v[64:65], v96 offset:24576
    v_mfma_f32_16x16x32_bf16 v[192:195], v[80:83], v[56:59], v[192:195]
    ds_read_b128 v[36:39], v23 offset:16384
    ds_read_b64_tr_b16 v[66:67], v96 offset:27648
    v_mfma_f32_16x16x32_bf16 v[144:147], v[84:87], v[52:55], v[144:147]
    ds_read_b128 v[40:43], v22 offset:18432
    ds_read_b64_tr_b16 v[68:69], v96 offset:36864
    v_mfma_f32_16x16x32_bf16 v[192:195], v[84:87], v[60:63], v[192:195]
    ds_read_b128 v[44:47], v23 offset:18432
    ds_read_b64_tr_b16 v[70:71], v96 offset:39936
    v_mfma_f32_16x16x32_bf16 v[148:151], v[88:91], v[48:51], v[148:151]
    ds_read_b64_tr_b16 v[72:73], v97 offset:24608
    ds_read_b64_tr_b16 v[80:81], v98 offset:24640
    v_mfma_f32_16x16x32_bf16 v[196:199], v[88:91], v[56:59], v[196:199]
    ds_read_b64_tr_b16 v[74:75], v97 offset:27680
    ds_read_b64_tr_b16 v[82:83], v98 offset:27712
    v_mfma_f32_16x16x32_bf16 v[148:151], v[92:95], v[52:55], v[148:151]
    ds_read_b64_tr_b16 v[76:77], v97 offset:36896
    ds_read_b64_tr_b16 v[84:85], v98 offset:36928
    v_mfma_f32_16x16x32_bf16 v[196:199], v[92:95], v[60:63], v[196:199]
    ds_read_b64_tr_b16 v[78:79], v97 offset:39968
    ds_read_b64_tr_b16 v[86:87], v98 offset:40000
    s_waitcnt lgkmcnt(8)
    s_add_u32 s32, s32, 128
    s_cmpk_eq_u32 s32, 1280
    s_cselect_b32 s32, 0, s32
    s_add_u32 m0, s47, 0
    v_mfma_f32_16x16x32_bf16 v[104:107], v[64:67], v[32:35], v[104:107]
    ds_read_b64_tr_b16 v[88:89], v99 offset:24672
    buffer_load_dwordx4 v6, s[88:91], s32 offen offset:0 lds
    v_mfma_f32_16x16x32_bf16 v[152:155], v[64:67], v[40:43], v[152:155]
    ds_read_b64_tr_b16 v[90:91], v99 offset:27744
    v_mfma_f32_16x16x32_bf16 v[104:107], v[68:71], v[36:39], v[104:107]
    ds_read_b64_tr_b16 v[92:93], v99 offset:36960
    v_mfma_f32_16x16x32_bf16 v[152:155], v[68:71], v[44:47], v[152:155]
    ds_read_b64_tr_b16 v[94:95], v99 offset:40032
    s_waitcnt lgkmcnt(5)
    v_mfma_f32_16x16x32_bf16 v[108:111], v[72:75], v[32:35], v[108:111]
    ds_read_b64_tr_b16 v[64:65], v96 offset:24704
    buffer_load_dwordx4 v7, s[88:91], s32 offen offset:1024 lds
    v_mfma_f32_16x16x32_bf16 v[156:159], v[72:75], v[40:43], v[156:159]
    ds_read_b64_tr_b16 v[66:67], v96 offset:27776
    v_mfma_f32_16x16x32_bf16 v[108:111], v[76:79], v[36:39], v[108:111]
    ds_read_b64_tr_b16 v[68:69], v96 offset:36992
    v_mfma_f32_16x16x32_bf16 v[156:159], v[76:79], v[44:47], v[156:159]
    ds_read_b64_tr_b16 v[70:71], v96 offset:40064
    s_waitcnt lgkmcnt(8)
    v_mfma_f32_16x16x32_bf16 v[112:115], v[80:83], v[32:35], v[112:115]
    ds_read_b64_tr_b16 v[72:73], v97 offset:24736
    buffer_load_dwordx4 v8, s[88:91], s32 offen offset:2048 lds
    v_mfma_f32_16x16x32_bf16 v[160:163], v[80:83], v[40:43], v[160:163]
    ds_read_b64_tr_b16 v[74:75], v97 offset:27808
    v_mfma_f32_16x16x32_bf16 v[112:115], v[84:87], v[36:39], v[112:115]
    ds_read_b64_tr_b16 v[76:77], v97 offset:37024
    v_mfma_f32_16x16x32_bf16 v[160:163], v[84:87], v[44:47], v[160:163]
    ds_read_b64_tr_b16 v[78:79], v97 offset:40096
    s_waitcnt lgkmcnt(8)
    v_mfma_f32_16x16x32_bf16 v[116:119], v[88:91], v[32:35], v[116:119]
    ds_read_b64_tr_b16 v[80:81], v98 offset:24768
    buffer_load_dwordx4 v9, s[88:91], s32 offen offset:3072 lds
    v_mfma_f32_16x16x32_bf16 v[164:167], v[88:91], v[40:43], v[164:167]
    ds_read_b64_tr_b16 v[82:83], v98 offset:27840
    v_mfma_f32_16x16x32_bf16 v[116:119], v[92:95], v[36:39], v[116:119]
    ds_read_b64_tr_b16 v[84:85], v98 offset:37056
    v_mfma_f32_16x16x32_bf16 v[164:167], v[92:95], v[44:47], v[164:167]
    ds_read_b64_tr_b16 v[86:87], v98 offset:40128
    s_waitcnt lgkmcnt(8)
    s_mul_i32 s33, s32, 1536
    s_add_u32 m0, s34, 0
    v_mfma_f32_16x16x32_bf16 v[120:123], v[64:67], v[32:35], v[120:123]
    ds_read_b64_tr_b16 v[88:89], v99 offset:24800
    buffer_load_dwordx4 v10, s[40:43], s33 offen offset:0 lds
    v_mfma_f32_16x16x32_bf16 v[168:171], v[64:67], v[40:43], v[168:171]
    ds_read_b64_tr_b16 v[90:91], v99 offset:27872
    v_mfma_f32_16x16x32_bf16 v[120:123], v[68:71], v[36:39], v[120:123]
    ds_read_b64_tr_b16 v[92:93], v99 offset:37088
    v_mfma_f32_16x16x32_bf16 v[168:171], v[68:71], v[44:47], v[168:171]
    ds_read_b64_tr_b16 v[94:95], v99 offset:40160
    s_waitcnt lgkmcnt(8)
    v_mfma_f32_16x16x32_bf16 v[124:127], v[72:75], v[32:35], v[124:127]
    ds_read_b64_tr_b16 v[64:65], v96 offset:24832
    buffer_load_dwordx4 v11, s[40:43], s33 offen offset:1024 lds
    v_mfma_f32_16x16x32_bf16 v[172:175], v[72:75], v[40:43], v[172:175]
    ds_read_b64_tr_b16 v[66:67], v96 offset:27904
    v_mfma_f32_16x16x32_bf16 v[124:127], v[76:79], v[36:39], v[124:127]
    ds_read_b64_tr_b16 v[68:69], v96 offset:37120
    v_mfma_f32_16x16x32_bf16 v[172:175], v[76:79], v[44:47], v[172:175]
    ds_read_b64_tr_b16 v[70:71], v96 offset:40192
    s_waitcnt lgkmcnt(8)
    v_mfma_f32_16x16x32_bf16 v[128:131], v[80:83], v[32:35], v[128:131]
    ds_read_b64_tr_b16 v[72:73], v97 offset:24864
    buffer_load_dwordx4 v12, s[40:43], s33 offen offset:2048 lds
    v_mfma_f32_16x16x32_bf16 v[176:179], v[80:83], v[40:43], v[176:179]
    ds_read_b64_tr_b16 v[74:75], v97 offset:27936
    v_mfma_f32_16x16x32_bf16 v[128:131], v[84:87], v[36:39], v[128:131]
    ds_read_b64_tr_b16 v[76:77], v97 offset:37152
    v_mfma_f32_16x16x32_bf16 v[176:179], v[84:87], v[44:47], v[176:179]
    ds_read_b64_tr_b16 v[78:79], v97 offset:40224
    s_waitcnt lgkmcnt(8)
    v_mfma_f32_16x16x32_bf16 v[132:135], v[88:91], v[32:35], v[132:135]
    ds_read_b64_tr_b16 v[80:81], v98 offset:24896
    buffer_load_dwordx4 v13, s[40:43], s33 offen offset:3072 lds
    v_mfma_f32_16x16x32_bf16 v[180:183], v[88:91], v[40:43], v[180:183]
    ds_read_b64_tr_b16 v[82:83], v98 offset:27968
    v_mfma_f32_16x16x32_bf16 v[132:135], v[92:95], v[36:39], v[132:135]
    ds_read_b64_tr_b16 v[84:85], v98 offset:37184
    v_mfma_f32_16x16x32_bf16 v[180:183], v[92:95], v[44:47], v[180:183]
    ds_read_b64_tr_b16 v[86:87], v98 offset:40256
    s_waitcnt lgkmcnt(8)
    s_add_u32 m0, s34, 4096
    v_mfma_f32_16x16x32_bf16 v[136:139], v[64:67], v[32:35], v[136:139]
    ds_read_b64_tr_b16 v[88:89], v99 offset:24928
    buffer_load_dwordx4 v14, s[40:43], s33 offen offset:0 lds
    v_mfma_f32_16x16x32_bf16 v[184:187], v[64:67], v[40:43], v[184:187]
    ds_read_b64_tr_b16 v[90:91], v99 offset:28000
    v_mfma_f32_16x16x32_bf16 v[136:139], v[68:71], v[36:39], v[136:139]
    ds_read_b64_tr_b16 v[92:93], v99 offset:37216
    v_mfma_f32_16x16x32_bf16 v[184:187], v[68:71], v[44:47], v[184:187]
    ds_read_b64_tr_b16 v[94:95], v99 offset:40288
    s_waitcnt lgkmcnt(8)
    v_mfma_f32_16x16x32_bf16 v[140:143], v[72:75], v[32:35], v[140:143]
    buffer_load_dwordx4 v15, s[40:43], s33 offen offset:1024 lds
    v_mfma_f32_16x16x32_bf16 v[188:191], v[72:75], v[40:43], v[188:191]
    v_mfma_f32_16x16x32_bf16 v[140:143], v[76:79], v[36:39], v[140:143]
    v_mfma_f32_16x16x32_bf16 v[188:191], v[76:79], v[44:47], v[188:191]
    s_waitcnt lgkmcnt(0)
    s_waitcnt vmcnt(10)
    s_barrier
    v_mfma_f32_16x16x32_bf16 v[144:147], v[80:83], v[32:35], v[144:147]
    ds_read_b128 v[48:51], v22 offset:32768
    ds_read_b64_tr_b16 v[64:65], v96 offset:49152
    v_mfma_f32_16x16x32_bf16 v[192:195], v[80:83], v[40:43], v[192:195]
    ds_read_b128 v[52:55], v23 offset:32768
    ds_read_b64_tr_b16 v[66:67], v96 offset:52224
    v_mfma_f32_16x16x32_bf16 v[144:147], v[84:87], v[36:39], v[144:147]
    ds_read_b128 v[56:59], v22 offset:34816
    ds_read_b64_tr_b16 v[68:69], v96 offset:61440
    v_mfma_f32_16x16x32_bf16 v[192:195], v[84:87], v[44:47], v[192:195]
    ds_read_b128 v[60:63], v23 offset:34816
    ds_read_b64_tr_b16 v[70:71], v96 offset:64512
    v_mfma_f32_16x16x32_bf16 v[148:151], v[88:91], v[32:35], v[148:151]
    ds_read_b64_tr_b16 v[72:73], v97 offset:49184
    ds_read_b64_tr_b16 v[80:81], v98 offset:49216
    v_mfma_f32_16x16x32_bf16 v[196:199], v[88:91], v[40:43], v[196:199]
    ds_read_b64_tr_b16 v[74:75], v97 offset:52256
    ds_read_b64_tr_b16 v[82:83], v98 offset:52288
    v_mfma_f32_16x16x32_bf16 v[148:151], v[92:95], v[36:39], v[148:151]
    ds_read_b64_tr_b16 v[76:77], v97 offset:61472
    ds_read_b64_tr_b16 v[84:85], v98 offset:61504
    v_mfma_f32_16x16x32_bf16 v[196:199], v[92:95], v[44:47], v[196:199]
    ds_read_b64_tr_b16 v[78:79], v97 offset:64544
    ds_read_b64_tr_b16 v[86:87], v98 offset:64576
    s_waitcnt lgkmcnt(8)
    s_add_u32 s32, s32, 128
    s_cmpk_eq_u32 s32, 1280
    s_cselect_b32 s32, 0, s32
    s_add_u32 m0, s47, 16384
    v_mfma_f32_16x16x32_bf16 v[104:107], v[64:67], v[48:51], v[104:107]
    ds_read_b64_tr_b16 v[88:89], v99 offset:49248
    buffer_load_dwordx4 v6, s[88:91], s32 offen offset:0 lds
    v_mfma_f32_16x16x32_bf16 v[152:155], v[64:67], v[56:59], v[152:155]
    ds_read_b64_tr_b16 v[90:91], v99 offset:52320
    v_mfma_f32_16x16x32_bf16 v[104:107], v[68:71], v[52:55], v[104:107]
    ds_read_b64_tr_b16 v[92:93], v99 offset:61536
    v_mfma_f32_16x16x32_bf16 v[152:155], v[68:71], v[60:63], v[152:155]
    ds_read_b64_tr_b16 v[94:95], v99 offset:64608
    s_waitcnt lgkmcnt(5)
    v_mfma_f32_16x16x32_bf16 v[108:111], v[72:75], v[48:51], v[108:111]
    ds_read_b64_tr_b16 v[64:65], v96 offset:49280
    buffer_load_dwordx4 v7, s[88:91], s32 offen offset:1024 lds
    v_mfma_f32_16x16x32_bf16 v[156:159], v[72:75], v[56:59], v[156:159]
    ds_read_b64_tr_b16 v[66:67], v96 offset:52352
    v_mfma_f32_16x16x32_bf16 v[108:111], v[76:79], v[52:55], v[108:111]
    ds_read_b64_tr_b16 v[68:69], v96 offset:61568
    v_mfma_f32_16x16x32_bf16 v[156:159], v[76:79], v[60:63], v[156:159]
    ds_read_b64_tr_b16 v[70:71], v96 offset:64640
    s_waitcnt lgkmcnt(8)
    v_mfma_f32_16x16x32_bf16 v[112:115], v[80:83], v[48:51], v[112:115]
    ds_read_b64_tr_b16 v[72:73], v97 offset:49312
    buffer_load_dwordx4 v8, s[88:91], s32 offen offset:2048 lds
    v_mfma_f32_16x16x32_bf16 v[160:163], v[80:83], v[56:59], v[160:163]
    ds_read_b64_tr_b16 v[74:75], v97 offset:52384
    v_mfma_f32_16x16x32_bf16 v[112:115], v[84:87], v[52:55], v[112:115]
    ds_read_b64_tr_b16 v[76:77], v97 offset:61600
    v_mfma_f32_16x16x32_bf16 v[160:163], v[84:87], v[60:63], v[160:163]
    ds_read_b64_tr_b16 v[78:79], v97 offset:64672
    s_waitcnt lgkmcnt(8)
    v_mfma_f32_16x16x32_bf16 v[116:119], v[88:91], v[48:51], v[116:119]
    ds_read_b64_tr_b16 v[80:81], v98 offset:49344
    buffer_load_dwordx4 v9, s[88:91], s32 offen offset:3072 lds
    v_mfma_f32_16x16x32_bf16 v[164:167], v[88:91], v[56:59], v[164:167]
    ds_read_b64_tr_b16 v[82:83], v98 offset:52416
    v_mfma_f32_16x16x32_bf16 v[116:119], v[92:95], v[52:55], v[116:119]
    ds_read_b64_tr_b16 v[84:85], v98 offset:61632
    v_mfma_f32_16x16x32_bf16 v[164:167], v[92:95], v[60:63], v[164:167]
    ds_read_b64_tr_b16 v[86:87], v98 offset:64704
    s_waitcnt lgkmcnt(8)
    s_mul_i32 s33, s32, 1536
    s_add_u32 m0, s34, 24576
    v_mfma_f32_16x16x32_bf16 v[120:123], v[64:67], v[48:51], v[120:123]
    ds_read_b64_tr_b16 v[88:89], v99 offset:49376
    buffer_load_dwordx4 v10, s[40:43], s33 offen offset:0 lds
    v_mfma_f32_16x16x32_bf16 v[168:171], v[64:67], v[56:59], v[168:171]
    ds_read_b64_tr_b16 v[90:91], v99 offset:52448
    v_mfma_f32_16x16x32_bf16 v[120:123], v[68:71], v[52:55], v[120:123]
    ds_read_b64_tr_b16 v[92:93], v99 offset:61664
    v_mfma_f32_16x16x32_bf16 v[168:171], v[68:71], v[60:63], v[168:171]
    ds_read_b64_tr_b16 v[94:95], v99 offset:64736
    s_waitcnt lgkmcnt(8)
    v_mfma_f32_16x16x32_bf16 v[124:127], v[72:75], v[48:51], v[124:127]
    ds_read_b64_tr_b16 v[64:65], v96 offset:49408
    buffer_load_dwordx4 v11, s[40:43], s33 offen offset:1024 lds
    v_mfma_f32_16x16x32_bf16 v[172:175], v[72:75], v[56:59], v[172:175]
    ds_read_b64_tr_b16 v[66:67], v96 offset:52480
    v_mfma_f32_16x16x32_bf16 v[124:127], v[76:79], v[52:55], v[124:127]
    ds_read_b64_tr_b16 v[68:69], v96 offset:61696
    v_mfma_f32_16x16x32_bf16 v[172:175], v[76:79], v[60:63], v[172:175]
    ds_read_b64_tr_b16 v[70:71], v96 offset:64768
    s_waitcnt lgkmcnt(8)
    v_mfma_f32_16x16x32_bf16 v[128:131], v[80:83], v[48:51], v[128:131]
    ds_read_b64_tr_b16 v[72:73], v97 offset:49440
    buffer_load_dwordx4 v12, s[40:43], s33 offen offset:2048 lds
    v_mfma_f32_16x16x32_bf16 v[176:179], v[80:83], v[56:59], v[176:179]
    ds_read_b64_tr_b16 v[74:75], v97 offset:52512
    v_mfma_f32_16x16x32_bf16 v[128:131], v[84:87], v[52:55], v[128:131]
    ds_read_b64_tr_b16 v[76:77], v97 offset:61728
    v_mfma_f32_16x16x32_bf16 v[176:179], v[84:87], v[60:63], v[176:179]
    ds_read_b64_tr_b16 v[78:79], v97 offset:64800
    s_waitcnt lgkmcnt(8)
    v_mfma_f32_16x16x32_bf16 v[132:135], v[88:91], v[48:51], v[132:135]
    ds_read_b64_tr_b16 v[80:81], v98 offset:49472
    buffer_load_dwordx4 v13, s[40:43], s33 offen offset:3072 lds
    v_mfma_f32_16x16x32_bf16 v[180:183], v[88:91], v[56:59], v[180:183]
    ds_read_b64_tr_b16 v[82:83], v98 offset:52544
    v_mfma_f32_16x16x32_bf16 v[132:135], v[92:95], v[52:55], v[132:135]
    ds_read_b64_tr_b16 v[84:85], v98 offset:61760
    v_mfma_f32_16x16x32_bf16 v[180:183], v[92:95], v[60:63], v[180:183]
    ds_read_b64_tr_b16 v[86:87], v98 offset:64832
    s_waitcnt lgkmcnt(8)
    s_add_u32 m0, s34, 28672
    v_mfma_f32_16x16x32_bf16 v[136:139], v[64:67], v[48:51], v[136:139]
    ds_read_b64_tr_b16 v[88:89], v99 offset:49504
    buffer_load_dwordx4 v14, s[40:43], s33 offen offset:0 lds
    v_mfma_f32_16x16x32_bf16 v[184:187], v[64:67], v[56:59], v[184:187]
    ds_read_b64_tr_b16 v[90:91], v99 offset:52576
    v_mfma_f32_16x16x32_bf16 v[136:139], v[68:71], v[52:55], v[136:139]
    ds_read_b64_tr_b16 v[92:93], v99 offset:61792
    v_mfma_f32_16x16x32_bf16 v[184:187], v[68:71], v[60:63], v[184:187]
    ds_read_b64_tr_b16 v[94:95], v99 offset:64864
    s_waitcnt lgkmcnt(8)
    v_mfma_f32_16x16x32_bf16 v[140:143], v[72:75], v[48:51], v[140:143]
    buffer_load_dwordx4 v15, s[40:43], s33 offen offset:1024 lds
    v_mfma_f32_16x16x32_bf16 v[188:191], v[72:75], v[56:59], v[188:191]
    v_mfma_f32_16x16x32_bf16 v[140:143], v[76:79], v[52:55], v[140:143]
    v_mfma_f32_16x16x32_bf16 v[188:191], v[76:79], v[60:63], v[188:191]
    s_waitcnt lgkmcnt(0)
    s_waitcnt vmcnt(10)
    s_barrier
    v_mfma_f32_16x16x32_bf16 v[144:147], v[80:83], v[48:51], v[144:147]
    ds_read_b128 v[32:35], v22 offset:0
    ds_read_b64_tr_b16 v[64:65], v96 offset:0
    v_mfma_f32_16x16x32_bf16 v[192:195], v[80:83], v[56:59], v[192:195]
    ds_read_b128 v[36:39], v23 offset:0
    ds_read_b64_tr_b16 v[66:67], v96 offset:3072
    v_mfma_f32_16x16x32_bf16 v[144:147], v[84:87], v[52:55], v[144:147]
    ds_read_b128 v[40:43], v22 offset:2048
    ds_read_b64_tr_b16 v[68:69], v96 offset:12288
    v_mfma_f32_16x16x32_bf16 v[192:195], v[84:87], v[60:63], v[192:195]
    ds_read_b128 v[44:47], v23 offset:2048
    ds_read_b64_tr_b16 v[70:71], v96 offset:15360
    v_mfma_f32_16x16x32_bf16 v[148:151], v[88:91], v[48:51], v[148:151]
    ds_read_b64_tr_b16 v[72:73], v97 offset:32
    ds_read_b64_tr_b16 v[80:81], v98 offset:64
    v_mfma_f32_16x16x32_bf16 v[196:199], v[88:91], v[56:59], v[196:199]
    ds_read_b64_tr_b16 v[74:75], v97 offset:3104
    ds_read_b64_tr_b16 v[82:83], v98 offset:3136
    v_mfma_f32_16x16x32_bf16 v[148:151], v[92:95], v[52:55], v[148:151]
    ds_read_b64_tr_b16 v[76:77], v97 offset:12320
    ds_read_b64_tr_b16 v[84:85], v98 offset:12352
    v_mfma_f32_16x16x32_bf16 v[196:199], v[92:95], v[60:63], v[196:199]
    ds_read_b64_tr_b16 v[78:79], v97 offset:15392
    ds_read_b64_tr_b16 v[86:87], v98 offset:15424
    s_add_u32 s4, s76, 0x01500000
    s_addc_u32 s5, s77, 0
    s_mov_b32 s6, 0x002a8000
    s_mov_b32 s7, 0x00020000
    s_mul_i32 s36, s61, 348160
    s_mul_i32 s37, s20, 61440
    s_add_u32 s36, s36, s37
    v_add_u32 v29, s36, v30
    v_lshlrev_b32 v19, 7, v5
    s_lshl_b32 s48, s61, 11
    s_lshl_b32 s36, s20, 9
    s_add_u32 s48, s48, s36
    s_add_u32 s48, s48, 81920
    s_waitcnt lgkmcnt(8)
    s_add_u32 s32, s32, 128
    s_cmpk_eq_u32 s32, 1280
    s_cselect_b32 s32, 0, s32
    s_add_u32 m0, s47, 32768
    v_mfma_f32_16x16x32_bf16 v[104:107], v[64:67], v[32:35], v[104:107]
    ds_read_b64_tr_b16 v[88:89], v99 offset:96
    buffer_load_dwordx4 v6, s[88:91], s32 offen offset:0 lds
    v_mfma_f32_16x16x32_bf16 v[152:155], v[64:67], v[40:43], v[152:155]
    ds_read_b64_tr_b16 v[90:91], v99 offset:3168
    v_mfma_f32_16x16x32_bf16 v[104:107], v[68:71], v[36:39], v[104:107]
    ds_read_b64_tr_b16 v[92:93], v99 offset:12384
    buffer_load_dwordx4 v7, s[88:91], s32 offen offset:1024 lds
    v_mfma_f32_16x16x32_bf16 v[152:155], v[68:71], v[44:47], v[152:155]
    ds_read_b64_tr_b16 v[94:95], v99 offset:15456
    s_waitcnt lgkmcnt(5)
    v_mfma_f32_16x16x32_bf16 v[108:111], v[72:75], v[32:35], v[108:111]
    ds_read_b64_tr_b16 v[64:65], v96 offset:128
    buffer_load_dwordx4 v8, s[88:91], s32 offen offset:2048 lds
    v_mfma_f32_16x16x32_bf16 v[156:159], v[72:75], v[40:43], v[156:159]
    ds_read_b64_tr_b16 v[66:67], v96 offset:3200
    v_mfma_f32_16x16x32_bf16 v[108:111], v[76:79], v[36:39], v[108:111]
    ds_read_b64_tr_b16 v[68:69], v96 offset:12416
    buffer_load_dwordx4 v9, s[88:91], s32 offen offset:3072 lds
    v_mfma_f32_16x16x32_bf16 v[156:159], v[76:79], v[44:47], v[156:159]
    ds_read_b64_tr_b16 v[70:71], v96 offset:15488
    s_waitcnt lgkmcnt(8)
    s_mul_i32 s33, s32, 1536
    s_add_u32 m0, s34, 49152
    v_mfma_f32_16x16x32_bf16 v[112:115], v[80:83], v[32:35], v[112:115]
    ds_read_b64_tr_b16 v[72:73], v97 offset:160
    buffer_load_dwordx4 v10, s[40:43], s33 offen offset:0 lds
    v_mfma_f32_16x16x32_bf16 v[160:163], v[80:83], v[40:43], v[160:163]
    ds_read_b64_tr_b16 v[74:75], v97 offset:3232
    v_mfma_f32_16x16x32_bf16 v[112:115], v[84:87], v[36:39], v[112:115]
    ds_read_b64_tr_b16 v[76:77], v97 offset:12448
    buffer_load_dwordx4 v11, s[40:43], s33 offen offset:1024 lds
    v_mfma_f32_16x16x32_bf16 v[160:163], v[84:87], v[44:47], v[160:163]
    ds_read_b64_tr_b16 v[78:79], v97 offset:15520
    s_waitcnt lgkmcnt(8)
    v_mfma_f32_16x16x32_bf16 v[116:119], v[88:91], v[32:35], v[116:119]
    ds_read_b64_tr_b16 v[80:81], v98 offset:192
    buffer_load_dwordx4 v12, s[40:43], s33 offen offset:2048 lds
    v_mfma_f32_16x16x32_bf16 v[164:167], v[88:91], v[40:43], v[164:167]
    ds_read_b64_tr_b16 v[82:83], v98 offset:3264
    v_mfma_f32_16x16x32_bf16 v[116:119], v[92:95], v[36:39], v[116:119]
    ds_read_b64_tr_b16 v[84:85], v98 offset:12480
    buffer_load_dwordx4 v13, s[40:43], s33 offen offset:3072 lds
    v_mfma_f32_16x16x32_bf16 v[164:167], v[92:95], v[44:47], v[164:167]
    ds_read_b64_tr_b16 v[86:87], v98 offset:15552
    s_waitcnt lgkmcnt(8)
    s_add_u32 m0, s34, 53248
    v_mfma_f32_16x16x32_bf16 v[120:123], v[64:67], v[32:35], v[120:123]
    ds_read_b64_tr_b16 v[88:89], v99 offset:224
    buffer_load_dwordx4 v14, s[40:43], s33 offen offset:0 lds
    v_mfma_f32_16x16x32_bf16 v[168:171], v[64:67], v[40:43], v[168:171]
    ds_read_b64_tr_b16 v[90:91], v99 offset:3296
    v_mfma_f32_16x16x32_bf16 v[120:123], v[68:71], v[36:39], v[120:123]
    ds_read_b64_tr_b16 v[92:93], v99 offset:12512
    buffer_load_dwordx4 v15, s[40:43], s33 offen offset:1024 lds
    v_mfma_f32_16x16x32_bf16 v[168:171], v[68:71], v[44:47], v[168:171]
    ds_read_b64_tr_b16 v[94:95], v99 offset:15584
    s_waitcnt lgkmcnt(8)
    v_mfma_f32_16x16x32_bf16 v[124:127], v[72:75], v[32:35], v[124:127]
    ds_read_b64_tr_b16 v[64:65], v96 offset:256
    buffer_load_dword v18, v19, s[80:83], s48 offen sc1
    v_mfma_f32_16x16x32_bf16 v[172:175], v[72:75], v[40:43], v[172:175]
    ds_read_b64_tr_b16 v[66:67], v96 offset:3328
    v_mfma_f32_16x16x32_bf16 v[124:127], v[76:79], v[36:39], v[124:127]
    ds_read_b64_tr_b16 v[68:69], v96 offset:12544
    v_mfma_f32_16x16x32_bf16 v[172:175], v[76:79], v[44:47], v[172:175]
    ds_read_b64_tr_b16 v[70:71], v96 offset:15616
    s_waitcnt lgkmcnt(8)
    v_mfma_f32_16x16x32_bf16 v[128:131], v[80:83], v[32:35], v[128:131]
    ds_read_b64_tr_b16 v[72:73], v97 offset:288
    v_mfma_f32_16x16x32_bf16 v[176:179], v[80:83], v[40:43], v[176:179]
    ds_read_b64_tr_b16 v[74:75], v97 offset:3360
    v_mfma_f32_16x16x32_bf16 v[128:131], v[84:87], v[36:39], v[128:131]
    ds_read_b64_tr_b16 v[76:77], v97 offset:12576
    v_mfma_f32_16x16x32_bf16 v[176:179], v[84:87], v[44:47], v[176:179]
    ds_read_b64_tr_b16 v[78:79], v97 offset:15648
    s_waitcnt lgkmcnt(8)
    v_mfma_f32_16x16x32_bf16 v[132:135], v[88:91], v[32:35], v[132:135]
    ds_read_b64_tr_b16 v[80:81], v98 offset:320
    v_mfma_f32_16x16x32_bf16 v[180:183], v[88:91], v[40:43], v[180:183]
    ds_read_b64_tr_b16 v[82:83], v98 offset:3392
    v_mfma_f32_16x16x32_bf16 v[132:135], v[92:95], v[36:39], v[132:135]
    ds_read_b64_tr_b16 v[84:85], v98 offset:12608
    v_mfma_f32_16x16x32_bf16 v[180:183], v[92:95], v[44:47], v[180:183]
    ds_read_b64_tr_b16 v[86:87], v98 offset:15680
    s_waitcnt lgkmcnt(8)
    v_mfma_f32_16x16x32_bf16 v[136:139], v[64:67], v[32:35], v[136:139]
    ds_read_b64_tr_b16 v[88:89], v99 offset:352
    v_mfma_f32_16x16x32_bf16 v[184:187], v[64:67], v[40:43], v[184:187]
    ds_read_b64_tr_b16 v[90:91], v99 offset:3424
    v_mfma_f32_16x16x32_bf16 v[136:139], v[68:71], v[36:39], v[136:139]
    ds_read_b64_tr_b16 v[92:93], v99 offset:12640
    v_mfma_f32_16x16x32_bf16 v[184:187], v[68:71], v[44:47], v[184:187]
    ds_read_b64_tr_b16 v[94:95], v99 offset:15712
    s_waitcnt lgkmcnt(8)
    v_mfma_f32_16x16x32_bf16 v[140:143], v[72:75], v[32:35], v[140:143]
    v_mfma_f32_16x16x32_bf16 v[188:191], v[72:75], v[40:43], v[188:191]
    v_mfma_f32_16x16x32_bf16 v[140:143], v[76:79], v[36:39], v[140:143]
    v_mfma_f32_16x16x32_bf16 v[188:191], v[76:79], v[44:47], v[188:191]
    s_waitcnt lgkmcnt(0)
    s_waitcnt vmcnt(11)
    s_barrier
    v_mfma_f32_16x16x32_bf16 v[144:147], v[80:83], v[32:35], v[144:147]
    ds_read_b128 v[48:51], v22 offset:16384
    ds_read_b64_tr_b16 v[64:65], v96 offset:24576
    v_mfma_f32_16x16x32_bf16 v[192:195], v[80:83], v[40:43], v[192:195]
    ds_read_b128 v[52:55], v23 offset:16384
    ds_read_b64_tr_b16 v[66:67], v96 offset:27648
    v_mfma_f32_16x16x32_bf16 v[144:147], v[84:87], v[36:39], v[144:147]
    ds_read_b128 v[56:59], v22 offset:18432
    ds_read_b64_tr_b16 v[68:69], v96 offset:36864
    v_mfma_f32_16x16x32_bf16 v[192:195], v[84:87], v[44:47], v[192:195]
    ds_read_b128 v[60:63], v23 offset:18432
    ds_read_b64_tr_b16 v[70:71], v96 offset:39936
    v_mfma_f32_16x16x32_bf16 v[148:151], v[88:91], v[32:35], v[148:151]
    ds_read_b64_tr_b16 v[72:73], v97 offset:24608
    ds_read_b64_tr_b16 v[80:81], v98 offset:24640
    v_mfma_f32_16x16x32_bf16 v[196:199], v[88:91], v[40:43], v[196:199]
    ds_read_b64_tr_b16 v[74:75], v97 offset:27680
    ds_read_b64_tr_b16 v[82:83], v98 offset:27712
    v_mfma_f32_16x16x32_bf16 v[148:151], v[92:95], v[36:39], v[148:151]
    ds_read_b64_tr_b16 v[76:77], v97 offset:36896
    ds_read_b64_tr_b16 v[84:85], v98 offset:36928
    v_mfma_f32_16x16x32_bf16 v[196:199], v[92:95], v[44:47], v[196:199]
    ds_read_b64_tr_b16 v[78:79], v97 offset:39968
    ds_read_b64_tr_b16 v[86:87], v98 offset:40000
    s_lshl_b32 s36, s22, 4
    s_add_u32 s36, s36, 128
    v_add_u32 v101, s36, v3
    v_lshl_add_u32 v21, v3, 4, s21
    v_and_b32 v20, 1, v2
    v_cmp_eq_u32 vcc, 0, v20
    s_nop 1
    v_cndmask_b32 v101, v21, v101, vcc
    v_lshlrev_b32 v101, 7, v101
    v_add_u32 v101, 98304, v101
    s_cmp_lg_u32 s20, 0
    s_cbranch_scc1 W0_72
    buffer_load_dword v20, v101, s[80:83], 0 offen sc1
W0_72:
    s_waitcnt lgkmcnt(8)
    s_add_u32 s32, s32, 128
    s_cmpk_eq_u32 s32, 1280
    s_cselect_b32 s32, 0, s32
    s_add_u32 m0, s47, 0
    v_mfma_f32_16x16x32_bf16 v[104:107], v[64:67], v[48:51], v[104:107]
    ds_read_b64_tr_b16 v[88:89], v99 offset:24672
    buffer_load_dwordx4 v6, s[88:91], s32 offen offset:0 lds
    v_mfma_f32_16x16x32_bf16 v[152:155], v[64:67], v[56:59], v[152:155]
    ds_read_b64_tr_b16 v[90:91], v99 offset:27744
    v_mfma_f32_16x16x32_bf16 v[104:107], v[68:71], v[52:55], v[104:107]
    ds_read_b64_tr_b16 v[92:93], v99 offset:36960
    buffer_load_dwordx4 v7, s[88:91], s32 offen offset:1024 lds
    v_mfma_f32_16x16x32_bf16 v[152:155], v[68:71], v[60:63], v[152:155]
    ds_read_b64_tr_b16 v[94:95], v99 offset:40032
    s_waitcnt lgkmcnt(5)
    v_mfma_f32_16x16x32_bf16 v[108:111], v[72:75], v[48:51], v[108:111]
    ds_read_b64_tr_b16 v[64:65], v96 offset:24704
    buffer_load_dwordx4 v8, s[88:91], s32 offen offset:2048 lds
    v_mfma_f32_16x16x32_bf16 v[156:159], v[72:75], v[56:59], v[156:159]
    ds_read_b64_tr_b16 v[66:67], v96 offset:27776
    v_mfma_f32_16x16x32_bf16 v[108:111], v[76:79], v[52:55], v[108:111]
    ds_read_b64_tr_b16 v[68:69], v96 offset:36992
    buffer_load_dwordx4 v9, s[88:91], s32 offen offset:3072 lds
    v_mfma_f32_16x16x32_bf16 v[156:159], v[76:79], v[60:63], v[156:159]
    ds_read_b64_tr_b16 v[70:71], v96 offset:40064
    s_waitcnt lgkmcnt(8)
    s_mul_i32 s33, s32, 1536
    s_add_u32 m0, s34, 0
    v_mfma_f32_16x16x32_bf16 v[112:115], v[80:83], v[48:51], v[112:115]
    ds_read_b64_tr_b16 v[72:73], v97 offset:24736
    buffer_load_dwordx4 v10, s[40:43], s33 offen offset:0 lds
    v_mfma_f32_16x16x32_bf16 v[160:163], v[80:83], v[56:59], v[160:163]
    ds_read_b64_tr_b16 v[74:75], v97 offset:27808
    v_mfma_f32_16x16x32_bf16 v[112:115], v[84:87], v[52:55], v[112:115]
    ds_read_b64_tr_b16 v[76:77], v97 offset:37024
    buffer_load_dwordx4 v11, s[40:43], s33 offen offset:1024 lds
    v_mfma_f32_16x16x32_bf16 v[160:163], v[84:87], v[60:63], v[160:163]
    ds_read_b64_tr_b16 v[78:79], v97 offset:40096
    s_waitcnt lgkmcnt(8)
    v_mfma_f32_16x16x32_bf16 v[116:119], v[88:91], v[48:51], v[116:119]
    ds_read_b64_tr_b16 v[80:81], v98 offset:24768
    buffer_load_dwordx4 v12, s[40:43], s33 offen offset:2048 lds
    v_mfma_f32_16x16x32_bf16 v[164:167], v[88:91], v[56:59], v[164:167]
    ds_read_b64_tr_b16 v[82:83], v98 offset:27840
    v_mfma_f32_16x16x32_bf16 v[116:119], v[92:95], v[52:55], v[116:119]
    ds_read_b64_tr_b16 v[84:85], v98 offset:37056
    buffer_load_dwordx4 v13, s[40:43], s33 offen offset:3072 lds
    v_mfma_f32_16x16x32_bf16 v[164:167], v[92:95], v[60:63], v[164:167]
    ds_read_b64_tr_b16 v[86:87], v98 offset:40128
    s_waitcnt lgkmcnt(8)
    s_add_u32 m0, s34, 4096
    v_mfma_f32_16x16x32_bf16 v[120:123], v[64:67], v[48:51], v[120:123]
    ds_read_b64_tr_b16 v[88:89], v99 offset:24800
    buffer_load_dwordx4 v14, s[40:43], s33 offen offset:0 lds
    v_mfma_f32_16x16x32_bf16 v[168:171], v[64:67], v[56:59], v[168:171]
    ds_read_b64_tr_b16 v[90:91], v99 offset:27872
    v_mfma_f32_16x16x32_bf16 v[120:123], v[68:71], v[52:55], v[120:123]
    ds_read_b64_tr_b16 v[92:93], v99 offset:37088
    buffer_load_dwordx4 v15, s[40:43], s33 offen offset:1024 lds
    v_mfma_f32_16x16x32_bf16 v[168:171], v[68:71], v[60:63], v[168:171]
    ds_read_b64_tr_b16 v[94:95], v99 offset:40160
    s_waitcnt lgkmcnt(8)
    s_waitcnt vmcnt(10)
    s_mov_b32 s98, 0
PL_73:
    v_cmp_ne_u32 vcc, 1, v18
    s_cbranch_vccz PD_74
    s_add_u32 s98, s98, 1
    s_cmp_ge_u32 s98, 0x40000
    s_cbranch_scc1 PD_74
    s_sleep 4
    buffer_load_dword v18, v19, s[80:83], s48 offen sc1
    s_waitcnt vmcnt(0)
    s_branch PL_73
PD_74:
    s_mov_b32 s51, 0
    v_mfma_f32_16x16x32_bf16 v[124:127], v[72:75], v[48:51], v[124:127]
    ds_read_b64_tr_b16 v[64:65], v96 offset:24832
    buffer_load_dwordx4 a[0:3], v29, s[4:7], s51 offen offset:0
    v_mfma_f32_16x16x32_bf16 v[172:175], v[72:75], v[56:59], v[172:175]
    ds_read_b64_tr_b16 v[66:67], v96 offset:27904
    v_mfma_f32_16x16x32_bf16 v[124:127], v[76:79], v[52:55], v[124:127]
    ds_read_b64_tr_b16 v[68:69], v96 offset:37120
    buffer_load_dwordx4 a[4:7], v29, s[4:7], s51 offen offset:1024
    v_mfma_f32_16x16x32_bf16 v[172:175], v[76:79], v[60:63], v[172:175]
    ds_read_b64_tr_b16 v[70:71], v96 offset:40192
    s_waitcnt lgkmcnt(8)
    v_mfma_f32_16x16x32_bf16 v[128:131], v[80:83], v[48:51], v[128:131]
    ds_read_b64_tr_b16 v[72:73], v97 offset:24864
    buffer_load_dwordx4 a[8:11], v29, s[4:7], s51 offen offset:2048
    v_mfma_f32_16x16x32_bf16 v[176:179], v[80:83], v[56:59], v[176:179]
    ds_read_b64_tr_b16 v[74:75], v97 offset:27936
    v_mfma_f32_16x16x32_bf16 v[128:131], v[84:87], v[52:55], v[128:131]
    ds_read_b64_tr_b16 v[76:77], v97 offset:37152
    v_mfma_f32_16x16x32_bf16 v[176:179], v[84:87], v[60:63], v[176:179]
    ds_read_b64_tr_b16 v[78:79], v97 offset:40224
    s_waitcnt lgkmcnt(8)
    v_mfma_f32_16x16x32_bf16 v[132:135], v[88:91], v[48:51], v[132:135]
    ds_read_b64_tr_b16 v[80:81], v98 offset:24896
    v_mfma_f32_16x16x32_bf16 v[180:183], v[88:91], v[56:59], v[180:183]
    ds_read_b64_tr_b16 v[82:83], v98 offset:27968
    v_mfma_f32_16x16x32_bf16 v[132:135], v[92:95], v[52:55], v[132:135]
    ds_read_b64_tr_b16 v[84:85], v98 offset:37184
    v_mfma_f32_16x16x32_bf16 v[180:183], v[92:95], v[60:63], v[180:183]
    ds_read_b64_tr_b16 v[86:87], v98 offset:40256
    s_waitcnt lgkmcnt(8)
    v_mfma_f32_16x16x32_bf16 v[136:139], v[64:67], v[48:51], v[136:139]
    ds_read_b64_tr_b16 v[88:89], v99 offset:24928
    v_mfma_f32_16x16x32_bf16 v[184:187], v[64:67], v[56:59], v[184:187]
    ds_read_b64_tr_b16 v[90:91], v99 offset:28000
    v_mfma_f32_16x16x32_bf16 v[136:139], v[68:71], v[52:55], v[136:139]
    ds_read_b64_tr_b16 v[92:93], v99 offset:37216
    v_mfma_f32_16x16x32_bf16 v[184:187], v[68:71], v[60:63], v[184:187]
    ds_read_b64_tr_b16 v[94:95], v99 offset:40288
    s_waitcnt lgkmcnt(8)
    v_mfma_f32_16x16x32_bf16 v[140:143], v[72:75], v[48:51], v[140:143]
    v_mfma_f32_16x16x32_bf16 v[188:191], v[72:75], v[56:59], v[188:191]
    v_mfma_f32_16x16x32_bf16 v[140:143], v[76:79], v[52:55], v[140:143]
    v_mfma_f32_16x16x32_bf16 v[188:191], v[76:79], v[60:63], v[188:191]
    s_waitcnt lgkmcnt(0)
    s_waitcnt vmcnt(13)
    s_cmp_lg_u32 s20, 0
    s_cbranch_scc1 W0_75
    s_mov_b32 s98, 0
PL_76:
    v_cmp_ne_u32 vcc, 1, v20
    s_cbranch_vccz PD_77
    s_add_u32 s98, s98, 1
    s_cmp_ge_u32 s98, 0x40000
    s_cbranch_scc1 PD_77
    s_sleep 0
    buffer_load_dword v20, v101, s[80:83], 0 offen sc1
    s_waitcnt vmcnt(0)
    s_branch PL_76
PD_77:
W0_75:
    s_barrier
    v_mfma_f32_16x16x32_bf16 v[144:147], v[80:83], v[48:51], v[144:147]
    ds_read_b128 v[32:35], v22 offset:32768
    ds_read_b64_tr_b16 v[64:65], v96 offset:49152
    v_mfma_f32_16x16x32_bf16 v[192:195], v[80:83], v[56:59], v[192:195]
    ds_read_b128 v[36:39], v23 offset:32768
    ds_read_b64_tr_b16 v[66:67], v96 offset:52224
    v_mfma_f32_16x16x32_bf16 v[144:147], v[84:87], v[52:55], v[144:147]
    ds_read_b128 v[40:43], v22 offset:34816
    ds_read_b64_tr_b16 v[68:69], v96 offset:61440
    v_mfma_f32_16x16x32_bf16 v[192:195], v[84:87], v[60:63], v[192:195]
    ds_read_b128 v[44:47], v23 offset:34816
    ds_read_b64_tr_b16 v[70:71], v96 offset:64512
    v_mfma_f32_16x16x32_bf16 v[148:151], v[88:91], v[48:51], v[148:151]
    ds_read_b64_tr_b16 v[72:73], v97 offset:49184
    ds_read_b64_tr_b16 v[80:81], v98 offset:49216
    v_mfma_f32_16x16x32_bf16 v[196:199], v[88:91], v[56:59], v[196:199]
    ds_read_b64_tr_b16 v[74:75], v97 offset:52256
    ds_read_b64_tr_b16 v[82:83], v98 offset:52288
    v_mfma_f32_16x16x32_bf16 v[148:151], v[92:95], v[52:55], v[148:151]
    ds_read_b64_tr_b16 v[76:77], v97 offset:61472
    ds_read_b64_tr_b16 v[84:85], v98 offset:61504
    v_mfma_f32_16x16x32_bf16 v[196:199], v[92:95], v[60:63], v[196:199]
    ds_read_b64_tr_b16 v[78:79], v97 offset:64544
    ds_read_b64_tr_b16 v[86:87], v98 offset:64576
    v_min_u32 v26, 95, v0
    v_lshlrev_b32 v26, 3, v26
    v_add_u32 v31, 159744, v26
    v_and_b32 v27, 31, v1
    s_lshl_b32 s36, s20, 8
    v_lshl_add_u32 v27, v27, 3, s36
    v_lshrrev_b32 v25, 5, v1
    v_lshl_add_u32 v27, v25, 10, v27
    s_waitcnt lgkmcnt(8)
    v_mfma_f32_16x16x32_bf16 v[104:107], v[64:67], v[32:35], v[104:107]
    ds_read_b64_tr_b16 v[88:89], v99 offset:49248
    buffer_load_dwordx2 v[244:245], v27, s[80:83], s50 offen offset:0
    v_mfma_f32_16x16x32_bf16 v[152:155], v[64:67], v[40:43], v[152:155]
    ds_read_b64_tr_b16 v[90:91], v99 offset:52320
    v_mfma_f32_16x16x32_bf16 v[104:107], v[68:71], v[36:39], v[104:107]
    ds_read_b64_tr_b16 v[92:93], v99 offset:61536
    buffer_load_dwordx2 v[246:247], v27, s[80:83], s50 offen offset:2048
    v_mfma_f32_16x16x32_bf16 v[152:155], v[68:71], v[44:47], v[152:155]
    ds_read_b64_tr_b16 v[94:95], v99 offset:64608
    s_add_u32 s50, s50, 4096
    buffer_load_dwordx2 v[248:249], v27, s[80:83], s50 offen offset:0
    s_waitcnt lgkmcnt(5)
    v_mfma_f32_16x16x32_bf16 v[108:111], v[72:75], v[32:35], v[108:111]
    ds_read_b64_tr_b16 v[64:65], v96 offset:49280
    buffer_load_dwordx2 v[250:251], v27, s[80:83], s50 offen offset:2048
    v_mfma_f32_16x16x32_bf16 v[156:159], v[72:75], v[40:43], v[156:159]
    ds_read_b64_tr_b16 v[66:67], v96 offset:52352
    s_add_u32 s50, s50, 4096
    v_mfma_f32_16x16x32_bf16 v[108:111], v[76:79], v[36:39], v[108:111]
    ds_read_b64_tr_b16 v[68:69], v96 offset:61568
    buffer_load_dwordx2 v[252:253], v27, s[80:83], s50 offen offset:0
    v_mfma_f32_16x16x32_bf16 v[156:159], v[76:79], v[44:47], v[156:159]
    ds_read_b64_tr_b16 v[70:71], v96 offset:64640
    buffer_load_dwordx2 v[6:7], v26, s[80:83], s49 offen offset:0
    s_waitcnt lgkmcnt(8)
    v_mfma_f32_16x16x32_bf16 v[112:115], v[80:83], v[32:35], v[112:115]
    ds_read_b64_tr_b16 v[72:73], v97 offset:49312
    buffer_load_dwordx2 v[8:9], v26, s[80:83], s49 offen offset:1280
    v_mfma_f32_16x16x32_bf16 v[160:163], v[80:83], v[40:43], v[160:163]
    ds_read_b64_tr_b16 v[74:75], v97 offset:52384
    v_mfma_f32_16x16x32_bf16 v[112:115], v[84:87], v[36:39], v[112:115]
    ds_read_b64_tr_b16 v[76:77], v97 offset:61600
    buffer_load_dwordx2 v[10:11], v26, s[80:83], s49 offen offset:2560
    v_mfma_f32_16x16x32_bf16 v[160:163], v[84:87], v[44:47], v[160:163]
    ds_read_b64_tr_b16 v[78:79], v97 offset:64672
    buffer_load_dwordx2 v[12:13], v26, s[80:83], s49 offen offset:3840
    s_waitcnt lgkmcnt(8)
    s_add_u32 s49, s49, 5120
    v_mfma_f32_16x16x32_bf16 v[116:119], v[88:91], v[32:35], v[116:119]
    ds_read_b64_tr_b16 v[80:81], v98 offset:49344
    buffer_load_dwordx2 v[14:15], v26, s[80:83], s49 offen offset:0
    v_mfma_f32_16x16x32_bf16 v[164:167], v[88:91], v[40:43], v[164:167]
    ds_read_b64_tr_b16 v[82:83], v98 offset:52416
    v_mfma_f32_16x16x32_bf16 v[116:119], v[92:95], v[36:39], v[116:119]
    ds_read_b64_tr_b16 v[84:85], v98 offset:61632
    buffer_load_dwordx2 v[16:17], v26, s[80:83], s49 offen offset:1280
    v_mfma_f32_16x16x32_bf16 v[164:167], v[92:95], v[44:47], v[164:167]
    ds_read_b64_tr_b16 v[86:87], v98 offset:64704
    buffer_load_dwordx2 v[100:101], v26, s[80:83], s49 offen offset:2560
    s_waitcnt lgkmcnt(8)
    v_mfma_f32_16x16x32_bf16 v[120:123], v[64:67], v[32:35], v[120:123]
    ds_read_b64_tr_b16 v[88:89], v99 offset:49376
    buffer_load_dwordx2 v[102:103], v26, s[80:83], s49 offen offset:3840
    v_mfma_f32_16x16x32_bf16 v[168:171], v[64:67], v[40:43], v[168:171]
    ds_read_b64_tr_b16 v[90:91], v99 offset:52448
    s_add_u32 s49, s49, 5120
    v_mfma_f32_16x16x32_bf16 v[120:123], v[68:71], v[36:39], v[120:123]
    ds_read_b64_tr_b16 v[92:93], v99 offset:61664
    buffer_load_dwordx2 v[240:241], v26, s[80:83], s49 offen offset:0
    v_mfma_f32_16x16x32_bf16 v[168:171], v[68:71], v[44:47], v[168:171]
    ds_read_b64_tr_b16 v[94:95], v99 offset:64736
    buffer_load_dwordx2 v[242:243], v26, s[80:83], s49 offen offset:1280
    s_waitcnt lgkmcnt(8)
    v_mfma_f32_16x16x32_bf16 v[124:127], v[72:75], v[32:35], v[124:127]
    ds_read_b64_tr_b16 v[64:65], v96 offset:49408
    buffer_load_dwordx4 a[12:15], v29, s[4:7], s51 offen offset:3072
    v_mfma_f32_16x16x32_bf16 v[172:175], v[72:75], v[40:43], v[172:175]
    ds_read_b64_tr_b16 v[66:67], v96 offset:52480
    s_mov_b32 s51, 4096
    v_mfma_f32_16x16x32_bf16 v[124:127], v[76:79], v[36:39], v[124:127]
    ds_read_b64_tr_b16 v[68:69], v96 offset:61696
    buffer_load_dwordx4 a[16:19], v29, s[4:7], s51 offen offset:0
    v_mfma_f32_16x16x32_bf16 v[172:175], v[76:79], v[44:47], v[172:175]
    ds_read_b64_tr_b16 v[70:71], v96 offset:64768
    buffer_load_dwordx4 a[20:23], v29, s[4:7], s51 offen offset:1024
    s_waitcnt lgkmcnt(8)
    v_mfma_f32_16x16x32_bf16 v[128:131], v[80:83], v[32:35], v[128:131]
    ds_read_b64_tr_b16 v[72:73], v97 offset:49440
    buffer_load_dwordx4 a[24:27], v29, s[4:7], s51 offen offset:2048
    v_mfma_f32_16x16x32_bf16 v[176:179], v[80:83], v[40:43], v[176:179]
    ds_read_b64_tr_b16 v[74:75], v97 offset:52512
    v_mfma_f32_16x16x32_bf16 v[128:131], v[84:87], v[36:39], v[128:131]
    ds_read_b64_tr_b16 v[76:77], v97 offset:61728
    buffer_load_dwordx4 a[28:31], v29, s[4:7], s51 offen offset:3072
    v_mfma_f32_16x16x32_bf16 v[176:179], v[84:87], v[44:47], v[176:179]
    ds_read_b64_tr_b16 v[78:79], v97 offset:64800
    s_mov_b32 s51, 8192
    buffer_load_dwordx4 a[32:35], v29, s[4:7], s51 offen offset:0
    s_waitcnt lgkmcnt(8)
    v_mfma_f32_16x16x32_bf16 v[132:135], v[88:91], v[32:35], v[132:135]
    ds_read_b64_tr_b16 v[80:81], v98 offset:49472
    buffer_load_dwordx4 a[36:39], v29, s[4:7], s51 offen offset:1024
    v_mfma_f32_16x16x32_bf16 v[180:183], v[88:91], v[40:43], v[180:183]
    ds_read_b64_tr_b16 v[82:83], v98 offset:52544
    v_mfma_f32_16x16x32_bf16 v[132:135], v[92:95], v[36:39], v[132:135]
    ds_read_b64_tr_b16 v[84:85], v98 offset:61760
    v_mfma_f32_16x16x32_bf16 v[180:183], v[92:95], v[44:47], v[180:183]
    ds_read_b64_tr_b16 v[86:87], v98 offset:64832
    s_waitcnt lgkmcnt(8)
    v_mfma_f32_16x16x32_bf16 v[136:139], v[64:67], v[32:35], v[136:139]
    ds_read_b64_tr_b16 v[88:89], v99 offset:49504
    v_mfma_f32_16x16x32_bf16 v[184:187], v[64:67], v[40:43], v[184:187]
    ds_read_b64_tr_b16 v[90:91], v99 offset:52576
    v_mfma_f32_16x16x32_bf16 v[136:139], v[68:71], v[36:39], v[136:139]
    ds_read_b64_tr_b16 v[92:93], v99 offset:61792
    v_mfma_f32_16x16x32_bf16 v[184:187], v[68:71], v[44:47], v[184:187]
    ds_read_b64_tr_b16 v[94:95], v99 offset:64864
    s_waitcnt lgkmcnt(8)
    v_mfma_f32_16x16x32_bf16 v[140:143], v[72:75], v[32:35], v[140:143]
    v_mfma_f32_16x16x32_bf16 v[188:191], v[72:75], v[40:43], v[188:191]
    v_mfma_f32_16x16x32_bf16 v[140:143], v[76:79], v[36:39], v[140:143]
    v_mfma_f32_16x16x32_bf16 v[188:191], v[76:79], v[44:47], v[188:191]
    s_waitcnt lgkmcnt(0)
    s_waitcnt vmcnt(25)
    s_barrier
    v_mfma_f32_16x16x32_bf16 v[144:147], v[80:83], v[32:35], v[144:147]
    ds_read_b128 v[48:51], v22 offset:0
    ds_read_b64_tr_b16 v[64:65], v96 offset:0
    v_mfma_f32_16x16x32_bf16 v[192:195], v[80:83], v[40:43], v[192:195]
    ds_read_b128 v[52:55], v23 offset:0
    ds_read_b64_tr_b16 v[66:67], v96 offset:3072
    v_mfma_f32_16x16x32_bf16 v[144:147], v[84:87], v[36:39], v[144:147]
    ds_read_b128 v[56:59], v22 offset:2048
    ds_read_b64_tr_b16 v[68:69], v96 offset:12288
    v_mfma_f32_16x16x32_bf16 v[192:195], v[84:87], v[44:47], v[192:195]
    ds_read_b128 v[60:63], v23 offset:2048
    ds_read_b64_tr_b16 v[70:71], v96 offset:15360
    v_mfma_f32_16x16x32_bf16 v[148:151], v[88:91], v[32:35], v[148:151]
    ds_read_b64_tr_b16 v[72:73], v97 offset:32
    ds_read_b64_tr_b16 v[80:81], v98 offset:64
    v_mfma_f32_16x16x32_bf16 v[196:199], v[88:91], v[40:43], v[196:199]
    ds_read_b64_tr_b16 v[74:75], v97 offset:3104
    ds_read_b64_tr_b16 v[82:83], v98 offset:3136
    v_mfma_f32_16x16x32_bf16 v[148:151], v[92:95], v[36:39], v[148:151]
    ds_read_b64_tr_b16 v[76:77], v97 offset:12320
    ds_read_b64_tr_b16 v[84:85], v98 offset:12352
    v_mfma_f32_16x16x32_bf16 v[196:199], v[92:95], v[44:47], v[196:199]
    ds_read_b64_tr_b16 v[78:79], v97 offset:15392
    ds_read_b64_tr_b16 v[86:87], v98 offset:15424
    s_waitcnt lgkmcnt(8)
    s_mov_b32 s51, 28672
    v_mfma_f32_16x16x32_bf16 v[104:107], v[64:67], v[48:51], v[104:107]
    ds_read_b64_tr_b16 v[88:89], v99 offset:96
    buffer_load_dwordx4 a[120:123], v29, s[4:7], s51 offen offset:2048
    v_mfma_f32_16x16x32_bf16 v[152:155], v[64:67], v[56:59], v[152:155]
    ds_read_b64_tr_b16 v[90:91], v99 offset:3168
    v_mfma_f32_16x16x32_bf16 v[104:107], v[68:71], v[52:55], v[104:107]
    ds_read_b64_tr_b16 v[92:93], v99 offset:12384
    v_mfma_f32_16x16x32_bf16 v[152:155], v[68:71], v[60:63], v[152:155]
    ds_read_b64_tr_b16 v[94:95], v99 offset:15456
    s_waitcnt lgkmcnt(5)
    v_mfma_f32_16x16x32_bf16 v[108:111], v[72:75], v[48:51], v[108:111]
    ds_read_b64_tr_b16 v[64:65], v96 offset:128
    buffer_load_dwordx4 a[124:127], v29, s[4:7], s51 offen offset:3072
    v_mfma_f32_16x16x32_bf16 v[156:159], v[72:75], v[56:59], v[156:159]
    ds_read_b64_tr_b16 v[66:67], v96 offset:3200
    v_mfma_f32_16x16x32_bf16 v[108:111], v[76:79], v[52:55], v[108:111]
    ds_read_b64_tr_b16 v[68:69], v96 offset:12416
    v_mfma_f32_16x16x32_bf16 v[156:159], v[76:79], v[60:63], v[156:159]
    ds_read_b64_tr_b16 v[70:71], v96 offset:15488
    s_waitcnt lgkmcnt(8)
    s_mov_b32 s51, 32768
    v_mfma_f32_16x16x32_bf16 v[112:115], v[80:83], v[48:51], v[112:115]
    ds_read_b64_tr_b16 v[72:73], v97 offset:160
    buffer_load_dwordx4 a[128:131], v29, s[4:7], s51 offen offset:0
    v_mfma_f32_16x16x32_bf16 v[160:163], v[80:83], v[56:59], v[160:163]
    ds_read_b64_tr_b16 v[74:75], v97 offset:3232
    v_mfma_f32_16x16x32_bf16 v[112:115], v[84:87], v[52:55], v[112:115]
    ds_read_b64_tr_b16 v[76:77], v97 offset:12448
    v_mfma_f32_16x16x32_bf16 v[160:163], v[84:87], v[60:63], v[160:163]
    ds_read_b64_tr_b16 v[78:79], v97 offset:15520
    s_waitcnt lgkmcnt(8)
    v_mfma_f32_16x16x32_bf16 v[116:119], v[88:91], v[48:51], v[116:119]
    ds_read_b64_tr_b16 v[80:81], v98 offset:192
    buffer_load_dwordx4 a[132:135], v29, s[4:7], s51 offen offset:1024
    v_mfma_f32_16x16x32_bf16 v[164:167], v[88:91], v[56:59], v[164:167]
    ds_read_b64_tr_b16 v[82:83], v98 offset:3264
    v_mfma_f32_16x16x32_bf16 v[116:119], v[92:95], v[52:55], v[116:119]
    ds_read_b64_tr_b16 v[84:85], v98 offset:12480
    v_mfma_f32_16x16x32_bf16 v[164:167], v[92:95], v[60:63], v[164:167]
    ds_read_b64_tr_b16 v[86:87], v98 offset:15552
    s_waitcnt lgkmcnt(8)
    v_mfma_f32_16x16x32_bf16 v[120:123], v[64:67], v[48:51], v[120:123]
    ds_read_b64_tr_b16 v[88:89], v99 offset:224
    buffer_load_dwordx4 a[136:139], v29, s[4:7], s51 offen offset:2048
    v_mfma_f32_16x16x32_bf16 v[168:171], v[64:67], v[56:59], v[168:171]
    ds_read_b64_tr_b16 v[90:91], v99 offset:3296
    v_mfma_f32_16x16x32_bf16 v[120:123], v[68:71], v[52:55], v[120:123]
    ds_read_b64_tr_b16 v[92:93], v99 offset:12512
    v_mfma_f32_16x16x32_bf16 v[168:171], v[68:71], v[60:63], v[168:171]
    ds_read_b64_tr_b16 v[94:95], v99 offset:15584
    s_waitcnt lgkmcnt(8)
    v_mfma_f32_16x16x32_bf16 v[124:127], v[72:75], v[48:51], v[124:127]
    ds_read_b64_tr_b16 v[64:65], v96 offset:256
    buffer_load_dwordx4 a[140:143], v29, s[4:7], s51 offen offset:3072
    v_mfma_f32_16x16x32_bf16 v[172:175], v[72:75], v[56:59], v[172:175]
    ds_read_b64_tr_b16 v[66:67], v96 offset:3328
    v_mfma_f32_16x16x32_bf16 v[124:127], v[76:79], v[52:55], v[124:127]
    ds_read_b64_tr_b16 v[68:69], v96 offset:12544
    v_mfma_f32_16x16x32_bf16 v[172:175], v[76:79], v[60:63], v[172:175]
    ds_read_b64_tr_b16 v[70:71], v96 offset:15616
    s_waitcnt lgkmcnt(8)
    s_mov_b32 s51, 36864
    v_mfma_f32_16x16x32_bf16 v[128:131], v[80:83], v[48:51], v[128:131]
    ds_read_b64_tr_b16 v[72:73], v97 offset:288
    buffer_load_dwordx4 a[144:147], v29, s[4:7], s51 offen offset:0
    v_mfma_f32_16x16x32_bf16 v[176:179], v[80:83], v[56:59], v[176:179]
    ds_read_b64_tr_b16 v[74:75], v97 offset:3360
    v_mfma_f32_16x16x32_bf16 v[128:131], v[84:87], v[52:55], v[128:131]
    ds_read_b64_tr_b16 v[76:77], v97 offset:12576
    v_mfma_f32_16x16x32_bf16 v[176:179], v[84:87], v[60:63], v[176:179]
    ds_read_b64_tr_b16 v[78:79], v97 offset:15648
    s_waitcnt lgkmcnt(8)
    v_mfma_f32_16x16x32_bf16 v[132:135], v[88:91], v[48:51], v[132:135]
    ds_read_b64_tr_b16 v[80:81], v98 offset:320
    buffer_load_dwordx4 a[148:151], v29, s[4:7], s51 offen offset:1024
    v_mfma_f32_16x16x32_bf16 v[180:183], v[88:91], v[56:59], v[180:183]
    ds_read_b64_tr_b16 v[82:83], v98 offset:3392
    v_mfma_f32_16x16x32_bf16 v[132:135], v[92:95], v[52:55], v[132:135]
    ds_read_b64_tr_b16 v[84:85], v98 offset:12608
    v_mfma_f32_16x16x32_bf16 v[180:183], v[92:95], v[60:63], v[180:183]
    ds_read_b64_tr_b16 v[86:87], v98 offset:15680
    s_waitcnt lgkmcnt(8)
    v_mfma_f32_16x16x32_bf16 v[136:139], v[64:67], v[48:51], v[136:139]
    ds_read_b64_tr_b16 v[88:89], v99 offset:352
    buffer_load_dwordx4 a[152:155], v29, s[4:7], s51 offen offset:2048
    s_waitcnt vmcnt(16)
    v_pk_add_f32 v[6:7], v[6:7], v[8:9]
    v_pk_add_f32 v[10:11], v[10:11], v[12:13]
    v_pk_add_f32 v[14:15], v[14:15], v[16:17]
    v_mfma_f32_16x16x32_bf16 v[184:187], v[64:67], v[56:59], v[184:187]
    ds_read_b64_tr_b16 v[90:91], v99 offset:3424
    v_pk_add_f32 v[100:101], v[100:101], v[102:103]
    v_pk_add_f32 v[240:241], v[240:241], v[242:243]
    v_pk_add_f32 v[6:7], v[6:7], v[10:11]
    v_pk_add_f32 v[14:15], v[14:15], v[100:101]
    v_mfma_f32_16x16x32_bf16 v[136:139], v[68:71], v[52:55], v[136:139]
    ds_read_b64_tr_b16 v[92:93], v99 offset:12640
    v_pk_add_f32 v[6:7], v[6:7], v[240:241]
    v_pk_add_f32 v[6:7], v[6:7], v[14:15]
    ds_write_b64 v31, v[6:7]
    v_pk_add_f32 v[244:245], v[244:245], v[246:247]
    v_mfma_f32_16x16x32_bf16 v[184:187], v[68:71], v[60:63], v[184:187]
    ds_read_b64_tr_b16 v[94:95], v99 offset:15712
    v_pk_add_f32 v[248:249], v[248:249], v[250:251]
    v_pk_add_f32 v[244:245], v[244:245], v[252:253]
    v_pk_add_f32 v[244:245], v[244:245], v[248:249]
    v_mov_b32 v246, v244
    s_waitcnt lgkmcnt(9)
    v_mfma_f32_16x16x32_bf16 v[140:143], v[72:75], v[48:51], v[140:143]
    buffer_load_dwordx4 a[156:159], v29, s[4:7], s51 offen offset:3072
    v_mov_b32 v247, v245
    v_permlane32_swap_b32 v244, v246
    s_nop 0
    v_permlane32_swap_b32 v245, v247
    v_add_f32 v248, v244, v246
    v_mfma_f32_16x16x32_bf16 v[188:191], v[72:75], v[56:59], v[188:191]
    v_add_f32 v249, v245, v247
    v_mul_f32 v248, 0x3acccccd, v248
    v_mul_f32 v249, 0x3acccccd, v249
    v_fma_f32 v249, -v248, v248, v249
    v_mfma_f32_16x16x32_bf16 v[140:143], v[76:79], v[52:55], v[140:143]
    v_max_f32 v249, 0, v249
    v_cvt_pk_bf16_f32 v250, v248, v249
    v_and_b32 v244, 0xffff0000, v250
    v_lshlrev_b32 v250, 16, v250
    v_mfma_f32_16x16x32_bf16 v[188:191], v[76:79], v[60:63], v[188:191]
    v_add_f32 v244, 0x3727c5ac, v244
    v_cvt_pk_bf16_f32 v244, v244, v244
    v_lshlrev_b32 v244, 16, v244
    v_sqrt_f32 v244, v244
    s_waitcnt lgkmcnt(5)
    v_mfma_f32_16x16x32_bf16 v[144:147], v[80:83], v[48:51], v[144:147]
    v_cvt_pk_bf16_f32 v244, v244, v244
    v_lshlrev_b32 v244, 16, v244
    v_rcp_f32 v244, v244
    s_nop 0
    v_mul_f32 v246, -v250, v244
    v_mfma_f32_16x16x32_bf16 v[192:195], v[80:83], v[56:59], v[192:195]
    v_sub_f32 v248, v248, v250
    v_mul_f32 v248, v248, v244
    v_mul_f32 v249, v249, v244
    v_mul_f32 v249, v249, v244
    v_mfma_f32_16x16x32_bf16 v[144:147], v[84:87], v[52:55], v[144:147]
    v_cvt_pk_bf16_f32 v250, v248, v249
    v_and_b32 v249, 0xffff0000, v250
    v_lshlrev_b32 v250, 16, v250
    v_add_f32 v249, 0x3727c5ac, v249
    v_mfma_f32_16x16x32_bf16 v[192:195], v[84:87], v[60:63], v[192:195]
    v_cvt_pk_bf16_f32 v249, v249, v249
    v_lshlrev_b32 v249, 16, v249
    v_sqrt_f32 v249, v249
    s_nop 0
    v_cvt_pk_bf16_f32 v249, v249, v249
    s_waitcnt lgkmcnt(0)
    v_mfma_f32_16x16x32_bf16 v[148:151], v[88:91], v[48:51], v[148:151]
    v_lshlrev_b32 v249, 16, v249
    v_rcp_f32 v249, v249
    v_sub_f32 v250, v246, v250
    v_mul_f32 v240, v244, v249
    v_mfma_f32_16x16x32_bf16 v[196:199], v[88:91], v[56:59], v[196:199]
    v_mul_f32 v242, v250, v249
    v_mov_b32 v241, v240
    v_mov_b32 v243, v242
    s_nop 0
    v_permlane16_swap_b32 v240, v241
    v_mfma_f32_16x16x32_bf16 v[148:151], v[92:95], v[52:55], v[148:151]
    v_permlane16_swap_b32 v242, v243
    v_mfma_f32_16x16x32_bf16 v[196:199], v[92:95], v[60:63], v[196:199]
    s_waitcnt lgkmcnt(0)
    s_barrier
    s_add_u32 s12, s24, 0x00780000
    s_addc_u32 s13, s25, 0
    s_mov_b32 s14, 0x00600000
    s_mov_b32 s15, 0x00020000
    v_lshlrev_b32 v24, 4, v2
    v_add_u32 v24, 159744, v24
    ds_read_b128 v[32:35], v24 offset:0
    ds_read_b128 v[36:39], v24 offset:1280
    ds_read_b128 v[40:43], v24 offset:64
    ds_read_b128 v[44:47], v24 offset:1344
    s_mul_i32 s36, s23, 49152
    s_mul_i32 s37, s22, 6144
    s_add_u32 s36, s36, s37
    v_add_u32 v6, s36, v30
    v_add_u32 v7, 4096, v6
    v_add_u32 v8, 49152, v6
    v_add_u32 v9, 53248, v6
    s_mov_b32 s36, 0xc0135761
    s_mov_b32 s37, 0xc0135761
    v_mov_b32 v26, 0xbdd2d3e8
    v_mov_b32 v27, 0xbdd2d3e8
    s_mov_b32 s28, s70
    s_mov_b32 s29, s71
    s_mov_b32 s30, 0x00000500
    s_mov_b32 s31, 0x00020000
    s_mul_i32 s32, s61, 160
    v_lshlrev_b32 v28, 3, v2
    buffer_load_dwordx2 v[200:201], v28, s[28:31], s32 offen offset:0
    buffer_load_dwordx2 v[202:203], v28, s[28:31], s32 offen offset:32
    buffer_load_dwordx2 v[204:205], v28, s[28:31], s32 offen offset:64
    buffer_load_dwordx2 v[206:207], v28, s[28:31], s32 offen offset:96
    buffer_load_dwordx2 v[248:249], v28, s[28:31], s32 offen offset:128
    s_add_u32 s16, s76, 0x00780000
    s_addc_u32 s17, s77, 0
    s_mov_b32 s18, 0x00600000
    s_mov_b32 s19, 0x00020000
    s_add_u32 s8, s76, 0x00500000
    s_addc_u32 s9, s77, 0
    s_mov_b32 s10, 0x00280000
    s_mov_b32 s11, 0x00020000
    s_lshl_b32 s34, s21, 9
    s_lshl_b32 s33, s20, 7
    s_add_u32 s34, s34, s33
    v_and_b32 v15, 7, v1
    v_lshl_add_u32 v15, v15, 2, s34
    s_lshl_b32 s33, s22, 2
    s_add_u32 s56, s34, s33
    s_add_u32 s56, s56, 64
    s_mul_i32 s33, s20, 12288
    v_add_u32 v10, s33, v30
    s_add_u32 s33, s33, 4096
    v_add_u32 v11, s33, v30
    s_add_u32 s33, s33, 4096
    v_add_u32 v12, s33, v30
    s_lshl_b32 s33, s21, 3
    s_lshl_b32 s32, s20, 1
    s_add_u32 s32, s32, 2
    s_and_b32 s32, s32, 7
    s_add_u32 s32, s32, s33
    s_mul_i32 s40, s32, 49152
    s_lshl_b32 s32, s20, 1
    s_add_u32 s32, s32, 3
    s_and_b32 s32, s32, 7
    s_add_u32 s32, s32, s33
    s_mul_i32 s41, s32, 49152
    s_lshl_b32 s32, s20, 1
    s_add_u32 s32, s32, 4
    s_and_b32 s32, s32, 7
    s_add_u32 s32, s32, s33
    s_mul_i32 s42, s32, 49152
    s_lshl_b32 s32, s20, 1
    s_add_u32 s32, s32, 5
    s_and_b32 s32, s32, 7
    s_add_u32 s32, s32, s33
    s_mul_i32 s43, s32, 49152
    s_lshl_b32 s32, s20, 1
    s_add_u32 s32, s32, 6
    s_and_b32 s32, s32, 7
    s_add_u32 s32, s32, s33
    s_mul_i32 s44, s32, 49152
    s_lshl_b32 s32, s20, 1
    s_add_u32 s32, s32, 7
    s_and_b32 s32, s32, 7
    s_add_u32 s32, s32, s33
    s_mul_i32 s45, s32, 49152
    s_lshl_b32 s32, s20, 1
    s_add_u32 s32, s32, 8
    s_and_b32 s32, s32, 7
    s_add_u32 s32, s32, s33
    s_mul_i32 s46, s32, 49152
    s_lshl_b32 s32, s20, 1
    s_add_u32 s32, s32, 9
    s_and_b32 s32, s32, 7
    s_add_u32 s32, s32, s33
    s_mul_i32 s47, s32, 49152
    s_mul_i32 s32, s20, 30720
    v_add_u32 v13, s32, v30
    s_lshl_b32 s32, s21, 3
    s_add_u32 s32, s32, s61
    s_lshl_b32 s32, s32, 2
    s_add_u32 s32, s32, s20
    s_mul_i32 s32, s32, 5120
    v_add_u32 v31, s32, v30
    v_mov_b32 v251, v29
    v_mov_b32 v16, 1
    v_mov_b32 v17, 2
    v_mov_b32 v250, 3
    ds_read_b128 v[48:51], v24 offset:128
    ds_read_b128 v[52:55], v24 offset:1408
    ds_read_b128 v[56:59], v24 offset:192
    ds_read_b128 v[60:63], v24 offset:1472
    s_waitcnt lgkmcnt(4)
    v_pk_fma_f32 v[80:81], v[32:33], v[242:243], v[36:37] op_sel:[0,0,0] op_sel_hi:[1,0,1]
    v_pk_fma_f32 v[82:83], v[34:35], v[242:243], v[38:39] op_sel:[0,0,0] op_sel_hi:[1,0,1]
    v_pk_fma_f32 v[104:105], v[104:105], v[240:241], v[80:81] op_sel:[0,0,0] op_sel_hi:[1,0,1]
    v_pk_fma_f32 v[106:107], v[106:107], v[240:241], v[82:83] op_sel:[0,0,0] op_sel_hi:[1,0,1]
    v_pk_mul_f32 v[80:81], v[104:105], v[104:105]
    v_pk_mul_f32 v[82:83], v[106:107], v[106:107]
    v_pk_fma_f32 v[80:81], v[80:81], v[26:27], s[36:37]
    v_pk_fma_f32 v[82:83], v[82:83], v[26:27], s[36:37]
    v_pk_mul_f32 v[80:81], v[80:81], v[104:105]
    v_pk_mul_f32 v[82:83], v[82:83], v[106:107]
    v_exp_f32 v80, v80
    v_exp_f32 v81, v81
    v_exp_f32 v82, v82
    v_exp_f32 v83, v83
    v_pk_add_f32 v[80:81], v[80:81], 1.0 op_sel_hi:[1,0]
    v_pk_add_f32 v[82:83], v[82:83], 1.0 op_sel_hi:[1,0]
    v_rcp_f32 v80, v80
    v_rcp_f32 v81, v81
    v_rcp_f32 v82, v82
    v_rcp_f32 v83, v83
    v_pk_mul_f32 v[104:105], v[104:105], v[80:81]
    v_pk_mul_f32 v[106:107], v[106:107], v[82:83]
    v_cvt_pk_bf16_f32 v64, v104, v105
    v_cvt_pk_bf16_f32 v65, v106, v107
    s_mov_b32 s51, 8192
    buffer_load_dwordx4 a[40:43], v29, s[4:7], s51 offen offset:2048
    buffer_load_dwordx4 a[44:47], v29, s[4:7], s51 offen offset:3072
    v_pk_fma_f32 v[84:85], v[40:41], v[242:243], v[44:45] op_sel:[0,0,0] op_sel_hi:[1,0,1]
    v_pk_fma_f32 v[86:87], v[42:43], v[242:243], v[46:47] op_sel:[0,0,0] op_sel_hi:[1,0,1]
    v_pk_fma_f32 v[108:109], v[108:109], v[240:241], v[84:85] op_sel:[0,0,0] op_sel_hi:[1,0,1]
    v_pk_fma_f32 v[110:111], v[110:111], v[240:241], v[86:87] op_sel:[0,0,0] op_sel_hi:[1,0,1]
    v_pk_mul_f32 v[84:85], v[108:109], v[108:109]
    v_pk_mul_f32 v[86:87], v[110:111], v[110:111]
    v_pk_fma_f32 v[84:85], v[84:85], v[26:27], s[36:37]
    v_pk_fma_f32 v[86:87], v[86:87], v[26:27], s[36:37]
    v_pk_mul_f32 v[84:85], v[84:85], v[108:109]
    v_pk_mul_f32 v[86:87], v[86:87], v[110:111]
    v_exp_f32 v84, v84
    v_exp_f32 v85, v85
    v_exp_f32 v86, v86
    v_exp_f32 v87, v87
    v_pk_add_f32 v[84:85], v[84:85], 1.0 op_sel_hi:[1,0]
    v_pk_add_f32 v[86:87], v[86:87], 1.0 op_sel_hi:[1,0]
    v_rcp_f32 v84, v84
    v_rcp_f32 v85, v85
    v_rcp_f32 v86, v86
    v_rcp_f32 v87, v87
    v_pk_mul_f32 v[108:109], v[108:109], v[84:85]
    v_pk_mul_f32 v[110:111], v[110:111], v[86:87]
    v_cvt_pk_bf16_f32 v66, v108, v109
    v_cvt_pk_bf16_f32 v67, v110, v111
    s_mov_b32 s51, 12288
    buffer_load_dwordx4 a[48:51], v29, s[4:7], s51 offen offset:0
    buffer_store_dwordx4 v[64:67], v6, s[12:15], 0 offen offset:0 sc1
    v_pk_fma_f32 v[80:81], v[32:33], v[242:243], v[36:37] op_sel:[0,1,0] op_sel_hi:[1,1,1]
    v_pk_fma_f32 v[82:83], v[34:35], v[242:243], v[38:39] op_sel:[0,1,0] op_sel_hi:[1,1,1]
    v_pk_fma_f32 v[152:153], v[152:153], v[240:241], v[80:81] op_sel:[0,1,0] op_sel_hi:[1,1,1]
    v_pk_fma_f32 v[154:155], v[154:155], v[240:241], v[82:83] op_sel:[0,1,0] op_sel_hi:[1,1,1]
    v_pk_mul_f32 v[80:81], v[152:153], v[152:153]
    v_pk_mul_f32 v[82:83], v[154:155], v[154:155]
    v_pk_fma_f32 v[80:81], v[80:81], v[26:27], s[36:37]
    v_pk_fma_f32 v[82:83], v[82:83], v[26:27], s[36:37]
    v_pk_mul_f32 v[80:81], v[80:81], v[152:153]
    v_pk_mul_f32 v[82:83], v[82:83], v[154:155]
    v_exp_f32 v80, v80
    v_exp_f32 v81, v81
    v_exp_f32 v82, v82
    v_exp_f32 v83, v83
    v_pk_add_f32 v[80:81], v[80:81], 1.0 op_sel_hi:[1,0]
    v_pk_add_f32 v[82:83], v[82:83], 1.0 op_sel_hi:[1,0]
    v_rcp_f32 v80, v80
    v_rcp_f32 v81, v81
    v_rcp_f32 v82, v82
    v_rcp_f32 v83, v83
    v_pk_mul_f32 v[152:153], v[152:153], v[80:81]
    v_pk_mul_f32 v[154:155], v[154:155], v[82:83]
    v_cvt_pk_bf16_f32 v68, v152, v153
    v_cvt_pk_bf16_f32 v69, v154, v155
    buffer_load_dwordx4 a[52:55], v29, s[4:7], s51 offen offset:1024
    buffer_load_dwordx4 a[56:59], v29, s[4:7], s51 offen offset:2048
    v_pk_fma_f32 v[84:85], v[40:41], v[242:243], v[44:45] op_sel:[0,1,0] op_sel_hi:[1,1,1]
    v_pk_fma_f32 v[86:87], v[42:43], v[242:243], v[46:47] op_sel:[0,1,0] op_sel_hi:[1,1,1]
    v_pk_fma_f32 v[156:157], v[156:157], v[240:241], v[84:85] op_sel:[0,1,0] op_sel_hi:[1,1,1]
    v_pk_fma_f32 v[158:159], v[158:159], v[240:241], v[86:87] op_sel:[0,1,0] op_sel_hi:[1,1,1]
    v_pk_mul_f32 v[84:85], v[156:157], v[156:157]
    v_pk_mul_f32 v[86:87], v[158:159], v[158:159]
    v_pk_fma_f32 v[84:85], v[84:85], v[26:27], s[36:37]
    v_pk_fma_f32 v[86:87], v[86:87], v[26:27], s[36:37]
    v_pk_mul_f32 v[84:85], v[84:85], v[156:157]
    v_pk_mul_f32 v[86:87], v[86:87], v[158:159]
    v_exp_f32 v84, v84
    v_exp_f32 v85, v85
    v_exp_f32 v86, v86
    v_exp_f32 v87, v87
    v_pk_add_f32 v[84:85], v[84:85], 1.0 op_sel_hi:[1,0]
    v_pk_add_f32 v[86:87], v[86:87], 1.0 op_sel_hi:[1,0]
    v_rcp_f32 v84, v84
    v_rcp_f32 v85, v85
    v_rcp_f32 v86, v86
    v_rcp_f32 v87, v87
    v_pk_mul_f32 v[156:157], v[156:157], v[84:85]
    v_pk_mul_f32 v[158:159], v[158:159], v[86:87]
    v_cvt_pk_bf16_f32 v70, v156, v157
    v_cvt_pk_bf16_f32 v71, v158, v159
    buffer_load_dwordx4 a[60:63], v29, s[4:7], s51 offen offset:3072
    buffer_store_dwordx4 v[68:71], v8, s[12:15], 0 offen offset:0 sc1
    ds_read_b128 v[32:35], v24 offset:256
    ds_read_b128 v[36:39], v24 offset:1536
    ds_read_b128 v[40:43], v24 offset:320
    ds_read_b128 v[44:47], v24 offset:1600
    s_waitcnt lgkmcnt(4)
    v_pk_fma_f32 v[80:81], v[48:49], v[242:243], v[52:53] op_sel:[0,0,0] op_sel_hi:[1,0,1]
    v_pk_fma_f32 v[82:83], v[50:51], v[242:243], v[54:55] op_sel:[0,0,0] op_sel_hi:[1,0,1]
    v_pk_fma_f32 v[112:113], v[112:113], v[240:241], v[80:81] op_sel:[0,0,0] op_sel_hi:[1,0,1]
    v_pk_fma_f32 v[114:115], v[114:115], v[240:241], v[82:83] op_sel:[0,0,0] op_sel_hi:[1,0,1]
    v_pk_mul_f32 v[80:81], v[112:113], v[112:113]
    v_pk_mul_f32 v[82:83], v[114:115], v[114:115]
    v_pk_fma_f32 v[80:81], v[80:81], v[26:27], s[36:37]
    v_pk_fma_f32 v[82:83], v[82:83], v[26:27], s[36:37]
    v_pk_mul_f32 v[80:81], v[80:81], v[112:113]
    v_pk_mul_f32 v[82:83], v[82:83], v[114:115]
    v_exp_f32 v80, v80
    v_exp_f32 v81, v81
    v_exp_f32 v82, v82
    v_exp_f32 v83, v83
    v_pk_add_f32 v[80:81], v[80:81], 1.0 op_sel_hi:[1,0]
    v_pk_add_f32 v[82:83], v[82:83], 1.0 op_sel_hi:[1,0]
    v_rcp_f32 v80, v80
    v_rcp_f32 v81, v81
    v_rcp_f32 v82, v82
    v_rcp_f32 v83, v83
    v_pk_mul_f32 v[112:113], v[112:113], v[80:81]
    v_pk_mul_f32 v[114:115], v[114:115], v[82:83]
    v_cvt_pk_bf16_f32 v72, v112, v113
    v_cvt_pk_bf16_f32 v73, v114, v115
    s_mov_b32 s51, 16384
    buffer_load_dwordx4 a[64:67], v29, s[4:7], s51 offen offset:0
    buffer_load_dwordx4 a[68:71], v29, s[4:7], s51 offen offset:1024
    v_pk_fma_f32 v[84:85], v[56:57], v[242:243], v[60:61] op_sel:[0,0,0] op_sel_hi:[1,0,1]
    v_pk_fma_f32 v[86:87], v[58:59], v[242:243], v[62:63] op_sel:[0,0,0] op_sel_hi:[1,0,1]
    v_pk_fma_f32 v[116:117], v[116:117], v[240:241], v[84:85] op_sel:[0,0,0] op_sel_hi:[1,0,1]
    v_pk_fma_f32 v[118:119], v[118:119], v[240:241], v[86:87] op_sel:[0,0,0] op_sel_hi:[1,0,1]
    v_pk_mul_f32 v[84:85], v[116:117], v[116:117]
    v_pk_mul_f32 v[86:87], v[118:119], v[118:119]
    v_pk_fma_f32 v[84:85], v[84:85], v[26:27], s[36:37]
    v_pk_fma_f32 v[86:87], v[86:87], v[26:27], s[36:37]
    v_pk_mul_f32 v[84:85], v[84:85], v[116:117]
    v_pk_mul_f32 v[86:87], v[86:87], v[118:119]
    v_exp_f32 v84, v84
    v_exp_f32 v85, v85
    v_exp_f32 v86, v86
    v_exp_f32 v87, v87
    v_pk_add_f32 v[84:85], v[84:85], 1.0 op_sel_hi:[1,0]
    v_pk_add_f32 v[86:87], v[86:87], 1.0 op_sel_hi:[1,0]
    v_rcp_f32 v84, v84
    v_rcp_f32 v85, v85
    v_rcp_f32 v86, v86
    v_rcp_f32 v87, v87
    v_pk_mul_f32 v[116:117], v[116:117], v[84:85]
    v_pk_mul_f32 v[118:119], v[118:119], v[86:87]
    v_cvt_pk_bf16_f32 v74, v116, v117
    v_cvt_pk_bf16_f32 v75, v118, v119
    buffer_load_dwordx4 a[72:75], v29, s[4:7], s51 offen offset:2048
    buffer_store_dwordx4 v[72:75], v6, s[12:15], 0 offen offset:1024 sc1
    v_pk_fma_f32 v[80:81], v[48:49], v[242:243], v[52:53] op_sel:[0,1,0] op_sel_hi:[1,1,1]
    v_pk_fma_f32 v[82:83], v[50:51], v[242:243], v[54:55] op_sel:[0,1,0] op_sel_hi:[1,1,1]
    v_pk_fma_f32 v[160:161], v[160:161], v[240:241], v[80:81] op_sel:[0,1,0] op_sel_hi:[1,1,1]
    v_pk_fma_f32 v[162:163], v[162:163], v[240:241], v[82:83] op_sel:[0,1,0] op_sel_hi:[1,1,1]
    v_pk_mul_f32 v[80:81], v[160:161], v[160:161]
    v_pk_mul_f32 v[82:83], v[162:163], v[162:163]
    v_pk_fma_f32 v[80:81], v[80:81], v[26:27], s[36:37]
    v_pk_fma_f32 v[82:83], v[82:83], v[26:27], s[36:37]
    v_pk_mul_f32 v[80:81], v[80:81], v[160:161]
    v_pk_mul_f32 v[82:83], v[82:83], v[162:163]
    v_exp_f32 v80, v80
    v_exp_f32 v81, v81
    v_exp_f32 v82, v82
    v_exp_f32 v83, v83
    v_pk_add_f32 v[80:81], v[80:81], 1.0 op_sel_hi:[1,0]
    v_pk_add_f32 v[82:83], v[82:83], 1.0 op_sel_hi:[1,0]
    v_rcp_f32 v80, v80
    v_rcp_f32 v81, v81
    v_rcp_f32 v82, v82
    v_rcp_f32 v83, v83
    v_pk_mul_f32 v[160:161], v[160:161], v[80:81]
    v_pk_mul_f32 v[162:163], v[162:163], v[82:83]
    v_cvt_pk_bf16_f32 v76, v160, v161
    v_cvt_pk_bf16_f32 v77, v162, v163
    buffer_load_dwordx4 a[76:79], v29, s[4:7], s51 offen offset:3072
    s_mov_b32 s51, 40960
    buffer_load_dwordx4 a[160:163], v29, s[4:7], s51 offen offset:0
    v_pk_fma_f32 v[84:85], v[56:57], v[242:243], v[60:61] op_sel:[0,1,0] op_sel_hi:[1,1,1]
    v_pk_fma_f32 v[86:87], v[58:59], v[242:243], v[62:63] op_sel:[0,1,0] op_sel_hi:[1,1,1]
    v_pk_fma_f32 v[164:165], v[164:165], v[240:241], v[84:85] op_sel:[0,1,0] op_sel_hi:[1,1,1]
    v_pk_fma_f32 v[166:167], v[166:167], v[240:241], v[86:87] op_sel:[0,1,0] op_sel_hi:[1,1,1]
    v_pk_mul_f32 v[84:85], v[164:165], v[164:165]
    v_pk_mul_f32 v[86:87], v[166:167], v[166:167]
    v_pk_fma_f32 v[84:85], v[84:85], v[26:27], s[36:37]
    v_pk_fma_f32 v[86:87], v[86:87], v[26:27], s[36:37]
    v_pk_mul_f32 v[84:85], v[84:85], v[164:165]
    v_pk_mul_f32 v[86:87], v[86:87], v[166:167]
    v_exp_f32 v84, v84
    v_exp_f32 v85, v85
    v_exp_f32 v86, v86
    v_exp_f32 v87, v87
    v_pk_add_f32 v[84:85], v[84:85], 1.0 op_sel_hi:[1,0]
    v_pk_add_f32 v[86:87], v[86:87], 1.0 op_sel_hi:[1,0]
    v_rcp_f32 v84, v84
    v_rcp_f32 v85, v85
    v_rcp_f32 v86, v86
    v_rcp_f32 v87, v87
    v_pk_mul_f32 v[164:165], v[164:165], v[84:85]
    v_pk_mul_f32 v[166:167], v[166:167], v[86:87]
    v_cvt_pk_bf16_f32 v78, v164, v165
    v_cvt_pk_bf16_f32 v79, v166, v167
    buffer_load_dwordx4 a[164:167], v29, s[4:7], s51 offen offset:1024
    buffer_store_dwordx4 v[76:79], v8, s[12:15], 0 offen offset:1024 sc1
    ds_read_b128 v[48:51], v24 offset:384
    ds_read_b128 v[52:55], v24 offset:1664
    ds_read_b128 v[56:59], v24 offset:448
    ds_read_b128 v[60:63], v24 offset:1728
    s_waitcnt lgkmcnt(4)
    v_pk_fma_f32 v[80:81], v[32:33], v[242:243], v[36:37] op_sel:[0,0,0] op_sel_hi:[1,0,1]
    v_pk_fma_f32 v[82:83], v[34:35], v[242:243], v[38:39] op_sel:[0,0,0] op_sel_hi:[1,0,1]
    v_pk_fma_f32 v[120:121], v[120:121], v[240:241], v[80:81] op_sel:[0,0,0] op_sel_hi:[1,0,1]
    v_pk_fma_f32 v[122:123], v[122:123], v[240:241], v[82:83] op_sel:[0,0,0] op_sel_hi:[1,0,1]
    v_pk_mul_f32 v[80:81], v[120:121], v[120:121]
    v_pk_mul_f32 v[82:83], v[122:123], v[122:123]
    v_pk_fma_f32 v[80:81], v[80:81], v[26:27], s[36:37]
    v_pk_fma_f32 v[82:83], v[82:83], v[26:27], s[36:37]
    v_pk_mul_f32 v[80:81], v[80:81], v[120:121]
    v_pk_mul_f32 v[82:83], v[82:83], v[122:123]
    v_exp_f32 v80, v80
    v_exp_f32 v81, v81
    v_exp_f32 v82, v82
    v_exp_f32 v83, v83
    v_pk_add_f32 v[80:81], v[80:81], 1.0 op_sel_hi:[1,0]
    v_pk_add_f32 v[82:83], v[82:83], 1.0 op_sel_hi:[1,0]
    v_rcp_f32 v80, v80
    v_rcp_f32 v81, v81
    v_rcp_f32 v82, v82
    v_rcp_f32 v83, v83
    v_pk_mul_f32 v[120:121], v[120:121], v[80:81]
    v_pk_mul_f32 v[122:123], v[122:123], v[82:83]
    v_cvt_pk_bf16_f32 v64, v120, v121
    v_cvt_pk_bf16_f32 v65, v122, v123
    buffer_load_dwordx4 a[168:171], v29, s[4:7], s51 offen offset:2048
    buffer_load_dwordx4 a[172:175], v29, s[4:7], s51 offen offset:3072
    v_pk_fma_f32 v[84:85], v[40:41], v[242:243], v[44:45] op_sel:[0,0,0] op_sel_hi:[1,0,1]
    v_pk_fma_f32 v[86:87], v[42:43], v[242:243], v[46:47] op_sel:[0,0,0] op_sel_hi:[1,0,1]
    v_pk_fma_f32 v[124:125], v[124:125], v[240:241], v[84:85] op_sel:[0,0,0] op_sel_hi:[1,0,1]
    v_pk_fma_f32 v[126:127], v[126:127], v[240:241], v[86:87] op_sel:[0,0,0] op_sel_hi:[1,0,1]
    v_pk_mul_f32 v[84:85], v[124:125], v[124:125]
    v_pk_mul_f32 v[86:87], v[126:127], v[126:127]
    v_pk_fma_f32 v[84:85], v[84:85], v[26:27], s[36:37]
    v_pk_fma_f32 v[86:87], v[86:87], v[26:27], s[36:37]
    v_pk_mul_f32 v[84:85], v[84:85], v[124:125]
    v_pk_mul_f32 v[86:87], v[86:87], v[126:127]
    v_exp_f32 v84, v84
    v_exp_f32 v85, v85
    v_exp_f32 v86, v86
    v_exp_f32 v87, v87
    v_pk_add_f32 v[84:85], v[84:85], 1.0 op_sel_hi:[1,0]
    v_pk_add_f32 v[86:87], v[86:87], 1.0 op_sel_hi:[1,0]
    v_rcp_f32 v84, v84
    v_rcp_f32 v85, v85
    v_rcp_f32 v86, v86
    v_rcp_f32 v87, v87
    v_pk_mul_f32 v[124:125], v[124:125], v[84:85]
    v_pk_mul_f32 v[126:127], v[126:127], v[86:87]
    v_cvt_pk_bf16_f32 v66, v124, v125
    v_cvt_pk_bf16_f32 v67, v126, v127
    s_mov_b32 s51, 45056
    buffer_load_dwordx4 a[176:179], v29, s[4:7], s51 offen offset:0
    buffer_store_dwordx4 v[64:67], v6, s[12:15], 0 offen offset:2048 sc1
    v_pk_fma_f32 v[80:81], v[32:33], v[242:243], v[36:37] op_sel:[0,1,0] op_sel_hi:[1,1,1]
    v_pk_fma_f32 v[82:83], v[34:35], v[242:243], v[38:39] op_sel:[0,1,0] op_sel_hi:[1,1,1]
    v_pk_fma_f32 v[168:169], v[168:169], v[240:241], v[80:81] op_sel:[0,1,0] op_sel_hi:[1,1,1]
    v_pk_fma_f32 v[170:171], v[170:171], v[240:241], v[82:83] op_sel:[0,1,0] op_sel_hi:[1,1,1]
    v_pk_mul_f32 v[80:81], v[168:169], v[168:169]
    v_pk_mul_f32 v[82:83], v[170:171], v[170:171]
    v_pk_fma_f32 v[80:81], v[80:81], v[26:27], s[36:37]
    v_pk_fma_f32 v[82:83], v[82:83], v[26:27], s[36:37]
    v_pk_mul_f32 v[80:81], v[80:81], v[168:169]
    v_pk_mul_f32 v[82:83], v[82:83], v[170:171]
    v_exp_f32 v80, v80
    v_exp_f32 v81, v81
    v_exp_f32 v82, v82
    v_exp_f32 v83, v83
    v_pk_add_f32 v[80:81], v[80:81], 1.0 op_sel_hi:[1,0]
    v_pk_add_f32 v[82:83], v[82:83], 1.0 op_sel_hi:[1,0]
    v_rcp_f32 v80, v80
    v_rcp_f32 v81, v81
    v_rcp_f32 v82, v82
    v_rcp_f32 v83, v83
    v_pk_mul_f32 v[168:169], v[168:169], v[80:81]
    v_pk_mul_f32 v[170:171], v[170:171], v[82:83]
    v_cvt_pk_bf16_f32 v68, v168, v169
    v_cvt_pk_bf16_f32 v69, v170, v171
    buffer_load_dwordx4 a[180:183], v29, s[4:7], s51 offen offset:1024
    buffer_load_dwordx4 a[184:187], v29, s[4:7], s51 offen offset:2048
    v_pk_fma_f32 v[84:85], v[40:41], v[242:243], v[44:45] op_sel:[0,1,0] op_sel_hi:[1,1,1]
    v_pk_fma_f32 v[86:87], v[42:43], v[242:243], v[46:47] op_sel:[0,1,0] op_sel_hi:[1,1,1]
    v_pk_fma_f32 v[172:173], v[172:173], v[240:241], v[84:85] op_sel:[0,1,0] op_sel_hi:[1,1,1]
    v_pk_fma_f32 v[174:175], v[174:175], v[240:241], v[86:87] op_sel:[0,1,0] op_sel_hi:[1,1,1]
    v_pk_mul_f32 v[84:85], v[172:173], v[172:173]
    v_pk_mul_f32 v[86:87], v[174:175], v[174:175]
    v_pk_fma_f32 v[84:85], v[84:85], v[26:27], s[36:37]
    v_pk_fma_f32 v[86:87], v[86:87], v[26:27], s[36:37]
    v_pk_mul_f32 v[84:85], v[84:85], v[172:173]
    v_pk_mul_f32 v[86:87], v[86:87], v[174:175]
    v_exp_f32 v84, v84
    v_exp_f32 v85, v85
    v_exp_f32 v86, v86
    v_exp_f32 v87, v87
    v_pk_add_f32 v[84:85], v[84:85], 1.0 op_sel_hi:[1,0]
    v_pk_add_f32 v[86:87], v[86:87], 1.0 op_sel_hi:[1,0]
    v_rcp_f32 v84, v84
    v_rcp_f32 v85, v85
    v_rcp_f32 v86, v86
    v_rcp_f32 v87, v87
    v_pk_mul_f32 v[172:173], v[172:173], v[84:85]
    v_pk_mul_f32 v[174:175], v[174:175], v[86:87]
    v_cvt_pk_bf16_f32 v70, v172, v173
    v_cvt_pk_bf16_f32 v71, v174, v175
    buffer_load_dwordx4 a[188:191], v29, s[4:7], s51 offen offset:3072
    buffer_store_dwordx4 v[68:71], v8, s[12:15], 0 offen offset:2048 sc1
    s_waitcnt vmcnt(8)
    buffer_store_dword v16, off, s[80:83], s57
    ds_read_b128 v[104:107], v24 offset:512
    ds_read_b128 v[108:111], v24 offset:1792
    ds_read_b128 v[112:115], v24 offset:576
    ds_read_b128 v[116:119], v24 offset:1856
    s_waitcnt lgkmcnt(4)
    v_pk_fma_f32 v[80:81], v[48:49], v[242:243], v[52:53] op_sel:[0,0,0] op_sel_hi:[1,0,1]
    v_pk_fma_f32 v[82:83], v[50:51], v[242:243], v[54:55] op_sel:[0,0,0] op_sel_hi:[1,0,1]
    v_pk_fma_f32 v[128:129], v[128:129], v[240:241], v[80:81] op_sel:[0,0,0] op_sel_hi:[1,0,1]
    v_pk_fma_f32 v[130:131], v[130:131], v[240:241], v[82:83] op_sel:[0,0,0] op_sel_hi:[1,0,1]
    v_pk_mul_f32 v[80:81], v[128:129], v[128:129]
    v_pk_mul_f32 v[82:83], v[130:131], v[130:131]
    v_pk_fma_f32 v[80:81], v[80:81], v[26:27], s[36:37]
    v_pk_fma_f32 v[82:83], v[82:83], v[26:27], s[36:37]
    v_pk_mul_f32 v[80:81], v[80:81], v[128:129]
    v_pk_mul_f32 v[82:83], v[82:83], v[130:131]
    v_exp_f32 v80, v80
    v_exp_f32 v81, v81
    v_exp_f32 v82, v82
    v_exp_f32 v83, v83
    v_pk_add_f32 v[80:81], v[80:81], 1.0 op_sel_hi:[1,0]
    v_pk_add_f32 v[82:83], v[82:83], 1.0 op_sel_hi:[1,0]
    v_rcp_f32 v80, v80
    v_rcp_f32 v81, v81
    v_rcp_f32 v82, v82
    v_rcp_f32 v83, v83
    v_pk_mul_f32 v[128:129], v[128:129], v[80:81]
    v_pk_mul_f32 v[130:131], v[130:131], v[82:83]
    v_cvt_pk_bf16_f32 v72, v128, v129
    v_cvt_pk_bf16_f32 v73, v130, v131
    s_mov_b32 s51, 49152
    buffer_load_dwordx4 a[192:195], v29, s[4:7], s51 offen offset:0
    buffer_load_dwordx4 a[196:199], v29, s[4:7], s51 offen offset:1024
    v_pk_fma_f32 v[84:85], v[56:57], v[242:243], v[60:61] op_sel:[0,0,0] op_sel_hi:[1,0,1]
    v_pk_fma_f32 v[86:87], v[58:59], v[242:243], v[62:63] op_sel:[0,0,0] op_sel_hi:[1,0,1]
    v_pk_fma_f32 v[132:133], v[132:133], v[240:241], v[84:85] op_sel:[0,0,0] op_sel_hi:[1,0,1]
    v_pk_fma_f32 v[134:135], v[134:135], v[240:241], v[86:87] op_sel:[0,0,0] op_sel_hi:[1,0,1]
    v_pk_mul_f32 v[84:85], v[132:133], v[132:133]
    v_pk_mul_f32 v[86:87], v[134:135], v[134:135]
    v_pk_fma_f32 v[84:85], v[84:85], v[26:27], s[36:37]
    v_pk_fma_f32 v[86:87], v[86:87], v[26:27], s[36:37]
    v_pk_mul_f32 v[84:85], v[84:85], v[132:133]
    v_pk_mul_f32 v[86:87], v[86:87], v[134:135]
    v_exp_f32 v84, v84
    v_exp_f32 v85, v85
    v_exp_f32 v86, v86
    v_exp_f32 v87, v87
    v_pk_add_f32 v[84:85], v[84:85], 1.0 op_sel_hi:[1,0]
    v_pk_add_f32 v[86:87], v[86:87], 1.0 op_sel_hi:[1,0]
    v_rcp_f32 v84, v84
    v_rcp_f32 v85, v85
    v_rcp_f32 v86, v86
    v_rcp_f32 v87, v87
    v_pk_mul_f32 v[132:133], v[132:133], v[84:85]
    v_pk_mul_f32 v[134:135], v[134:135], v[86:87]
    v_cvt_pk_bf16_f32 v74, v132, v133
    v_cvt_pk_bf16_f32 v75, v134, v135
    s_mov_b32 s51, 20480
    buffer_load_dwordx4 a[80:83], v29, s[4:7], s51 offen offset:0
    buffer_store_dwordx4 v[72:75], v6, s[12:15], 0 offen offset:3072 sc1
    v_pk_fma_f32 v[80:81], v[48:49], v[242:243], v[52:53] op_sel:[0,1,0] op_sel_hi:[1,1,1]
    v_pk_fma_f32 v[82:83], v[50:51], v[242:243], v[54:55] op_sel:[0,1,0] op_sel_hi:[1,1,1]
    v_pk_fma_f32 v[176:177], v[176:177], v[240:241], v[80:81] op_sel:[0,1,0] op_sel_hi:[1,1,1]
    v_pk_fma_f32 v[178:179], v[178:179], v[240:241], v[82:83] op_sel:[0,1,0] op_sel_hi:[1,1,1]
    v_pk_mul_f32 v[80:81], v[176:177], v[176:177]
    v_pk_mul_f32 v[82:83], v[178:179], v[178:179]
    v_pk_fma_f32 v[80:81], v[80:81], v[26:27], s[36:37]
    v_pk_fma_f32 v[82:83], v[82:83], v[26:27], s[36:37]
    v_pk_mul_f32 v[80:81], v[80:81], v[176:177]
    v_pk_mul_f32 v[82:83], v[82:83], v[178:179]
    v_exp_f32 v80, v80
    v_exp_f32 v81, v81
    v_exp_f32 v82, v82
    v_exp_f32 v83, v83
    v_pk_add_f32 v[80:81], v[80:81], 1.0 op_sel_hi:[1,0]
    v_pk_add_f32 v[82:83], v[82:83], 1.0 op_sel_hi:[1,0]
    v_rcp_f32 v80, v80
    v_rcp_f32 v81, v81
    v_rcp_f32 v82, v82
    v_rcp_f32 v83, v83
    v_pk_mul_f32 v[176:177], v[176:177], v[80:81]
    v_pk_mul_f32 v[178:179], v[178:179], v[82:83]
    v_cvt_pk_bf16_f32 v76, v176, v177
    v_cvt_pk_bf16_f32 v77, v178, v179
    buffer_load_dwordx4 a[84:87], v29, s[4:7], s51 offen offset:1024
    buffer_load_dwordx4 a[88:91], v29, s[4:7], s51 offen offset:2048
    v_pk_fma_f32 v[84:85], v[56:57], v[242:243], v[60:61] op_sel:[0,1,0] op_sel_hi:[1,1,1]
    v_pk_fma_f32 v[86:87], v[58:59], v[242:243], v[62:63] op_sel:[0,1,0] op_sel_hi:[1,1,1]
    v_pk_fma_f32 v[180:181], v[180:181], v[240:241], v[84:85] op_sel:[0,1,0] op_sel_hi:[1,1,1]
    v_pk_fma_f32 v[182:183], v[182:183], v[240:241], v[86:87] op_sel:[0,1,0] op_sel_hi:[1,1,1]
    v_pk_mul_f32 v[84:85], v[180:181], v[180:181]
    v_pk_mul_f32 v[86:87], v[182:183], v[182:183]
    v_pk_fma_f32 v[84:85], v[84:85], v[26:27], s[36:37]
    v_pk_fma_f32 v[86:87], v[86:87], v[26:27], s[36:37]
    v_pk_mul_f32 v[84:85], v[84:85], v[180:181]
    v_pk_mul_f32 v[86:87], v[86:87], v[182:183]
    v_exp_f32 v84, v84
    v_exp_f32 v85, v85
    v_exp_f32 v86, v86
    v_exp_f32 v87, v87
    v_pk_add_f32 v[84:85], v[84:85], 1.0 op_sel_hi:[1,0]
    v_pk_add_f32 v[86:87], v[86:87], 1.0 op_sel_hi:[1,0]
    v_rcp_f32 v84, v84
    v_rcp_f32 v85, v85
    v_rcp_f32 v86, v86
    v_rcp_f32 v87, v87
    v_pk_mul_f32 v[180:181], v[180:181], v[84:85]
    v_pk_mul_f32 v[182:183], v[182:183], v[86:87]
    v_cvt_pk_bf16_f32 v78, v180, v181
    v_cvt_pk_bf16_f32 v79, v182, v183
    buffer_load_dwordx4 a[92:95], v29, s[4:7], s51 offen offset:3072
    buffer_load_dword v14, v15, s[80:83], 0 offen sc1
    buffer_store_dwordx4 v[76:79], v8, s[12:15], 0 offen offset:3072 sc1
    ds_read_b128 v[152:155], v24 offset:640
    ds_read_b128 v[156:159], v24 offset:1920
    ds_read_b128 v[160:163], v24 offset:704
    ds_read_b128 v[164:167], v24 offset:1984
    s_waitcnt lgkmcnt(4)
    v_pk_fma_f32 v[80:81], v[104:105], v[242:243], v[108:109] op_sel:[0,0,0] op_sel_hi:[1,0,1]
    v_pk_fma_f32 v[82:83], v[106:107], v[242:243], v[110:111] op_sel:[0,0,0] op_sel_hi:[1,0,1]
    v_pk_fma_f32 v[136:137], v[136:137], v[240:241], v[80:81] op_sel:[0,0,0] op_sel_hi:[1,0,1]
    v_pk_fma_f32 v[138:139], v[138:139], v[240:241], v[82:83] op_sel:[0,0,0] op_sel_hi:[1,0,1]
    v_pk_mul_f32 v[80:81], v[136:137], v[136:137]
    v_pk_mul_f32 v[82:83], v[138:139], v[138:139]
    v_pk_fma_f32 v[80:81], v[80:81], v[26:27], s[36:37]
    v_pk_fma_f32 v[82:83], v[82:83], v[26:27], s[36:37]
    v_pk_mul_f32 v[80:81], v[80:81], v[136:137]
    v_pk_mul_f32 v[82:83], v[82:83], v[138:139]
    v_exp_f32 v80, v80
    v_exp_f32 v81, v81
    v_exp_f32 v82, v82
    v_exp_f32 v83, v83
    v_pk_add_f32 v[80:81], v[80:81], 1.0 op_sel_hi:[1,0]
    v_pk_add_f32 v[82:83], v[82:83], 1.0 op_sel_hi:[1,0]
    v_rcp_f32 v80, v80
    v_rcp_f32 v81, v81
    v_rcp_f32 v82, v82
    v_rcp_f32 v83, v83
    v_pk_mul_f32 v[136:137], v[136:137], v[80:81]
    v_pk_mul_f32 v[138:139], v[138:139], v[82:83]
    v_cvt_pk_bf16_f32 v64, v136, v137
    v_cvt_pk_bf16_f32 v65, v138, v139
    s_mov_b32 s51, 24576
    buffer_load_dwordx4 a[96:99], v29, s[4:7], s51 offen offset:0
    buffer_load_dwordx4 a[100:103], v29, s[4:7], s51 offen offset:1024
    v_pk_fma_f32 v[84:85], v[112:113], v[242:243], v[116:117] op_sel:[0,0,0] op_sel_hi:[1,0,1]
    v_pk_fma_f32 v[86:87], v[114:115], v[242:243], v[118:119] op_sel:[0,0,0] op_sel_hi:[1,0,1]
    v_pk_fma_f32 v[140:141], v[140:141], v[240:241], v[84:85] op_sel:[0,0,0] op_sel_hi:[1,0,1]
    v_pk_fma_f32 v[142:143], v[142:143], v[240:241], v[86:87] op_sel:[0,0,0] op_sel_hi:[1,0,1]
    v_pk_mul_f32 v[84:85], v[140:141], v[140:141]
    v_pk_mul_f32 v[86:87], v[142:143], v[142:143]
    v_pk_fma_f32 v[84:85], v[84:85], v[26:27], s[36:37]
    v_pk_fma_f32 v[86:87], v[86:87], v[26:27], s[36:37]
    v_pk_mul_f32 v[84:85], v[84:85], v[140:141]
    v_pk_mul_f32 v[86:87], v[86:87], v[142:143]
    v_exp_f32 v84, v84
    v_exp_f32 v85, v85
    v_exp_f32 v86, v86
    v_exp_f32 v87, v87
    v_pk_add_f32 v[84:85], v[84:85], 1.0 op_sel_hi:[1,0]
    v_pk_add_f32 v[86:87], v[86:87], 1.0 op_sel_hi:[1,0]
    v_rcp_f32 v84, v84
    v_rcp_f32 v85, v85
    v_rcp_f32 v86, v86
    v_rcp_f32 v87, v87
    v_pk_mul_f32 v[140:141], v[140:141], v[84:85]
    v_pk_mul_f32 v[142:143], v[142:143], v[86:87]
    v_cvt_pk_bf16_f32 v66, v140, v141
    v_cvt_pk_bf16_f32 v67, v142, v143
    buffer_load_dwordx4 a[104:107], v29, s[4:7], s51 offen offset:2048
    buffer_store_dwordx4 v[64:67], v7, s[12:15], 0 offen offset:0 sc1
    v_pk_fma_f32 v[80:81], v[104:105], v[242:243], v[108:109] op_sel:[0,1,0] op_sel_hi:[1,1,1]
    v_pk_fma_f32 v[82:83], v[106:107], v[242:243], v[110:111] op_sel:[0,1,0] op_sel_hi:[1,1,1]
    v_pk_fma_f32 v[184:185], v[184:185], v[240:241], v[80:81] op_sel:[0,1,0] op_sel_hi:[1,1,1]
    v_pk_fma_f32 v[186:187], v[186:187], v[240:241], v[82:83] op_sel:[0,1,0] op_sel_hi:[1,1,1]
    v_pk_mul_f32 v[80:81], v[184:185], v[184:185]
    v_pk_mul_f32 v[82:83], v[186:187], v[186:187]
    v_pk_fma_f32 v[80:81], v[80:81], v[26:27], s[36:37]
    v_pk_fma_f32 v[82:83], v[82:83], v[26:27], s[36:37]
    v_pk_mul_f32 v[80:81], v[80:81], v[184:185]
    v_pk_mul_f32 v[82:83], v[82:83], v[186:187]
    v_exp_f32 v80, v80
    v_exp_f32 v81, v81
    v_exp_f32 v82, v82
    v_exp_f32 v83, v83
    v_pk_add_f32 v[80:81], v[80:81], 1.0 op_sel_hi:[1,0]
    v_pk_add_f32 v[82:83], v[82:83], 1.0 op_sel_hi:[1,0]
    v_rcp_f32 v80, v80
    v_rcp_f32 v81, v81
    v_rcp_f32 v82, v82
    v_rcp_f32 v83, v83
    v_pk_mul_f32 v[184:185], v[184:185], v[80:81]
    v_pk_mul_f32 v[186:187], v[186:187], v[82:83]
    v_cvt_pk_bf16_f32 v68, v184, v185
    v_cvt_pk_bf16_f32 v69, v186, v187
    buffer_load_dwordx4 a[108:111], v29, s[4:7], s51 offen offset:3072
    s_mov_b32 s51, 28672
    buffer_load_dwordx4 a[112:115], v29, s[4:7], s51 offen offset:0
    v_pk_fma_f32 v[84:85], v[112:113], v[242:243], v[116:117] op_sel:[0,1,0] op_sel_hi:[1,1,1]
    v_pk_fma_f32 v[86:87], v[114:115], v[242:243], v[118:119] op_sel:[0,1,0] op_sel_hi:[1,1,1]
    v_pk_fma_f32 v[188:189], v[188:189], v[240:241], v[84:85] op_sel:[0,1,0] op_sel_hi:[1,1,1]
    v_pk_fma_f32 v[190:191], v[190:191], v[240:241], v[86:87] op_sel:[0,1,0] op_sel_hi:[1,1,1]
    v_pk_mul_f32 v[84:85], v[188:189], v[188:189]
    v_pk_mul_f32 v[86:87], v[190:191], v[190:191]
    v_pk_fma_f32 v[84:85], v[84:85], v[26:27], s[36:37]
    v_pk_fma_f32 v[86:87], v[86:87], v[26:27], s[36:37]
    v_pk_mul_f32 v[84:85], v[84:85], v[188:189]
    v_pk_mul_f32 v[86:87], v[86:87], v[190:191]
    v_exp_f32 v84, v84
    v_exp_f32 v85, v85
    v_exp_f32 v86, v86
    v_exp_f32 v87, v87
    v_pk_add_f32 v[84:85], v[84:85], 1.0 op_sel_hi:[1,0]
    v_pk_add_f32 v[86:87], v[86:87], 1.0 op_sel_hi:[1,0]
    v_rcp_f32 v84, v84
    v_rcp_f32 v85, v85
    v_rcp_f32 v86, v86
    v_rcp_f32 v87, v87
    v_pk_mul_f32 v[188:189], v[188:189], v[84:85]
    v_pk_mul_f32 v[190:191], v[190:191], v[86:87]
    v_cvt_pk_bf16_f32 v70, v188, v189
    v_cvt_pk_bf16_f32 v71, v190, v191
    buffer_load_dwordx4 a[116:119], v29, s[4:7], s51 offen offset:1024
    buffer_store_dwordx4 v[68:71], v9, s[12:15], 0 offen offset:0 sc1
    s_waitcnt vmcnt(9)
    s_mov_b32 s98, 0
PL_78:
    v_cmp_gt_u32 vcc, 1, v14
    s_cbranch_vccz PD_79
    s_add_u32 s98, s98, 1
    s_cmp_ge_u32 s98, 0x40000
    s_cbranch_scc1 PD_79
    s_sleep 2
    buffer_load_dword v14, v15, s[80:83], 0 offen sc1
    s_waitcnt vmcnt(0)
    s_branch PL_78
PD_79:
    buffer_load_dwordx4 v[32:35], v10, s[16:19], s40 offen offset:0
    buffer_load_dwordx4 v[36:39], v10, s[16:19], s41 offen offset:0
    buffer_load_dwordx4 v[40:43], v10, s[16:19], s42 offen offset:0
    buffer_load_dwordx4 v[44:47], v10, s[16:19], s43 offen offset:0
    s_waitcnt lgkmcnt(0)
    v_pk_fma_f32 v[80:81], v[152:153], v[242:243], v[156:157] op_sel:[0,0,0] op_sel_hi:[1,0,1]
    v_pk_fma_f32 v[82:83], v[154:155], v[242:243], v[158:159] op_sel:[0,0,0] op_sel_hi:[1,0,1]
    v_pk_fma_f32 v[144:145], v[144:145], v[240:241], v[80:81] op_sel:[0,0,0] op_sel_hi:[1,0,1]
    v_pk_fma_f32 v[146:147], v[146:147], v[240:241], v[82:83] op_sel:[0,0,0] op_sel_hi:[1,0,1]
    v_pk_mul_f32 v[80:81], v[144:145], v[144:145]
    v_pk_mul_f32 v[82:83], v[146:147], v[146:147]
    v_pk_fma_f32 v[80:81], v[80:81], v[26:27], s[36:37]
    v_pk_fma_f32 v[82:83], v[82:83], v[26:27], s[36:37]
    v_pk_mul_f32 v[80:81], v[80:81], v[144:145]
    v_pk_mul_f32 v[82:83], v[82:83], v[146:147]
    v_exp_f32 v80, v80
    v_exp_f32 v81, v81
    v_exp_f32 v82, v82
    v_exp_f32 v83, v83
    v_pk_add_f32 v[80:81], v[80:81], 1.0 op_sel_hi:[1,0]
    v_pk_add_f32 v[82:83], v[82:83], 1.0 op_sel_hi:[1,0]
    v_rcp_f32 v80, v80
    v_rcp_f32 v81, v81
    v_rcp_f32 v82, v82
    v_rcp_f32 v83, v83
    v_pk_mul_f32 v[144:145], v[144:145], v[80:81]
    v_pk_mul_f32 v[146:147], v[146:147], v[82:83]
    v_cvt_pk_bf16_f32 v72, v144, v145
    v_cvt_pk_bf16_f32 v73, v146, v147
    buffer_load_dwordx4 v[48:51], v10, s[16:19], s44 offen offset:0
    buffer_load_dwordx4 v[52:55], v10, s[16:19], s45 offen offset:0
    buffer_load_dwordx4 v[56:59], v10, s[16:19], s46 offen offset:0
    buffer_load_dwordx4 v[60:63], v10, s[16:19], s47 offen offset:0
    v_pk_fma_f32 v[84:85], v[160:161], v[242:243], v[164:165] op_sel:[0,0,0] op_sel_hi:[1,0,1]
    v_pk_fma_f32 v[86:87], v[162:163], v[242:243], v[166:167] op_sel:[0,0,0] op_sel_hi:[1,0,1]
    v_pk_fma_f32 v[148:149], v[148:149], v[240:241], v[84:85] op_sel:[0,0,0] op_sel_hi:[1,0,1]
    v_pk_fma_f32 v[150:151], v[150:151], v[240:241], v[86:87] op_sel:[0,0,0] op_sel_hi:[1,0,1]
    v_pk_mul_f32 v[84:85], v[148:149], v[148:149]
    v_pk_mul_f32 v[86:87], v[150:151], v[150:151]
    v_pk_fma_f32 v[84:85], v[84:85], v[26:27], s[36:37]
    v_pk_fma_f32 v[86:87], v[86:87], v[26:27], s[36:37]
    v_pk_mul_f32 v[84:85], v[84:85], v[148:149]
    v_pk_mul_f32 v[86:87], v[86:87], v[150:151]
    v_exp_f32 v84, v84
    v_exp_f32 v85, v85
    v_exp_f32 v86, v86
    v_exp_f32 v87, v87
    v_pk_add_f32 v[84:85], v[84:85], 1.0 op_sel_hi:[1,0]
    v_pk_add_f32 v[86:87], v[86:87], 1.0 op_sel_hi:[1,0]
    v_rcp_f32 v84, v84
    v_rcp_f32 v85, v85
    v_rcp_f32 v86, v86
    v_rcp_f32 v87, v87
    v_pk_mul_f32 v[148:149], v[148:149], v[84:85]
    v_pk_mul_f32 v[150:151], v[150:151], v[86:87]
    v_cvt_pk_bf16_f32 v74, v148, v149
    v_cvt_pk_bf16_f32 v75, v150, v151
    buffer_store_dwordx4 v[72:75], v7, s[12:15], 0 offen offset:1024 sc1
    v_pk_fma_f32 v[80:81], v[152:153], v[242:243], v[156:157] op_sel:[0,1,0] op_sel_hi:[1,1,1]
    v_pk_fma_f32 v[82:83], v[154:155], v[242:243], v[158:159] op_sel:[0,1,0] op_sel_hi:[1,1,1]
    v_pk_fma_f32 v[192:193], v[192:193], v[240:241], v[80:81] op_sel:[0,1,0] op_sel_hi:[1,1,1]
    v_pk_fma_f32 v[194:195], v[194:195], v[240:241], v[82:83] op_sel:[0,1,0] op_sel_hi:[1,1,1]
    v_pk_mul_f32 v[80:81], v[192:193], v[192:193]
    v_pk_mul_f32 v[82:83], v[194:195], v[194:195]
    v_pk_fma_f32 v[80:81], v[80:81], v[26:27], s[36:37]
    v_pk_fma_f32 v[82:83], v[82:83], v[26:27], s[36:37]
    v_pk_mul_f32 v[80:81], v[80:81], v[192:193]
    v_pk_mul_f32 v[82:83], v[82:83], v[194:195]
    v_exp_f32 v80, v80
    v_exp_f32 v81, v81
    v_exp_f32 v82, v82
    v_exp_f32 v83, v83
    v_pk_add_f32 v[80:81], v[80:81], 1.0 op_sel_hi:[1,0]
    v_pk_add_f32 v[82:83], v[82:83], 1.0 op_sel_hi:[1,0]
    v_rcp_f32 v80, v80
    v_rcp_f32 v81, v81
    v_rcp_f32 v82, v82
    v_rcp_f32 v83, v83
    v_pk_mul_f32 v[192:193], v[192:193], v[80:81]
    v_pk_mul_f32 v[194:195], v[194:195], v[82:83]
    v_cvt_pk_bf16_f32 v76, v192, v193
    v_cvt_pk_bf16_f32 v77, v194, v195
    v_pk_fma_f32 v[84:85], v[160:161], v[242:243], v[164:165] op_sel:[0,1,0] op_sel_hi:[1,1,1]
    v_pk_fma_f32 v[86:87], v[162:163], v[242:243], v[166:167] op_sel:[0,1,0] op_sel_hi:[1,1,1]
    v_pk_fma_f32 v[196:197], v[196:197], v[240:241], v[84:85] op_sel:[0,1,0] op_sel_hi:[1,1,1]
    v_pk_fma_f32 v[198:199], v[198:199], v[240:241], v[86:87] op_sel:[0,1,0] op_sel_hi:[1,1,1]
    v_pk_mul_f32 v[84:85], v[196:197], v[196:197]
    v_pk_mul_f32 v[86:87], v[198:199], v[198:199]
    v_pk_fma_f32 v[84:85], v[84:85], v[26:27], s[36:37]
    v_pk_fma_f32 v[86:87], v[86:87], v[26:27], s[36:37]
    v_pk_mul_f32 v[84:85], v[84:85], v[196:197]
    v_pk_mul_f32 v[86:87], v[86:87], v[198:199]
    v_exp_f32 v84, v84
    v_exp_f32 v85, v85
    v_exp_f32 v86, v86
    v_exp_f32 v87, v87
    v_pk_add_f32 v[84:85], v[84:85], 1.0 op_sel_hi:[1,0]
    v_pk_add_f32 v[86:87], v[86:87], 1.0 op_sel_hi:[1,0]
    v_rcp_f32 v84, v84
    v_rcp_f32 v85, v85
    v_rcp_f32 v86, v86
    v_rcp_f32 v87, v87
    v_pk_mul_f32 v[196:197], v[196:197], v[84:85]
    v_pk_mul_f32 v[198:199], v[198:199], v[86:87]
    v_cvt_pk_bf16_f32 v78, v196, v197
    v_cvt_pk_bf16_f32 v79, v198, v199
    buffer_store_dwordx4 v[76:79], v9, s[12:15], 0 offen offset:1024 sc1
    s_waitcnt vmcnt(18)
    buffer_store_dword v17, off, s[80:83], s57
    v_mov_b32 v9, v31
    buffer_load_dwordx4 v[16:19], v10, s[16:19], s40 offen offset:1024
    buffer_load_dwordx4 v[20:23], v10, s[16:19], s41 offen offset:1024
    s_mov_b32 s51, 49152
    buffer_load_dwordx4 a[200:203], v251, s[4:7], s51 offen offset:2048
    buffer_load_dwordx4 a[204:207], v251, s[4:7], s51 offen offset:3072
    v_lshlrev_b32 v208, 16, v200
    v_and_b32 v209, 0xffff0000, v200
    v_lshlrev_b32 v228, 16, v200
    v_and_b32 v229, 0xffff0000, v200
    v_lshlrev_b32 v210, 16, v201
    v_and_b32 v211, 0xffff0000, v201
    v_lshlrev_b32 v230, 16, v201
    v_and_b32 v231, 0xffff0000, v201
    v_lshlrev_b32 v212, 16, v202
    v_and_b32 v213, 0xffff0000, v202
    v_lshlrev_b32 v232, 16, v202
    v_and_b32 v233, 0xffff0000, v202
    v_lshlrev_b32 v214, 16, v203
    v_and_b32 v215, 0xffff0000, v203
    v_lshlrev_b32 v234, 16, v203
    v_and_b32 v235, 0xffff0000, v203
    v_lshlrev_b32 v216, 16, v204
    v_and_b32 v217, 0xffff0000, v204
    v_lshlrev_b32 v236, 16, v204
    v_and_b32 v237, 0xffff0000, v204
    v_lshlrev_b32 v218, 16, v205
    v_and_b32 v219, 0xffff0000, v205
    v_lshlrev_b32 v238, 16, v205
    v_and_b32 v239, 0xffff0000, v205
    v_lshlrev_b32 v220, 16, v206
    v_and_b32 v221, 0xffff0000, v206
    v_lshlrev_b32 v240, 16, v206
    v_and_b32 v241, 0xffff0000, v206
    v_lshlrev_b32 v222, 16, v207
    v_and_b32 v223, 0xffff0000, v207
    v_lshlrev_b32 v242, 16, v207
    v_and_b32 v243, 0xffff0000, v207
    v_lshlrev_b32 v224, 16, v248
    v_and_b32 v225, 0xffff0000, v248
    v_lshlrev_b32 v244, 16, v248
    v_and_b32 v245, 0xffff0000, v248
    v_lshlrev_b32 v226, 16, v249
    v_and_b32 v227, 0xffff0000, v249
    v_lshlrev_b32 v246, 16, v249
    v_and_b32 v247, 0xffff0000, v249
    s_sub_u32 s32, s20, 1
    s_and_b32 s32, s32, 3
    s_mul_i32 s32, s32, 30720
    v_lshl_add_u32 v6, v1, 4, s32
    s_sub_u32 s32, s20, 2
    s_and_b32 s32, s32, 3
    s_mul_i32 s32, s32, 30720
    v_lshl_add_u32 v7, v1, 4, s32
    s_sub_u32 s32, s20, 3
    s_and_b32 s32, s32, 3
    s_mul_i32 s32, s32, 30720
    v_lshl_add_u32 v8, v1, 4, s32
    s_sub_u32 s55, s56, 32
    s_waitcnt vmcnt(14)
    v_mfma_f32_16x16x32_bf16 v[88:91], a[0:3], v[32:35], 0
    v_mfma_f32_16x16x32_bf16 v[92:95], a[4:7], v[32:35], 0
    s_mov_b32 s51, 53248
    v_mfma_f32_16x16x32_bf16 v[96:99], a[8:11], v[32:35], 0
    buffer_load_dwordx4 a[208:211], v251, s[4:7], s51 offen offset:0
    v_mfma_f32_16x16x32_bf16 v[100:103], a[12:15], v[32:35], 0
    v_mfma_f32_16x16x32_bf16 v[104:107], a[16:19], v[32:35], 0
    s_waitcnt vmcnt(14)
    v_mfma_f32_16x16x32_bf16 v[108:111], a[0:3], v[36:39], 0
    buffer_load_dwordx4 v[32:35], v10, s[16:19], s42 offen offset:1024
    v_mfma_f32_16x16x32_bf16 v[112:115], a[4:7], v[36:39], 0
    v_mfma_f32_16x16x32_bf16 v[116:119], a[8:11], v[36:39], 0
    v_mfma_f32_16x16x32_bf16 v[120:123], a[12:15], v[36:39], 0
    v_mfma_f32_16x16x32_bf16 v[124:127], a[16:19], v[36:39], 0
    s_waitcnt vmcnt(14)
    v_mfma_f32_16x16x32_bf16 v[128:131], a[0:3], v[40:43], 0
    buffer_load_dwordx4 v[36:39], v10, s[16:19], s43 offen offset:1024
    v_mfma_f32_16x16x32_bf16 v[132:135], a[4:7], v[40:43], 0
    v_mfma_f32_16x16x32_bf16 v[136:139], a[8:11], v[40:43], 0
    v_mfma_f32_16x16x32_bf16 v[140:143], a[12:15], v[40:43], 0
    v_mfma_f32_16x16x32_bf16 v[144:147], a[16:19], v[40:43], 0
    s_waitcnt vmcnt(14)
    v_mfma_f32_16x16x32_bf16 v[148:151], a[0:3], v[44:47], 0
    buffer_load_dwordx4 v[40:43], v10, s[16:19], s44 offen offset:1024
    v_mfma_f32_16x16x32_bf16 v[152:155], a[4:7], v[44:47], 0
    v_mfma_f32_16x16x32_bf16 v[156:159], a[8:11], v[44:47], 0
    v_mfma_f32_16x16x32_bf16 v[160:163], a[12:15], v[44:47], 0
    v_mfma_f32_16x16x32_bf16 v[164:167], a[16:19], v[44:47], 0
    s_waitcnt vmcnt(14)
    v_mfma_f32_16x16x32_bf16 v[168:171], a[0:3], v[48:51], 0
    buffer_load_dwordx4 v[44:47], v10, s[16:19], s45 offen offset:1024
    v_mfma_f32_16x16x32_bf16 v[172:175], a[4:7], v[48:51], 0
    v_mfma_f32_16x16x32_bf16 v[176:179], a[8:11], v[48:51], 0
    buffer_load_dwordx4 a[212:215], v251, s[4:7], s51 offen offset:1024
    v_mfma_f32_16x16x32_bf16 v[180:183], a[12:15], v[48:51], 0
    v_mfma_f32_16x16x32_bf16 v[184:187], a[16:19], v[48:51], 0
    s_waitcnt vmcnt(15)
    v_mfma_f32_16x16x32_bf16 v[188:191], a[0:3], v[52:55], 0
    buffer_load_dwordx4 v[48:51], v10, s[16:19], s46 offen offset:1024
    v_mfma_f32_16x16x32_bf16 v[192:195], a[4:7], v[52:55], 0
    v_mfma_f32_16x16x32_bf16 v[196:199], a[8:11], v[52:55], 0
    v_mfma_f32_16x16x32_bf16 v[200:203], a[12:15], v[52:55], 0
    v_mfma_f32_16x16x32_bf16 v[204:207], a[16:19], v[52:55], 0
    s_waitcnt vmcnt(15)
    v_mfma_f32_16x16x32_bf16 v[208:211], a[0:3], v[56:59], v[208:211]
    buffer_load_dwordx4 v[52:55], v10, s[16:19], s47 offen offset:1024
    v_mfma_f32_16x16x32_bf16 v[212:215], a[4:7], v[56:59], v[212:215]
    v_mfma_f32_16x16x32_bf16 v[216:219], a[8:11], v[56:59], v[216:219]
    v_mfma_f32_16x16x32_bf16 v[220:223], a[12:15], v[56:59], v[220:223]
    v_mfma_f32_16x16x32_bf16 v[224:227], a[16:19], v[56:59], v[224:227]
    s_waitcnt vmcnt(15)
    v_mfma_f32_16x16x32_bf16 v[228:231], a[0:3], v[60:63], v[228:231]
    buffer_load_dwordx4 v[56:59], v11, s[16:19], s40 offen offset:2048
    v_mfma_f32_16x16x32_bf16 v[232:235], a[4:7], v[60:63], v[232:235]
    v_mfma_f32_16x16x32_bf16 v[236:239], a[8:11], v[60:63], v[236:239]
    v_mfma_f32_16x16x32_bf16 v[240:243], a[12:15], v[60:63], v[240:243]
    v_mfma_f32_16x16x32_bf16 v[244:247], a[16:19], v[60:63], v[244:247]
    s_waitcnt vmcnt(12)
    buffer_store_dword v250, off, s[80:83], s57
    v_mfma_f32_16x16x32_bf16 v[88:91], a[20:23], v[16:19], v[88:91]
    buffer_load_dwordx4 v[60:63], v11, s[16:19], s41 offen offset:2048
    v_mfma_f32_16x16x32_bf16 v[92:95], a[24:27], v[16:19], v[92:95]
    v_mfma_f32_16x16x32_bf16 v[96:99], a[28:31], v[16:19], v[96:99]
    buffer_load_dwordx4 a[216:219], v251, s[4:7], s51 offen offset:2048
    v_mfma_f32_16x16x32_bf16 v[100:103], a[32:35], v[16:19], v[100:103]
    v_mfma_f32_16x16x32_bf16 v[104:107], a[36:39], v[16:19], v[104:107]
    s_waitcnt vmcnt(14)
    v_mfma_f32_16x16x32_bf16 v[108:111], a[20:23], v[20:23], v[108:111]
    buffer_load_dwordx4 v[16:19], v11, s[16:19], s42 offen offset:2048
    v_mfma_f32_16x16x32_bf16 v[112:115], a[24:27], v[20:23], v[112:115]
    v_mfma_f32_16x16x32_bf16 v[116:119], a[28:31], v[20:23], v[116:119]
    v_mfma_f32_16x16x32_bf16 v[120:123], a[32:35], v[20:23], v[120:123]
    v_mfma_f32_16x16x32_bf16 v[124:127], a[36:39], v[20:23], v[124:127]
    s_waitcnt vmcnt(11)
    v_mfma_f32_16x16x32_bf16 v[128:131], a[20:23], v[32:35], v[128:131]
    buffer_load_dwordx4 v[20:23], v11, s[16:19], s43 offen offset:2048
    v_mfma_f32_16x16x32_bf16 v[132:135], a[24:27], v[32:35], v[132:135]
    v_mfma_f32_16x16x32_bf16 v[136:139], a[28:31], v[32:35], v[136:139]
    v_mfma_f32_16x16x32_bf16 v[140:143], a[32:35], v[32:35], v[140:143]
    v_mfma_f32_16x16x32_bf16 v[144:147], a[36:39], v[32:35], v[144:147]
    s_waitcnt vmcnt(11)
    v_mfma_f32_16x16x32_bf16 v[148:151], a[20:23], v[36:39], v[148:151]
    buffer_load_dwordx4 v[32:35], v11, s[16:19], s44 offen offset:2048
    v_mfma_f32_16x16x32_bf16 v[152:155], a[24:27], v[36:39], v[152:155]
    v_mfma_f32_16x16x32_bf16 v[156:159], a[28:31], v[36:39], v[156:159]
    v_mfma_f32_16x16x32_bf16 v[160:163], a[32:35], v[36:39], v[160:163]
    v_mfma_f32_16x16x32_bf16 v[164:167], a[36:39], v[36:39], v[164:167]
    s_waitcnt vmcnt(11)
    v_mfma_f32_16x16x32_bf16 v[168:171], a[20:23], v[40:43], v[168:171]
    buffer_load_dwordx4 v[36:39], v11, s[16:19], s45 offen offset:2048
    v_mfma_f32_16x16x32_bf16 v[172:175], a[24:27], v[40:43], v[172:175]
    v_mfma_f32_16x16x32_bf16 v[176:179], a[28:31], v[40:43], v[176:179]
    buffer_load_dwordx4 a[220:223], v251, s[4:7], s51 offen offset:3072
    v_mfma_f32_16x16x32_bf16 v[180:183], a[32:35], v[40:43], v[180:183]
    v_mfma_f32_16x16x32_bf16 v[184:187], a[36:39], v[40:43], v[184:187]
    s_waitcnt vmcnt(12)
    v_mfma_f32_16x16x32_bf16 v[188:191], a[20:23], v[44:47], v[188:191]
    buffer_load_dwordx4 v[40:43], v11, s[16:19], s46 offen offset:2048
    v_mfma_f32_16x16x32_bf16 v[192:195], a[24:27], v[44:47], v[192:195]
    v_mfma_f32_16x16x32_bf16 v[196:199], a[28:31], v[44:47], v[196:199]
    v_mfma_f32_16x16x32_bf16 v[200:203], a[32:35], v[44:47], v[200:203]
    v_mfma_f32_16x16x32_bf16 v[204:207], a[36:39], v[44:47], v[204:207]
    s_waitcnt vmcnt(11)
    v_mfma_f32_16x16x32_bf16 v[208:211], a[20:23], v[48:51], v[208:211]
    buffer_load_dwordx4 v[44:47], v11, s[16:19], s47 offen offset:2048
    v_mfma_f32_16x16x32_bf16 v[212:215], a[24:27], v[48:51], v[212:215]
    v_mfma_f32_16x16x32_bf16 v[216:219], a[28:31], v[48:51], v[216:219]
    v_mfma_f32_16x16x32_bf16 v[220:223], a[32:35], v[48:51], v[220:223]
    v_mfma_f32_16x16x32_bf16 v[224:227], a[36:39], v[48:51], v[224:227]
    s_waitcnt vmcnt(11)
    buffer_load_dword v14, v15, s[80:83], 0 offen sc1
    v_mfma_f32_16x16x32_bf16 v[228:231], a[20:23], v[52:55], v[228:231]
    buffer_load_dwordx4 v[48:51], v11, s[16:19], s40 offen offset:3072
    v_mfma_f32_16x16x32_bf16 v[232:235], a[24:27], v[52:55], v[232:235]
    v_mfma_f32_16x16x32_bf16 v[236:239], a[28:31], v[52:55], v[236:239]
    v_mfma_f32_16x16x32_bf16 v[240:243], a[32:35], v[52:55], v[240:243]
    v_mfma_f32_16x16x32_bf16 v[244:247], a[36:39], v[52:55], v[244:247]
    s_waitcnt vmcnt(12)
    v_mfma_f32_16x16x32_bf16 v[88:91], a[120:123], v[56:59], v[88:91]
    buffer_load_dwordx4 v[52:55], v11, s[16:19], s41 offen offset:3072
    v_mfma_f32_16x16x32_bf16 v[92:95], a[124:127], v[56:59], v[92:95]
    s_mov_b32 s51, 57344
    v_mfma_f32_16x16x32_bf16 v[96:99], a[128:131], v[56:59], v[96:99]
    buffer_load_dwordx4 a[224:227], v251, s[4:7], s51 offen offset:0
    v_mfma_f32_16x16x32_bf16 v[100:103], a[132:135], v[56:59], v[100:103]
    v_mfma_f32_16x16x32_bf16 v[104:107], a[136:139], v[56:59], v[104:107]
    s_waitcnt vmcnt(12)
    v_mfma_f32_16x16x32_bf16 v[108:111], a[120:123], v[60:63], v[108:111]
    buffer_load_dwordx4 v[56:59], v11, s[16:19], s42 offen offset:3072
    v_mfma_f32_16x16x32_bf16 v[112:115], a[124:127], v[60:63], v[112:115]
    v_mfma_f32_16x16x32_bf16 v[116:119], a[128:131], v[60:63], v[116:119]
    v_mfma_f32_16x16x32_bf16 v[120:123], a[132:135], v[60:63], v[120:123]
    v_mfma_f32_16x16x32_bf16 v[124:127], a[136:139], v[60:63], v[124:127]
    s_waitcnt vmcnt(11)
    v_mfma_f32_16x16x32_bf16 v[128:131], a[120:123], v[16:19], v[128:131]
    buffer_load_dwordx4 v[60:63], v11, s[16:19], s43 offen offset:3072
    v_mfma_f32_16x16x32_bf16 v[132:135], a[124:127], v[16:19], v[132:135]
    v_mfma_f32_16x16x32_bf16 v[136:139], a[128:131], v[16:19], v[136:139]
    v_mfma_f32_16x16x32_bf16 v[140:143], a[132:135], v[16:19], v[140:143]
    v_mfma_f32_16x16x32_bf16 v[144:147], a[136:139], v[16:19], v[144:147]
    s_waitcnt vmcnt(11)
    v_mfma_f32_16x16x32_bf16 v[148:151], a[120:123], v[20:23], v[148:151]
    buffer_load_dwordx4 v[16:19], v11, s[16:19], s44 offen offset:3072
    v_mfma_f32_16x16x32_bf16 v[152:155], a[124:127], v[20:23], v[152:155]
    v_mfma_f32_16x16x32_bf16 v[156:159], a[128:131], v[20:23], v[156:159]
    v_mfma_f32_16x16x32_bf16 v[160:163], a[132:135], v[20:23], v[160:163]
    v_mfma_f32_16x16x32_bf16 v[164:167], a[136:139], v[20:23], v[164:167]
    s_waitcnt vmcnt(11)
    v_mfma_f32_16x16x32_bf16 v[168:171], a[120:123], v[32:35], v[168:171]
    buffer_load_dwordx4 v[20:23], v11, s[16:19], s45 offen offset:3072
    v_mfma_f32_16x16x32_bf16 v[172:175], a[124:127], v[32:35], v[172:175]
    v_mfma_f32_16x16x32_bf16 v[176:179], a[128:131], v[32:35], v[176:179]
    buffer_load_dwordx4 a[228:231], v251, s[4:7], s51 offen offset:1024
    v_mfma_f32_16x16x32_bf16 v[180:183], a[132:135], v[32:35], v[180:183]
    v_mfma_f32_16x16x32_bf16 v[184:187], a[136:139], v[32:35], v[184:187]
    s_waitcnt vmcnt(12)
    v_mfma_f32_16x16x32_bf16 v[188:191], a[120:123], v[36:39], v[188:191]
    buffer_load_dwordx4 v[32:35], v11, s[16:19], s46 offen offset:3072
    v_mfma_f32_16x16x32_bf16 v[192:195], a[124:127], v[36:39], v[192:195]
    v_mfma_f32_16x16x32_bf16 v[196:199], a[128:131], v[36:39], v[196:199]
    v_mfma_f32_16x16x32_bf16 v[200:203], a[132:135], v[36:39], v[200:203]
    v_mfma_f32_16x16x32_bf16 v[204:207], a[136:139], v[36:39], v[204:207]
    s_waitcnt vmcnt(11)
    v_mfma_f32_16x16x32_bf16 v[208:211], a[120:123], v[40:43], v[208:211]
    buffer_load_dwordx4 v[36:39], v11, s[16:19], s47 offen offset:3072
    v_mfma_f32_16x16x32_bf16 v[212:215], a[124:127], v[40:43], v[212:215]
    v_mfma_f32_16x16x32_bf16 v[216:219], a[128:131], v[40:43], v[216:219]
    v_mfma_f32_16x16x32_bf16 v[220:223], a[132:135], v[40:43], v[220:223]
    v_mfma_f32_16x16x32_bf16 v[224:227], a[136:139], v[40:43], v[224:227]
    s_waitcnt vmcnt(11)
    s_waitcnt vmcnt(10)
    s_mov_b32 s98, 0
PL_80:
    v_cmp_gt_u32 vcc, 2, v14
    s_cbranch_vccz PD_81
    s_add_u32 s98, s98, 1
    s_cmp_ge_u32 s98, 0x40000
    s_cbranch_scc1 PD_81
    s_sleep 2
    buffer_load_dword v14, v15, s[80:83], 0 offen sc1
    s_waitcnt vmcnt(0)
    s_branch PL_80
PD_81:
    v_mfma_f32_16x16x32_bf16 v[228:231], a[120:123], v[44:47], v[228:231]
    buffer_load_dwordx4 v[40:43], v10, s[16:19], s40 offen offset:2048
    v_mfma_f32_16x16x32_bf16 v[232:235], a[124:127], v[44:47], v[232:235]
    v_mfma_f32_16x16x32_bf16 v[236:239], a[128:131], v[44:47], v[236:239]
    v_mfma_f32_16x16x32_bf16 v[240:243], a[132:135], v[44:47], v[240:243]
    v_mfma_f32_16x16x32_bf16 v[244:247], a[136:139], v[44:47], v[244:247]
    s_waitcnt vmcnt(10)
    v_mfma_f32_16x16x32_bf16 v[88:91], a[140:143], v[48:51], v[88:91]
    buffer_load_dwordx4 v[44:47], v10, s[16:19], s41 offen offset:2048
    v_mfma_f32_16x16x32_bf16 v[92:95], a[144:147], v[48:51], v[92:95]
    v_mfma_f32_16x16x32_bf16 v[96:99], a[148:151], v[48:51], v[96:99]
    buffer_load_dwordx4 a[232:235], v251, s[4:7], s51 offen offset:2048
    v_mfma_f32_16x16x32_bf16 v[100:103], a[152:155], v[48:51], v[100:103]
    v_mfma_f32_16x16x32_bf16 v[104:107], a[156:159], v[48:51], v[104:107]
    s_waitcnt vmcnt(11)
    v_mfma_f32_16x16x32_bf16 v[108:111], a[140:143], v[52:55], v[108:111]
    buffer_load_dwordx4 v[48:51], v10, s[16:19], s42 offen offset:2048
    v_mfma_f32_16x16x32_bf16 v[112:115], a[144:147], v[52:55], v[112:115]
    v_mfma_f32_16x16x32_bf16 v[116:119], a[148:151], v[52:55], v[116:119]
    v_mfma_f32_16x16x32_bf16 v[120:123], a[152:155], v[52:55], v[120:123]
    v_mfma_f32_16x16x32_bf16 v[124:127], a[156:159], v[52:55], v[124:127]
    s_waitcnt vmcnt(10)
    v_mfma_f32_16x16x32_bf16 v[128:131], a[140:143], v[56:59], v[128:131]
    buffer_load_dwordx4 v[52:55], v10, s[16:19], s43 offen offset:2048
    v_mfma_f32_16x16x32_bf16 v[132:135], a[144:147], v[56:59], v[132:135]
    v_mfma_f32_16x16x32_bf16 v[136:139], a[148:151], v[56:59], v[136:139]
    v_mfma_f32_16x16x32_bf16 v[140:143], a[152:155], v[56:59], v[140:143]
    v_mfma_f32_16x16x32_bf16 v[144:147], a[156:159], v[56:59], v[144:147]
    s_waitcnt vmcnt(10)
    v_mfma_f32_16x16x32_bf16 v[148:151], a[140:143], v[60:63], v[148:151]
    buffer_load_dwordx4 v[56:59], v10, s[16:19], s44 offen offset:2048
    v_mfma_f32_16x16x32_bf16 v[152:155], a[144:147], v[60:63], v[152:155]
    v_mfma_f32_16x16x32_bf16 v[156:159], a[148:151], v[60:63], v[156:159]
    v_mfma_f32_16x16x32_bf16 v[160:163], a[152:155], v[60:63], v[160:163]
    v_mfma_f32_16x16x32_bf16 v[164:167], a[156:159], v[60:63], v[164:167]
    s_waitcnt vmcnt(10)
    v_mfma_f32_16x16x32_bf16 v[168:171], a[140:143], v[16:19], v[168:171]
    buffer_load_dwordx4 v[60:63], v10, s[16:19], s45 offen offset:2048
    v_mfma_f32_16x16x32_bf16 v[172:175], a[144:147], v[16:19], v[172:175]
    v_mfma_f32_16x16x32_bf16 v[176:179], a[148:151], v[16:19], v[176:179]
    buffer_load_dwordx4 a[236:239], v251, s[4:7], s51 offen offset:3072
    v_mfma_f32_16x16x32_bf16 v[180:183], a[152:155], v[16:19], v[180:183]
    v_mfma_f32_16x16x32_bf16 v[184:187], a[156:159], v[16:19], v[184:187]
    s_waitcnt vmcnt(11)
    v_mfma_f32_16x16x32_bf16 v[188:191], a[140:143], v[20:23], v[188:191]
    buffer_load_dwordx4 v[16:19], v10, s[16:19], s46 offen offset:2048
    v_mfma_f32_16x16x32_bf16 v[192:195], a[144:147], v[20:23], v[192:195]
    v_mfma_f32_16x16x32_bf16 v[196:199], a[148:151], v[20:23], v[196:199]
    v_mfma_f32_16x16x32_bf16 v[200:203], a[152:155], v[20:23], v[200:203]
    v_mfma_f32_16x16x32_bf16 v[204:207], a[156:159], v[20:23], v[204:207]
    s_waitcnt vmcnt(10)
    v_mfma_f32_16x16x32_bf16 v[208:211], a[140:143], v[32:35], v[208:211]
    buffer_load_dwordx4 v[20:23], v10, s[16:19], s47 offen offset:2048
    v_mfma_f32_16x16x32_bf16 v[212:215], a[144:147], v[32:35], v[212:215]
    v_mfma_f32_16x16x32_bf16 v[216:219], a[148:151], v[32:35], v[216:219]
    v_mfma_f32_16x16x32_bf16 v[220:223], a[152:155], v[32:35], v[220:223]
    v_mfma_f32_16x16x32_bf16 v[224:227], a[156:159], v[32:35], v[224:227]
    s_waitcnt vmcnt(10)
    v_mfma_f32_16x16x32_bf16 v[228:231], a[140:143], v[36:39], v[228:231]
    buffer_load_dwordx4 v[32:35], v10, s[16:19], s40 offen offset:3072
    v_mfma_f32_16x16x32_bf16 v[232:235], a[144:147], v[36:39], v[232:235]
    v_mfma_f32_16x16x32_bf16 v[236:239], a[148:151], v[36:39], v[236:239]
    v_mfma_f32_16x16x32_bf16 v[240:243], a[152:155], v[36:39], v[240:243]
    v_mfma_f32_16x16x32_bf16 v[244:247], a[156:159], v[36:39], v[244:247]
    s_waitcnt vmcnt(10)
    v_mfma_f32_16x16x32_bf16 v[88:91], a[40:43], v[40:43], v[88:91]
    buffer_load_dwordx4 v[36:39], v10, s[16:19], s41 offen offset:3072
    v_mfma_f32_16x16x32_bf16 v[92:95], a[44:47], v[40:43], v[92:95]
    v_mfma_f32_16x16x32_bf16 v[96:99], a[48:51], v[40:43], v[96:99]
    v_mfma_f32_16x16x32_bf16 v[100:103], a[52:55], v[40:43], v[100:103]
    v_mfma_f32_16x16x32_bf16 v[104:107], a[56:59], v[40:43], v[104:107]
    s_waitcnt vmcnt(10)
    buffer_load_dword v14, v15, s[80:83], 0 offen sc1
    v_mfma_f32_16x16x32_bf16 v[108:111], a[40:43], v[44:47], v[108:111]
    buffer_load_dwordx4 v[40:43], v10, s[16:19], s42 offen offset:3072
    v_mfma_f32_16x16x32_bf16 v[112:115], a[44:47], v[44:47], v[112:115]
    v_mfma_f32_16x16x32_bf16 v[116:119], a[48:51], v[44:47], v[116:119]
    v_mfma_f32_16x16x32_bf16 v[120:123], a[52:55], v[44:47], v[120:123]
    v_mfma_f32_16x16x32_bf16 v[124:127], a[56:59], v[44:47], v[124:127]
    s_waitcnt vmcnt(10)
    v_mfma_f32_16x16x32_bf16 v[128:131], a[40:43], v[48:51], v[128:131]
    buffer_load_dwordx4 v[44:47], v10, s[16:19], s43 offen offset:3072
    v_mfma_f32_16x16x32_bf16 v[132:135], a[44:47], v[48:51], v[132:135]
    v_mfma_f32_16x16x32_bf16 v[136:139], a[48:51], v[48:51], v[136:139]
    v_mfma_f32_16x16x32_bf16 v[140:143], a[52:55], v[48:51], v[140:143]
    v_mfma_f32_16x16x32_bf16 v[144:147], a[56:59], v[48:51], v[144:147]
    s_waitcnt vmcnt(10)
    v_mfma_f32_16x16x32_bf16 v[148:151], a[40:43], v[52:55], v[148:151]
    buffer_load_dwordx4 v[48:51], v10, s[16:19], s44 offen offset:3072
    v_mfma_f32_16x16x32_bf16 v[152:155], a[44:47], v[52:55], v[152:155]
    v_mfma_f32_16x16x32_bf16 v[156:159], a[48:51], v[52:55], v[156:159]
    v_mfma_f32_16x16x32_bf16 v[160:163], a[52:55], v[52:55], v[160:163]
    v_mfma_f32_16x16x32_bf16 v[164:167], a[56:59], v[52:55], v[164:167]
    s_waitcnt vmcnt(10)
    v_mfma_f32_16x16x32_bf16 v[168:171], a[40:43], v[56:59], v[168:171]
    buffer_load_dwordx4 v[52:55], v10, s[16:19], s45 offen offset:3072
    v_mfma_f32_16x16x32_bf16 v[172:175], a[44:47], v[56:59], v[172:175]
    v_mfma_f32_16x16x32_bf16 v[176:179], a[48:51], v[56:59], v[176:179]
    v_mfma_f32_16x16x32_bf16 v[180:183], a[52:55], v[56:59], v[180:183]
    v_mfma_f32_16x16x32_bf16 v[184:187], a[56:59], v[56:59], v[184:187]
    s_waitcnt vmcnt(10)
    v_mfma_f32_16x16x32_bf16 v[188:191], a[40:43], v[60:63], v[188:191]
    buffer_load_dwordx4 v[56:59], v10, s[16:19], s46 offen offset:3072
    v_mfma_f32_16x16x32_bf16 v[192:195], a[44:47], v[60:63], v[192:195]
    v_mfma_f32_16x16x32_bf16 v[196:199], a[48:51], v[60:63], v[196:199]
    v_mfma_f32_16x16x32_bf16 v[200:203], a[52:55], v[60:63], v[200:203]
    v_mfma_f32_16x16x32_bf16 v[204:207], a[56:59], v[60:63], v[204:207]
    s_waitcnt vmcnt(9)
    v_mfma_f32_16x16x32_bf16 v[208:211], a[40:43], v[16:19], v[208:211]
    buffer_load_dwordx4 v[60:63], v10, s[16:19], s47 offen offset:3072
    v_mfma_f32_16x16x32_bf16 v[212:215], a[44:47], v[16:19], v[212:215]
    v_mfma_f32_16x16x32_bf16 v[216:219], a[48:51], v[16:19], v[216:219]
    v_mfma_f32_16x16x32_bf16 v[220:223], a[52:55], v[16:19], v[220:223]
    v_mfma_f32_16x16x32_bf16 v[224:227], a[56:59], v[16:19], v[224:227]
    s_waitcnt vmcnt(9)
    v_mfma_f32_16x16x32_bf16 v[228:231], a[40:43], v[20:23], v[228:231]
    buffer_load_dwordx4 v[16:19], v12, s[16:19], s40 offen offset:0
    v_mfma_f32_16x16x32_bf16 v[232:235], a[44:47], v[20:23], v[232:235]
    v_mfma_f32_16x16x32_bf16 v[236:239], a[48:51], v[20:23], v[236:239]
    v_mfma_f32_16x16x32_bf16 v[240:243], a[52:55], v[20:23], v[240:243]
    v_mfma_f32_16x16x32_bf16 v[244:247], a[56:59], v[20:23], v[244:247]
    s_waitcnt vmcnt(9)
    v_mfma_f32_16x16x32_bf16 v[88:91], a[60:63], v[32:35], v[88:91]
    buffer_load_dwordx4 v[20:23], v12, s[16:19], s40 offen offset:1024
    v_mfma_f32_16x16x32_bf16 v[92:95], a[64:67], v[32:35], v[92:95]
    v_mfma_f32_16x16x32_bf16 v[96:99], a[68:71], v[32:35], v[96:99]
    v_mfma_f32_16x16x32_bf16 v[100:103], a[72:75], v[32:35], v[100:103]
    v_mfma_f32_16x16x32_bf16 v[104:107], a[76:79], v[32:35], v[104:107]
    s_waitcnt vmcnt(9)
    s_waitcnt vmcnt(8)
    s_mov_b32 s98, 0
PL_82:
    v_cmp_gt_u32 vcc, 3, v14
    s_cbranch_vccz PD_83
    s_add_u32 s98, s98, 1
    s_cmp_ge_u32 s98, 0x40000
    s_cbranch_scc1 PD_83
    s_sleep 2
    buffer_load_dword v14, v15, s[80:83], 0 offen sc1
    s_waitcnt vmcnt(0)
    s_branch PL_82
PD_83:
    v_mfma_f32_16x16x32_bf16 v[108:111], a[60:63], v[36:39], v[108:111]
    buffer_load_dwordx4 v[32:35], v11, s[16:19], s40 offen offset:0
    v_mfma_f32_16x16x32_bf16 v[112:115], a[64:67], v[36:39], v[112:115]
    v_mfma_f32_16x16x32_bf16 v[116:119], a[68:71], v[36:39], v[116:119]
    v_mfma_f32_16x16x32_bf16 v[120:123], a[72:75], v[36:39], v[120:123]
    v_mfma_f32_16x16x32_bf16 v[124:127], a[76:79], v[36:39], v[124:127]
    s_waitcnt vmcnt(8)
    v_mfma_f32_16x16x32_bf16 v[128:131], a[60:63], v[40:43], v[128:131]
    buffer_load_dwordx4 v[36:39], v11, s[16:19], s40 offen offset:1024
    v_mfma_f32_16x16x32_bf16 v[132:135], a[64:67], v[40:43], v[132:135]
    v_mfma_f32_16x16x32_bf16 v[136:139], a[68:71], v[40:43], v[136:139]
    v_mfma_f32_16x16x32_bf16 v[140:143], a[72:75], v[40:43], v[140:143]
    v_mfma_f32_16x16x32_bf16 v[144:147], a[76:79], v[40:43], v[144:147]
    s_waitcnt vmcnt(8)
    v_mfma_f32_16x16x32_bf16 v[148:151], a[60:63], v[44:47], v[148:151]
    buffer_load_dwordx4 v[40:43], v12, s[16:19], s40 offen offset:2048
    v_mfma_f32_16x16x32_bf16 v[152:155], a[64:67], v[44:47], v[152:155]
    v_mfma_f32_16x16x32_bf16 v[156:159], a[68:71], v[44:47], v[156:159]
    v_mfma_f32_16x16x32_bf16 v[160:163], a[72:75], v[44:47], v[160:163]
    v_mfma_f32_16x16x32_bf16 v[164:167], a[76:79], v[44:47], v[164:167]
    s_waitcnt vmcnt(8)
    v_mfma_f32_16x16x32_bf16 v[168:171], a[60:63], v[48:51], v[168:171]
    buffer_load_dwordx4 v[44:47], v12, s[16:19], s40 offen offset:3072
    v_mfma_f32_16x16x32_bf16 v[172:175], a[64:67], v[48:51], v[172:175]
    v_mfma_f32_16x16x32_bf16 v[176:179], a[68:71], v[48:51], v[176:179]
    v_mfma_f32_16x16x32_bf16 v[180:183], a[72:75], v[48:51], v[180:183]
    v_mfma_f32_16x16x32_bf16 v[184:187], a[76:79], v[48:51], v[184:187]
    s_waitcnt vmcnt(8)
    v_mfma_f32_16x16x32_bf16 v[188:191], a[60:63], v[52:55], v[188:191]
    buffer_load_dwordx4 v[48:51], v12, s[16:19], s41 offen offset:0
    v_mfma_f32_16x16x32_bf16 v[192:195], a[64:67], v[52:55], v[192:195]
    v_mfma_f32_16x16x32_bf16 v[196:199], a[68:71], v[52:55], v[196:199]
    v_mfma_f32_16x16x32_bf16 v[200:203], a[72:75], v[52:55], v[200:203]
    v_mfma_f32_16x16x32_bf16 v[204:207], a[76:79], v[52:55], v[204:207]
    s_waitcnt vmcnt(8)
    v_mfma_f32_16x16x32_bf16 v[208:211], a[60:63], v[56:59], v[208:211]
    buffer_load_dwordx4 v[52:55], v12, s[16:19], s41 offen offset:1024
    v_mfma_f32_16x16x32_bf16 v[212:215], a[64:67], v[56:59], v[212:215]
    v_mfma_f32_16x16x32_bf16 v[216:219], a[68:71], v[56:59], v[216:219]
    v_mfma_f32_16x16x32_bf16 v[220:223], a[72:75], v[56:59], v[220:223]
    v_mfma_f32_16x16x32_bf16 v[224:227], a[76:79], v[56:59], v[224:227]
    s_waitcnt vmcnt(8)
    v_mfma_f32_16x16x32_bf16 v[228:231], a[60:63], v[60:63], v[228:231]
    buffer_load_dwordx4 v[56:59], v11, s[16:19], s41 offen offset:0
    v_mfma_f32_16x16x32_bf16 v[232:235], a[64:67], v[60:63], v[232:235]
    v_mfma_f32_16x16x32_bf16 v[236:239], a[68:71], v[60:63], v[236:239]
    v_mfma_f32_16x16x32_bf16 v[240:243], a[72:75], v[60:63], v[240:243]
    v_mfma_f32_16x16x32_bf16 v[244:247], a[76:79], v[60:63], v[244:247]
    s_waitcnt vmcnt(8)
    v_mfma_f32_16x16x32_bf16 v[88:91], a[160:163], v[16:19], v[88:91]
    buffer_load_dwordx4 v[60:63], v11, s[16:19], s41 offen offset:1024
    v_mfma_f32_16x16x32_bf16 v[92:95], a[164:167], v[16:19], v[92:95]
    v_mfma_f32_16x16x32_bf16 v[96:99], a[168:171], v[16:19], v[96:99]
    v_mfma_f32_16x16x32_bf16 v[100:103], a[172:175], v[16:19], v[100:103]
    v_mfma_f32_16x16x32_bf16 v[104:107], a[176:179], v[16:19], v[104:107]
    s_waitcnt vmcnt(8)
    v_mfma_f32_16x16x32_bf16 v[88:91], a[180:183], v[20:23], v[88:91]
    buffer_load_dwordx4 v[16:19], v12, s[16:19], s41 offen offset:2048
    v_mfma_f32_16x16x32_bf16 v[92:95], a[184:187], v[20:23], v[92:95]
    v_mfma_f32_16x16x32_bf16 v[96:99], a[188:191], v[20:23], v[96:99]
    v_mfma_f32_16x16x32_bf16 v[100:103], a[192:195], v[20:23], v[100:103]
    v_mfma_f32_16x16x32_bf16 v[104:107], a[196:199], v[20:23], v[104:107]
    s_waitcnt vmcnt(8)
    v_mfma_f32_16x16x32_bf16 v[88:91], a[80:83], v[32:35], v[88:91]
    buffer_load_dwordx4 v[20:23], v12, s[16:19], s41 offen offset:3072
    v_mfma_f32_16x16x32_bf16 v[92:95], a[84:87], v[32:35], v[92:95]
    v_mfma_f32_16x16x32_bf16 v[96:99], a[88:91], v[32:35], v[96:99]
    v_mfma_f32_16x16x32_bf16 v[100:103], a[92:95], v[32:35], v[100:103]
    v_mfma_f32_16x16x32_bf16 v[104:107], a[96:99], v[32:35], v[104:107]
    s_waitcnt vmcnt(8)
    v_mfma_f32_16x16x32_bf16 v[88:91], a[100:103], v[36:39], v[88:91]
    buffer_load_dwordx4 v[32:35], v12, s[16:19], s42 offen offset:0
    v_mfma_f32_16x16x32_bf16 v[92:95], a[104:107], v[36:39], v[92:95]
    v_mfma_f32_16x16x32_bf16 v[96:99], a[108:111], v[36:39], v[96:99]
    v_mfma_f32_16x16x32_bf16 v[100:103], a[112:115], v[36:39], v[100:103]
    v_mfma_f32_16x16x32_bf16 v[104:107], a[116:119], v[36:39], v[104:107]
    s_waitcnt vmcnt(8)
    v_mfma_f32_16x16x32_bf16 v[88:91], a[200:203], v[40:43], v[88:91]
    buffer_load_dwordx4 v[36:39], v12, s[16:19], s42 offen offset:1024
    v_mfma_f32_16x16x32_bf16 v[92:95], a[204:207], v[40:43], v[92:95]
    v_mfma_f32_16x16x32_bf16 v[96:99], a[208:211], v[40:43], v[96:99]
    v_mfma_f32_16x16x32_bf16 v[100:103], a[212:215], v[40:43], v[100:103]
    v_mfma_f32_16x16x32_bf16 v[104:107], a[216:219], v[40:43], v[104:107]
    s_waitcnt vmcnt(8)
    v_mfma_f32_16x16x32_bf16 v[88:91], a[220:223], v[44:47], v[88:91]
    buffer_load_dwordx4 v[40:43], v11, s[16:19], s42 offen offset:0
    v_mfma_f32_16x16x32_bf16 v[92:95], a[224:227], v[44:47], v[92:95]
    v_mfma_f32_16x16x32_bf16 v[96:99], a[228:231], v[44:47], v[96:99]
    v_mfma_f32_16x16x32_bf16 v[100:103], a[232:235], v[44:47], v[100:103]
    v_mfma_f32_16x16x32_bf16 v[104:107], a[236:239], v[44:47], v[104:107]
    s_waitcnt vmcnt(8)
    v_mfma_f32_16x16x32_bf16 v[108:111], a[160:163], v[48:51], v[108:111]
    buffer_load_dwordx4 v[44:47], v11, s[16:19], s42 offen offset:1024
    v_mfma_f32_16x16x32_bf16 v[112:115], a[164:167], v[48:51], v[112:115]
    ds_write_b128 v13, v[88:91] offset:0
    v_mfma_f32_16x16x32_bf16 v[116:119], a[168:171], v[48:51], v[116:119]
    v_mfma_f32_16x16x32_bf16 v[120:123], a[172:175], v[48:51], v[120:123]
    ds_write_b128 v13, v[92:95] offset:1024
    v_mfma_f32_16x16x32_bf16 v[124:127], a[176:179], v[48:51], v[124:127]
    s_waitcnt vmcnt(8)
    v_mfma_f32_16x16x32_bf16 v[108:111], a[180:183], v[52:55], v[108:111]
    buffer_load_dwordx4 v[48:51], v12, s[16:19], s42 offen offset:2048
    v_mfma_f32_16x16x32_bf16 v[112:115], a[184:187], v[52:55], v[112:115]
    ds_write_b128 v13, v[96:99] offset:2048
    v_mfma_f32_16x16x32_bf16 v[116:119], a[188:191], v[52:55], v[116:119]
    v_mfma_f32_16x16x32_bf16 v[120:123], a[192:195], v[52:55], v[120:123]
    ds_write_b128 v13, v[100:103] offset:3072
    v_mfma_f32_16x16x32_bf16 v[124:127], a[196:199], v[52:55], v[124:127]
    s_waitcnt vmcnt(8)
    v_mfma_f32_16x16x32_bf16 v[108:111], a[80:83], v[56:59], v[108:111]
    buffer_load_dwordx4 v[52:55], v12, s[16:19], s42 offen offset:3072
    v_mfma_f32_16x16x32_bf16 v[112:115], a[84:87], v[56:59], v[112:115]
    ds_write_b128 v13, v[104:107] offset:4096
    v_mfma_f32_16x16x32_bf16 v[116:119], a[88:91], v[56:59], v[116:119]
    v_mfma_f32_16x16x32_bf16 v[120:123], a[92:95], v[56:59], v[120:123]
    v_mfma_f32_16x16x32_bf16 v[124:127], a[96:99], v[56:59], v[124:127]
    s_waitcnt vmcnt(8)
    v_mfma_f32_16x16x32_bf16 v[108:111], a[100:103], v[60:63], v[108:111]
    buffer_load_dwordx4 v[56:59], v12, s[16:19], s43 offen offset:0
    v_mfma_f32_16x16x32_bf16 v[112:115], a[104:107], v[60:63], v[112:115]
    v_mfma_f32_16x16x32_bf16 v[116:119], a[108:111], v[60:63], v[116:119]
    v_mfma_f32_16x16x32_bf16 v[120:123], a[112:115], v[60:63], v[120:123]
    v_mfma_f32_16x16x32_bf16 v[124:127], a[116:119], v[60:63], v[124:127]
    s_waitcnt vmcnt(8)
    v_mfma_f32_16x16x32_bf16 v[108:111], a[200:203], v[16:19], v[108:111]
    buffer_load_dwordx4 v[60:63], v12, s[16:19], s43 offen offset:1024
    v_mfma_f32_16x16x32_bf16 v[112:115], a[204:207], v[16:19], v[112:115]
    v_mfma_f32_16x16x32_bf16 v[116:119], a[208:211], v[16:19], v[116:119]
    v_mfma_f32_16x16x32_bf16 v[120:123], a[212:215], v[16:19], v[120:123]
    v_mfma_f32_16x16x32_bf16 v[124:127], a[216:219], v[16:19], v[124:127]
    s_waitcnt vmcnt(8)
    v_mfma_f32_16x16x32_bf16 v[108:111], a[220:223], v[20:23], v[108:111]
    buffer_load_dwordx4 v[16:19], v11, s[16:19], s43 offen offset:0
    v_mfma_f32_16x16x32_bf16 v[112:115], a[224:227], v[20:23], v[112:115]
    v_mfma_f32_16x16x32_bf16 v[116:119], a[228:231], v[20:23], v[116:119]
    v_mfma_f32_16x16x32_bf16 v[120:123], a[232:235], v[20:23], v[120:123]
    v_mfma_f32_16x16x32_bf16 v[124:127], a[236:239], v[20:23], v[124:127]
    s_waitcnt vmcnt(8)
    v_mfma_f32_16x16x32_bf16 v[128:131], a[160:163], v[32:35], v[128:131]
    buffer_load_dwordx4 v[20:23], v11, s[16:19], s43 offen offset:1024
    v_mfma_f32_16x16x32_bf16 v[132:135], a[164:167], v[32:35], v[132:135]
    ds_write_b128 v13, v[108:111] offset:5120
    v_mfma_f32_16x16x32_bf16 v[136:139], a[168:171], v[32:35], v[136:139]
    v_mfma_f32_16x16x32_bf16 v[140:143], a[172:175], v[32:35], v[140:143]
    ds_write_b128 v13, v[112:115] offset:6144
    v_mfma_f32_16x16x32_bf16 v[144:147], a[176:179], v[32:35], v[144:147]
    s_waitcnt vmcnt(8)
    v_mfma_f32_16x16x32_bf16 v[128:131], a[180:183], v[36:39], v[128:131]
    buffer_load_dwordx4 v[32:35], v12, s[16:19], s43 offen offset:2048
    v_mfma_f32_16x16x32_bf16 v[132:135], a[184:187], v[36:39], v[132:135]
    ds_write_b128 v13, v[116:119] offset:7168
    v_mfma_f32_16x16x32_bf16 v[136:139], a[188:191], v[36:39], v[136:139]
    v_mfma_f32_16x16x32_bf16 v[140:143], a[192:195], v[36:39], v[140:143]
    ds_write_b128 v13, v[120:123] offset:8192
    v_mfma_f32_16x16x32_bf16 v[144:147], a[196:199], v[36:39], v[144:147]
    s_waitcnt vmcnt(8)
    v_mfma_f32_16x16x32_bf16 v[128:131], a[80:83], v[40:43], v[128:131]
    buffer_load_dwordx4 v[36:39], v12, s[16:19], s43 offen offset:3072
    v_mfma_f32_16x16x32_bf16 v[132:135], a[84:87], v[40:43], v[132:135]
    ds_write_b128 v13, v[124:127] offset:9216
    v_mfma_f32_16x16x32_bf16 v[136:139], a[88:91], v[40:43], v[136:139]
    v_mfma_f32_16x16x32_bf16 v[140:143], a[92:95], v[40:43], v[140:143]
    v_mfma_f32_16x16x32_bf16 v[144:147], a[96:99], v[40:43], v[144:147]
    s_waitcnt vmcnt(8)
    v_mfma_f32_16x16x32_bf16 v[128:131], a[100:103], v[44:47], v[128:131]
    buffer_load_dwordx4 v[40:43], v12, s[16:19], s44 offen offset:0
    v_mfma_f32_16x16x32_bf16 v[132:135], a[104:107], v[44:47], v[132:135]
    v_mfma_f32_16x16x32_bf16 v[136:139], a[108:111], v[44:47], v[136:139]
    v_mfma_f32_16x16x32_bf16 v[140:143], a[112:115], v[44:47], v[140:143]
    v_mfma_f32_16x16x32_bf16 v[144:147], a[116:119], v[44:47], v[144:147]
    s_waitcnt vmcnt(8)
    v_mfma_f32_16x16x32_bf16 v[128:131], a[200:203], v[48:51], v[128:131]
    buffer_load_dwordx4 v[44:47], v12, s[16:19], s44 offen offset:1024
    v_mfma_f32_16x16x32_bf16 v[132:135], a[204:207], v[48:51], v[132:135]
    v_mfma_f32_16x16x32_bf16 v[136:139], a[208:211], v[48:51], v[136:139]
    v_mfma_f32_16x16x32_bf16 v[140:143], a[212:215], v[48:51], v[140:143]
    v_mfma_f32_16x16x32_bf16 v[144:147], a[216:219], v[48:51], v[144:147]
    s_waitcnt vmcnt(8)
    v_mfma_f32_16x16x32_bf16 v[128:131], a[220:223], v[52:55], v[128:131]
    buffer_load_dwordx4 v[48:51], v11, s[16:19], s44 offen offset:0
    v_mfma_f32_16x16x32_bf16 v[132:135], a[224:227], v[52:55], v[132:135]
    v_mfma_f32_16x16x32_bf16 v[136:139], a[228:231], v[52:55], v[136:139]
    v_mfma_f32_16x16x32_bf16 v[140:143], a[232:235], v[52:55], v[140:143]
    v_mfma_f32_16x16x32_bf16 v[144:147], a[236:239], v[52:55], v[144:147]
    s_waitcnt vmcnt(8)
    v_mfma_f32_16x16x32_bf16 v[148:151], a[160:163], v[56:59], v[148:151]
    buffer_load_dwordx4 v[52:55], v11, s[16:19], s44 offen offset:1024
    v_mfma_f32_16x16x32_bf16 v[152:155], a[164:167], v[56:59], v[152:155]
    ds_write_b128 v13, v[128:131] offset:10240
    v_mfma_f32_16x16x32_bf16 v[156:159], a[168:171], v[56:59], v[156:159]
    v_mfma_f32_16x16x32_bf16 v[160:163], a[172:175], v[56:59], v[160:163]
    ds_write_b128 v13, v[132:135] offset:11264
    v_mfma_f32_16x16x32_bf16 v[164:167], a[176:179], v[56:59], v[164:167]
    s_waitcnt vmcnt(8)
    v_mfma_f32_16x16x32_bf16 v[148:151], a[180:183], v[60:63], v[148:151]
    buffer_load_dwordx4 v[56:59], v12, s[16:19], s44 offen offset:2048
    v_mfma_f32_16x16x32_bf16 v[152:155], a[184:187], v[60:63], v[152:155]
    ds_write_b128 v13, v[136:139] offset:12288
    v_mfma_f32_16x16x32_bf16 v[156:159], a[188:191], v[60:63], v[156:159]
    v_mfma_f32_16x16x32_bf16 v[160:163], a[192:195], v[60:63], v[160:163]
    ds_write_b128 v13, v[140:143] offset:13312
    v_mfma_f32_16x16x32_bf16 v[164:167], a[196:199], v[60:63], v[164:167]
    s_waitcnt vmcnt(8)
    v_mfma_f32_16x16x32_bf16 v[148:151], a[80:83], v[16:19], v[148:151]
    buffer_load_dwordx4 v[60:63], v12, s[16:19], s44 offen offset:3072
    v_mfma_f32_16x16x32_bf16 v[152:155], a[84:87], v[16:19], v[152:155]
    ds_write_b128 v13, v[144:147] offset:14336
    v_mfma_f32_16x16x32_bf16 v[156:159], a[88:91], v[16:19], v[156:159]
    v_mfma_f32_16x16x32_bf16 v[160:163], a[92:95], v[16:19], v[160:163]
    v_mfma_f32_16x16x32_bf16 v[164:167], a[96:99], v[16:19], v[164:167]
    s_waitcnt vmcnt(8)
    v_mfma_f32_16x16x32_bf16 v[148:151], a[100:103], v[20:23], v[148:151]
    buffer_load_dwordx4 v[16:19], v12, s[16:19], s45 offen offset:0
    v_mfma_f32_16x16x32_bf16 v[152:155], a[104:107], v[20:23], v[152:155]
    v_mfma_f32_16x16x32_bf16 v[156:159], a[108:111], v[20:23], v[156:159]
    v_mfma_f32_16x16x32_bf16 v[160:163], a[112:115], v[20:23], v[160:163]
    v_mfma_f32_16x16x32_bf16 v[164:167], a[116:119], v[20:23], v[164:167]
    s_waitcnt vmcnt(8)
    v_mfma_f32_16x16x32_bf16 v[148:151], a[200:203], v[32:35], v[148:151]
    buffer_load_dwordx4 v[20:23], v12, s[16:19], s45 offen offset:1024
    v_mfma_f32_16x16x32_bf16 v[152:155], a[204:207], v[32:35], v[152:155]
    v_mfma_f32_16x16x32_bf16 v[156:159], a[208:211], v[32:35], v[156:159]
    v_mfma_f32_16x16x32_bf16 v[160:163], a[212:215], v[32:35], v[160:163]
    v_mfma_f32_16x16x32_bf16 v[164:167], a[216:219], v[32:35], v[164:167]
    s_waitcnt vmcnt(8)
    v_mfma_f32_16x16x32_bf16 v[148:151], a[220:223], v[36:39], v[148:151]
    buffer_load_dwordx4 v[32:35], v11, s[16:19], s45 offen offset:0
    v_mfma_f32_16x16x32_bf16 v[152:155], a[224:227], v[36:39], v[152:155]
    v_mfma_f32_16x16x32_bf16 v[156:159], a[228:231], v[36:39], v[156:159]
    v_mfma_f32_16x16x32_bf16 v[160:163], a[232:235], v[36:39], v[160:163]
    v_mfma_f32_16x16x32_bf16 v[164:167], a[236:239], v[36:39], v[164:167]
    s_waitcnt vmcnt(8)
    v_mfma_f32_16x16x32_bf16 v[168:171], a[160:163], v[40:43], v[168:171]
    buffer_load_dwordx4 v[36:39], v11, s[16:19], s45 offen offset:1024
    v_mfma_f32_16x16x32_bf16 v[172:175], a[164:167], v[40:43], v[172:175]
    ds_write_b128 v13, v[148:151] offset:15360
    v_mfma_f32_16x16x32_bf16 v[176:179], a[168:171], v[40:43], v[176:179]
    v_mfma_f32_16x16x32_bf16 v[180:183], a[172:175], v[40:43], v[180:183]
    ds_write_b128 v13, v[152:155] offset:16384
    v_mfma_f32_16x16x32_bf16 v[184:187], a[176:179], v[40:43], v[184:187]
    s_waitcnt vmcnt(8)
    v_mfma_f32_16x16x32_bf16 v[168:171], a[180:183], v[44:47], v[168:171]
    buffer_load_dwordx4 v[40:43], v12, s[16:19], s45 offen offset:2048
    v_mfma_f32_16x16x32_bf16 v[172:175], a[184:187], v[44:47], v[172:175]
    ds_write_b128 v13, v[156:159] offset:17408
    v_mfma_f32_16x16x32_bf16 v[176:179], a[188:191], v[44:47], v[176:179]
    v_mfma_f32_16x16x32_bf16 v[180:183], a[192:195], v[44:47], v[180:183]
    ds_write_b128 v13, v[160:163] offset:18432
    v_mfma_f32_16x16x32_bf16 v[184:187], a[196:199], v[44:47], v[184:187]
    s_waitcnt vmcnt(8)
    v_mfma_f32_16x16x32_bf16 v[168:171], a[80:83], v[48:51], v[168:171]
    buffer_load_dwordx4 v[44:47], v12, s[16:19], s45 offen offset:3072
    v_mfma_f32_16x16x32_bf16 v[172:175], a[84:87], v[48:51], v[172:175]
    ds_write_b128 v13, v[164:167] offset:19456
    v_mfma_f32_16x16x32_bf16 v[176:179], a[88:91], v[48:51], v[176:179]
    v_mfma_f32_16x16x32_bf16 v[180:183], a[92:95], v[48:51], v[180:183]
    v_mfma_f32_16x16x32_bf16 v[184:187], a[96:99], v[48:51], v[184:187]
    s_waitcnt vmcnt(8)
    v_mfma_f32_16x16x32_bf16 v[168:171], a[100:103], v[52:55], v[168:171]
    buffer_load_dwordx4 v[48:51], v12, s[16:19], s46 offen offset:0
    v_mfma_f32_16x16x32_bf16 v[172:175], a[104:107], v[52:55], v[172:175]
    v_mfma_f32_16x16x32_bf16 v[176:179], a[108:111], v[52:55], v[176:179]
    v_mfma_f32_16x16x32_bf16 v[180:183], a[112:115], v[52:55], v[180:183]
    v_mfma_f32_16x16x32_bf16 v[184:187], a[116:119], v[52:55], v[184:187]
    s_waitcnt vmcnt(8)
    v_mfma_f32_16x16x32_bf16 v[168:171], a[200:203], v[56:59], v[168:171]
    buffer_load_dwordx4 v[52:55], v12, s[16:19], s46 offen offset:1024
    v_mfma_f32_16x16x32_bf16 v[172:175], a[204:207], v[56:59], v[172:175]
    v_mfma_f32_16x16x32_bf16 v[176:179], a[208:211], v[56:59], v[176:179]
    v_mfma_f32_16x16x32_bf16 v[180:183], a[212:215], v[56:59], v[180:183]
    v_mfma_f32_16x16x32_bf16 v[184:187], a[216:219], v[56:59], v[184:187]
    s_waitcnt vmcnt(8)
    v_mfma_f32_16x16x32_bf16 v[168:171], a[220:223], v[60:63], v[168:171]
    buffer_load_dwordx4 v[56:59], v11, s[16:19], s46 offen offset:0
    v_mfma_f32_16x16x32_bf16 v[172:175], a[224:227], v[60:63], v[172:175]
    v_mfma_f32_16x16x32_bf16 v[176:179], a[228:231], v[60:63], v[176:179]
    v_mfma_f32_16x16x32_bf16 v[180:183], a[232:235], v[60:63], v[180:183]
    v_mfma_f32_16x16x32_bf16 v[184:187], a[236:239], v[60:63], v[184:187]
    s_waitcnt vmcnt(8)
    v_mfma_f32_16x16x32_bf16 v[188:191], a[160:163], v[16:19], v[188:191]
    buffer_load_dwordx4 v[60:63], v11, s[16:19], s46 offen offset:1024
    v_mfma_f32_16x16x32_bf16 v[192:195], a[164:167], v[16:19], v[192:195]
    ds_write_b128 v13, v[168:171] offset:20480
    v_mfma_f32_16x16x32_bf16 v[196:199], a[168:171], v[16:19], v[196:199]
    v_mfma_f32_16x16x32_bf16 v[200:203], a[172:175], v[16:19], v[200:203]
    ds_write_b128 v13, v[172:175] offset:21504
    v_mfma_f32_16x16x32_bf16 v[204:207], a[176:179], v[16:19], v[204:207]
    s_waitcnt vmcnt(8)
    v_mfma_f32_16x16x32_bf16 v[188:191], a[180:183], v[20:23], v[188:191]
    buffer_load_dwordx4 v[16:19], v12, s[16:19], s46 offen offset:2048
    v_mfma_f32_16x16x32_bf16 v[192:195], a[184:187], v[20:23], v[192:195]
    ds_write_b128 v13, v[176:179] offset:22528
    v_mfma_f32_16x16x32_bf16 v[196:199], a[188:191], v[20:23], v[196:199]
    v_mfma_f32_16x16x32_bf16 v[200:203], a[192:195], v[20:23], v[200:203]
    ds_write_b128 v13, v[180:183] offset:23552
    v_mfma_f32_16x16x32_bf16 v[204:207], a[196:199], v[20:23], v[204:207]
    s_waitcnt vmcnt(8)
    v_mfma_f32_16x16x32_bf16 v[188:191], a[80:83], v[32:35], v[188:191]
    buffer_load_dwordx4 v[20:23], v12, s[16:19], s46 offen offset:3072
    v_mfma_f32_16x16x32_bf16 v[192:195], a[84:87], v[32:35], v[192:195]
    ds_write_b128 v13, v[184:187] offset:24576
    v_mfma_f32_16x16x32_bf16 v[196:199], a[88:91], v[32:35], v[196:199]
    v_mfma_f32_16x16x32_bf16 v[200:203], a[92:95], v[32:35], v[200:203]
    v_mfma_f32_16x16x32_bf16 v[204:207], a[96:99], v[32:35], v[204:207]
    s_waitcnt vmcnt(8)
    v_mfma_f32_16x16x32_bf16 v[188:191], a[100:103], v[36:39], v[188:191]
    buffer_load_dwordx4 v[32:35], v12, s[16:19], s47 offen offset:0
    v_mfma_f32_16x16x32_bf16 v[192:195], a[104:107], v[36:39], v[192:195]
    v_mfma_f32_16x16x32_bf16 v[196:199], a[108:111], v[36:39], v[196:199]
    v_mfma_f32_16x16x32_bf16 v[200:203], a[112:115], v[36:39], v[200:203]
    v_mfma_f32_16x16x32_bf16 v[204:207], a[116:119], v[36:39], v[204:207]
    s_waitcnt vmcnt(8)
    v_mfma_f32_16x16x32_bf16 v[188:191], a[200:203], v[40:43], v[188:191]
    buffer_load_dwordx4 v[36:39], v12, s[16:19], s47 offen offset:1024
    v_mfma_f32_16x16x32_bf16 v[192:195], a[204:207], v[40:43], v[192:195]
    v_mfma_f32_16x16x32_bf16 v[196:199], a[208:211], v[40:43], v[196:199]
    v_mfma_f32_16x16x32_bf16 v[200:203], a[212:215], v[40:43], v[200:203]
    v_mfma_f32_16x16x32_bf16 v[204:207], a[216:219], v[40:43], v[204:207]
    s_waitcnt vmcnt(8)
    v_mfma_f32_16x16x32_bf16 v[188:191], a[220:223], v[44:47], v[188:191]
    buffer_load_dwordx4 v[40:43], v11, s[16:19], s47 offen offset:0
    v_mfma_f32_16x16x32_bf16 v[192:195], a[224:227], v[44:47], v[192:195]
    v_mfma_f32_16x16x32_bf16 v[196:199], a[228:231], v[44:47], v[196:199]
    v_mfma_f32_16x16x32_bf16 v[200:203], a[232:235], v[44:47], v[200:203]
    v_mfma_f32_16x16x32_bf16 v[204:207], a[236:239], v[44:47], v[204:207]
    s_waitcnt vmcnt(8)
    v_mfma_f32_16x16x32_bf16 v[208:211], a[160:163], v[48:51], v[208:211]
    buffer_load_dwordx4 v[44:47], v11, s[16:19], s47 offen offset:1024
    ds_write_b128 v13, v[188:191] offset:25600
    v_mfma_f32_16x16x32_bf16 v[212:215], a[164:167], v[48:51], v[212:215]
    ds_write_b128 v13, v[192:195] offset:26624
    v_mfma_f32_16x16x32_bf16 v[216:219], a[168:171], v[48:51], v[216:219]
    ds_write_b128 v13, v[196:199] offset:27648
    v_mfma_f32_16x16x32_bf16 v[220:223], a[172:175], v[48:51], v[220:223]
    ds_write_b128 v13, v[200:203] offset:28672
    v_mfma_f32_16x16x32_bf16 v[224:227], a[176:179], v[48:51], v[224:227]
    ds_write_b128 v13, v[204:207] offset:29696
    s_waitcnt vmcnt(8)
    v_mfma_f32_16x16x32_bf16 v[208:211], a[180:183], v[52:55], v[208:211]
    buffer_load_dwordx4 v[48:51], v12, s[16:19], s47 offen offset:2048
    v_mfma_f32_16x16x32_bf16 v[212:215], a[184:187], v[52:55], v[212:215]
    v_mfma_f32_16x16x32_bf16 v[216:219], a[188:191], v[52:55], v[216:219]
    v_mfma_f32_16x16x32_bf16 v[220:223], a[192:195], v[52:55], v[220:223]
    v_mfma_f32_16x16x32_bf16 v[224:227], a[196:199], v[52:55], v[224:227]
    s_waitcnt vmcnt(8)
    s_waitcnt lgkmcnt(0)
    s_barrier
    v_mfma_f32_16x16x32_bf16 v[208:211], a[80:83], v[56:59], v[208:211]
    buffer_load_dwordx4 v[52:55], v12, s[16:19], s47 offen offset:3072
    ds_read_b128 v[88:91], v6 offset:0
    ds_read_b128 v[92:95], v7 offset:10240
    v_mfma_f32_16x16x32_bf16 v[212:215], a[84:87], v[56:59], v[212:215]
    ds_read_b128 v[96:99], v8 offset:20480
    ds_read_b128 v[100:103], v6 offset:1024
    v_mfma_f32_16x16x32_bf16 v[216:219], a[88:91], v[56:59], v[216:219]
    ds_read_b128 v[104:107], v7 offset:11264
    ds_read_b128 v[108:111], v8 offset:21504
    v_mfma_f32_16x16x32_bf16 v[220:223], a[92:95], v[56:59], v[220:223]
    ds_read_b128 v[112:115], v6 offset:2048
    ds_read_b128 v[116:119], v7 offset:12288
    v_mfma_f32_16x16x32_bf16 v[224:227], a[96:99], v[56:59], v[224:227]
    ds_read_b128 v[120:123], v8 offset:22528
    ds_read_b128 v[124:127], v6 offset:3072
    s_waitcnt vmcnt(8)
    v_mfma_f32_16x16x32_bf16 v[208:211], a[100:103], v[60:63], v[208:211]
    buffer_load_dword v14, off, s[80:83], s55 sc1
    ds_read_b128 v[128:131], v7 offset:13312
    ds_read_b128 v[132:135], v8 offset:23552
    v_mfma_f32_16x16x32_bf16 v[212:215], a[104:107], v[60:63], v[212:215]
    ds_read_b128 v[136:139], v6 offset:4096
    ds_read_b128 v[140:143], v7 offset:14336
    v_mfma_f32_16x16x32_bf16 v[216:219], a[108:111], v[60:63], v[216:219]
    ds_read_b128 v[144:147], v8 offset:24576
    s_waitcnt lgkmcnt(12)
    v_add_f32 v88, v88, v92
    v_mfma_f32_16x16x32_bf16 v[220:223], a[112:115], v[60:63], v[220:223]
    v_add_f32 v89, v89, v93
    v_add_f32 v90, v90, v94
    v_mfma_f32_16x16x32_bf16 v[224:227], a[116:119], v[60:63], v[224:227]
    v_add_f32 v91, v91, v95
    v_add_f32 v88, v88, v96
    s_waitcnt vmcnt(8)
    v_mfma_f32_16x16x32_bf16 v[208:211], a[200:203], v[16:19], v[208:211]
    v_add_f32 v89, v89, v97
    v_add_f32 v90, v90, v98
    v_mfma_f32_16x16x32_bf16 v[212:215], a[204:207], v[16:19], v[212:215]
    v_add_f32 v91, v91, v99
    ds_read_b128 v[148:151], v6 offset:5120
    v_mfma_f32_16x16x32_bf16 v[216:219], a[208:211], v[16:19], v[216:219]
    ds_read_b128 v[152:155], v7 offset:15360
    ds_read_b128 v[156:159], v8 offset:25600
    v_mfma_f32_16x16x32_bf16 v[220:223], a[212:215], v[16:19], v[220:223]
    s_waitcnt lgkmcnt(12)
    v_add_f32 v100, v100, v104
    v_add_f32 v101, v101, v105
    v_mfma_f32_16x16x32_bf16 v[224:227], a[216:219], v[16:19], v[224:227]
    v_add_f32 v102, v102, v106
    v_add_f32 v103, v103, v107
    s_waitcnt vmcnt(7)
    v_mfma_f32_16x16x32_bf16 v[208:211], a[220:223], v[20:23], v[208:211]
    v_add_f32 v100, v100, v108
    v_add_f32 v101, v101, v109
    v_mfma_f32_16x16x32_bf16 v[212:215], a[224:227], v[20:23], v[212:215]
    v_add_f32 v102, v102, v110
    v_add_f32 v103, v103, v111
    v_mfma_f32_16x16x32_bf16 v[216:219], a[228:231], v[20:23], v[216:219]
    ds_read_b128 v[160:163], v6 offset:6144
    ds_read_b128 v[164:167], v7 offset:16384
    v_mfma_f32_16x16x32_bf16 v[220:223], a[232:235], v[20:23], v[220:223]
    ds_read_b128 v[168:171], v8 offset:26624
    s_waitcnt lgkmcnt(12)
    v_add_f32 v112, v112, v116
    v_mfma_f32_16x16x32_bf16 v[224:227], a[236:239], v[20:23], v[224:227]
    v_add_f32 v113, v113, v117
    v_add_f32 v114, v114, v118
    s_waitcnt vmcnt(6)
    v_mfma_f32_16x16x32_bf16 v[228:231], a[160:163], v[32:35], v[228:231]
    v_add_f32 v115, v115, v119
    v_add_f32 v112, v112, v120
    v_mfma_f32_16x16x32_bf16 v[232:235], a[164:167], v[32:35], v[232:235]
    v_add_f32 v113, v113, v121
    v_add_f32 v114, v114, v122
    v_mfma_f32_16x16x32_bf16 v[236:239], a[168:171], v[32:35], v[236:239]
    v_add_f32 v115, v115, v123
    ds_read_b128 v[172:175], v6 offset:7168
    v_mfma_f32_16x16x32_bf16 v[240:243], a[172:175], v[32:35], v[240:243]
    ds_read_b128 v[176:179], v7 offset:17408
    ds_read_b128 v[180:183], v8 offset:27648
    v_mfma_f32_16x16x32_bf16 v[244:247], a[176:179], v[32:35], v[244:247]
    s_waitcnt lgkmcnt(12)
    v_add_f32 v124, v124, v128
    v_add_f32 v125, v125, v129
    s_waitcnt vmcnt(5)
    v_mfma_f32_16x16x32_bf16 v[228:231], a[180:183], v[36:39], v[228:231]
    v_add_f32 v126, v126, v130
    v_add_f32 v127, v127, v131
    v_mfma_f32_16x16x32_bf16 v[232:235], a[184:187], v[36:39], v[232:235]
    v_add_f32 v124, v124, v132
    v_add_f32 v125, v125, v133
    v_mfma_f32_16x16x32_bf16 v[236:239], a[188:191], v[36:39], v[236:239]
    v_add_f32 v126, v126, v134
    v_add_f32 v127, v127, v135
    v_mfma_f32_16x16x32_bf16 v[240:243], a[192:195], v[36:39], v[240:243]
    ds_read_b128 v[184:187], v6 offset:8192
    ds_read_b128 v[188:191], v7 offset:18432
    v_mfma_f32_16x16x32_bf16 v[244:247], a[196:199], v[36:39], v[244:247]
    ds_read_b128 v[192:195], v8 offset:28672
    s_waitcnt lgkmcnt(12)
    v_add_f32 v136, v136, v140
    s_waitcnt vmcnt(4)
    v_mfma_f32_16x16x32_bf16 v[228:231], a[80:83], v[40:43], v[228:231]
    v_add_f32 v137, v137, v141
    v_add_f32 v138, v138, v142
    v_mfma_f32_16x16x32_bf16 v[232:235], a[84:87], v[40:43], v[232:235]
    v_add_f32 v139, v139, v143
    v_add_f32 v136, v136, v144
    v_mfma_f32_16x16x32_bf16 v[236:239], a[88:91], v[40:43], v[236:239]
    v_add_f32 v137, v137, v145
    v_add_f32 v138, v138, v146
    v_mfma_f32_16x16x32_bf16 v[240:243], a[92:95], v[40:43], v[240:243]
    v_add_f32 v139, v139, v147
    ds_read_b128 v[196:199], v6 offset:9216
    v_mfma_f32_16x16x32_bf16 v[244:247], a[96:99], v[40:43], v[244:247]
    ds_read_b128 v[200:203], v7 offset:19456
    ds_read_b128 v[204:207], v8 offset:29696
    s_waitcnt vmcnt(3)
    v_mfma_f32_16x16x32_bf16 v[228:231], a[100:103], v[44:47], v[228:231]
    s_waitcnt lgkmcnt(12)
    v_add_f32 v148, v148, v152
    v_add_f32 v149, v149, v153
    v_mfma_f32_16x16x32_bf16 v[232:235], a[104:107], v[44:47], v[232:235]
    v_add_f32 v150, v150, v154
    v_add_f32 v151, v151, v155
    v_mfma_f32_16x16x32_bf16 v[236:239], a[108:111], v[44:47], v[236:239]
    v_add_f32 v148, v148, v156
    v_add_f32 v149, v149, v157
    v_mfma_f32_16x16x32_bf16 v[240:243], a[112:115], v[44:47], v[240:243]
    v_add_f32 v150, v150, v158
    v_add_f32 v151, v151, v159
    v_mfma_f32_16x16x32_bf16 v[244:247], a[116:119], v[44:47], v[244:247]
    s_waitcnt lgkmcnt(9)
    v_add_f32 v160, v160, v164
    v_add_f32 v161, v161, v165
    s_waitcnt vmcnt(2)
    v_mfma_f32_16x16x32_bf16 v[228:231], a[200:203], v[48:51], v[228:231]
    v_add_f32 v162, v162, v166
    v_add_f32 v163, v163, v167
    v_mfma_f32_16x16x32_bf16 v[232:235], a[204:207], v[48:51], v[232:235]
    v_add_f32 v160, v160, v168
    v_add_f32 v161, v161, v169
    v_mfma_f32_16x16x32_bf16 v[236:239], a[208:211], v[48:51], v[236:239]
    v_add_f32 v162, v162, v170
    v_add_f32 v163, v163, v171
    v_mfma_f32_16x16x32_bf16 v[240:243], a[212:215], v[48:51], v[240:243]
    s_waitcnt lgkmcnt(6)
    v_add_f32 v172, v172, v176
    v_add_f32 v173, v173, v177
    v_mfma_f32_16x16x32_bf16 v[244:247], a[216:219], v[48:51], v[244:247]
    v_add_f32 v174, v174, v178
    v_add_f32 v175, v175, v179
    s_waitcnt vmcnt(1)
    v_mfma_f32_16x16x32_bf16 v[228:231], a[220:223], v[52:55], v[228:231]
    v_add_f32 v172, v172, v180
    v_add_f32 v173, v173, v181
    v_mfma_f32_16x16x32_bf16 v[232:235], a[224:227], v[52:55], v[232:235]
    v_add_f32 v174, v174, v182
    v_add_f32 v175, v175, v183
    v_mfma_f32_16x16x32_bf16 v[236:239], a[228:231], v[52:55], v[236:239]
    s_waitcnt lgkmcnt(3)
    v_add_f32 v184, v184, v188
    v_add_f32 v185, v185, v189
    v_mfma_f32_16x16x32_bf16 v[240:243], a[232:235], v[52:55], v[240:243]
    v_add_f32 v186, v186, v190
    v_add_f32 v187, v187, v191
    v_mfma_f32_16x16x32_bf16 v[244:247], a[236:239], v[52:55], v[244:247]
    v_add_f32 v184, v184, v192
    v_add_f32 v185, v185, v193
    v_add_f32 v186, v186, v194
    v_add_f32 v187, v187, v195
    s_waitcnt lgkmcnt(0)
    v_add_f32 v196, v196, v200
    v_add_f32 v197, v197, v201
    v_add_f32 v198, v198, v202
    v_add_f32 v199, v199, v203
    v_add_f32 v196, v196, v204
    v_add_f32 v197, v197, v205
    v_add_f32 v198, v198, v206
    v_add_f32 v199, v199, v207
    s_waitcnt vmcnt(0)
    s_mov_b32 s98, 0
PL_84:
    v_cmp_ne_u32 vcc, 1, v14
    s_cbranch_vccz PD_85
    s_add_u32 s98, s98, 1
    s_cmp_ge_u32 s98, 0x40000
    s_cbranch_scc1 PD_85
    s_sleep 4
    buffer_load_dword v14, off, s[80:83], s55 sc1
    s_waitcnt vmcnt(0)
    s_branch PL_84
PD_85:
    v_pk_add_f32 v[208:209], v[208:209], v[88:89]
    v_pk_add_f32 v[210:211], v[210:211], v[90:91]
    v_cvt_pk_bf16_f32 v16, v208, v209
    v_cvt_pk_bf16_f32 v17, v210, v211
    v_pk_add_f32 v[212:213], v[212:213], v[100:101]
    v_pk_add_f32 v[214:215], v[214:215], v[102:103]
    v_cvt_pk_bf16_f32 v18, v212, v213
    v_cvt_pk_bf16_f32 v19, v214, v215
    buffer_store_dwordx4 v[16:19], v9, s[8:11], 0 offen offset:0
    v_pk_add_f32 v[216:217], v[216:217], v[112:113]
    v_pk_add_f32 v[218:219], v[218:219], v[114:115]
    v_cvt_pk_bf16_f32 v20, v216, v217
    v_cvt_pk_bf16_f32 v21, v218, v219
    v_pk_add_f32 v[220:221], v[220:221], v[124:125]
    v_pk_add_f32 v[222:223], v[222:223], v[126:127]
    v_cvt_pk_bf16_f32 v22, v220, v221
    v_cvt_pk_bf16_f32 v23, v222, v223
    buffer_store_dwordx4 v[20:23], v9, s[8:11], 0 offen offset:1024
    v_pk_add_f32 v[228:229], v[228:229], v[148:149]
    v_pk_add_f32 v[230:231], v[230:231], v[150:151]
    v_cvt_pk_bf16_f32 v24, v228, v229
    v_cvt_pk_bf16_f32 v25, v230, v231
    v_pk_add_f32 v[232:233], v[232:233], v[160:161]
    v_pk_add_f32 v[234:235], v[234:235], v[162:163]
    v_cvt_pk_bf16_f32 v26, v232, v233
    v_cvt_pk_bf16_f32 v27, v234, v235
    buffer_store_dwordx4 v[24:27], v9, s[8:11], 0 offen offset:2048
    v_pk_add_f32 v[236:237], v[236:237], v[172:173]
    v_pk_add_f32 v[238:239], v[238:239], v[174:175]
    v_cvt_pk_bf16_f32 v28, v236, v237
    v_cvt_pk_bf16_f32 v29, v238, v239
    v_pk_add_f32 v[240:241], v[240:241], v[184:185]
    v_pk_add_f32 v[242:243], v[242:243], v[186:187]
    v_cvt_pk_bf16_f32 v30, v240, v241
    v_cvt_pk_bf16_f32 v31, v242, v243
    buffer_store_dwordx4 v[28:31], v9, s[8:11], 0 offen offset:3072
    v_pk_add_f32 v[224:225], v[224:225], v[136:137]
    v_pk_add_f32 v[226:227], v[226:227], v[138:139]
    v_cvt_pk_bf16_f32 v32, v224, v225
    v_cvt_pk_bf16_f32 v33, v226, v227
    v_pk_add_f32 v[244:245], v[244:245], v[196:197]
    v_pk_add_f32 v[246:247], v[246:247], v[198:199]
    v_cvt_pk_bf16_f32 v34, v244, v245
    v_cvt_pk_bf16_f32 v35, v246, v247
    v_add_u32 v9, 4096, v9
    buffer_store_dwordx4 v[32:35], v9, s[8:11], 0 offen offset:0
    v_mov_b32 v14, 1
    v_mov_b32 v15, 0
    s_waitcnt vmcnt(0)
    buffer_store_dword v14, v15, s[80:83], s56 offen
    s_branch KF_END
SLOW:
    s_waitcnt lgkmcnt(0)
    s_mov_b64 s[24:25], s[76:77]
    s_mov_b32 s84, s74
    s_mov_b32 s85, s75
    s_mov_b32 s86, 0x00000100
    s_mov_b32 s87, 0x00020000
    s_mov_b32 s88, s64
    s_mov_b32 s89, s65
    s_mov_b32 s90, 0x00280000
    s_mov_b32 s91, 0x00020000
    s_add_u32 s80, s76, 0x01400000
    s_addc_u32 s81, s77, 0
    s_mov_b32 s82, 0x00080000
    s_mov_b32 s83, 0x00020000
    s_mov_b32 s99, s2
    s_cmp_ge_u32 s2, 4
    s_cbranch_scc1 ZF_86
    s_and_b32 s3, s2, 1
    s_lshl_b32 s3, s3, 8
    v_add_u32 v24, s3, v0
    s_cmp_ge_u32 s2, 2
    s_cselect_b32 s3, 4, 7
    s_cselect_b32 s92, 0, 65536
    v_lshlrev_b32 v24, s3, v24
    v_mov_b32 v20, 0
    v_mov_b32 v21, 0
    v_mov_b32 v22, 0
    v_mov_b32 v23, 0
    buffer_store_dwordx4 v[20:23], v24, s[80:83], s92 offen sc1
ZF_86:
    s_and_b32 s3, s2, 7
    s_cmp_eq_u32 s3, s62
    s_cbranch_scc1 RESTART
    s_waitcnt vmcnt(0)
    s_barrier
    s_lshl_b32 s3, s20, 2
    s_add_u32 s3, s3, s99
    s_cmp_ge_u32 s3, 4
    s_cbranch_scc1 ZS_87
    v_mov_b32 v24, 1
    s_mov_b64 exec, 1
    buffer_store_byte v24, off, s[84:87], s99 sc1
    s_mov_b64 exec, -1
ZS_87:
    s_mov_b32 s99, 255
    s_cmp_lg_u32 s20, 0
    s_cbranch_scc1 W0_88
    buffer_load_dword v23, off, s[84:87], 0 sc1
    s_waitcnt vmcnt(0)
    s_mov_b32 s98, 0
PL_89:
    v_cmp_ne_u32 vcc, 0x01010101, v23
    s_cbranch_vccz PD_90
    s_add_u32 s98, s98, 1
    s_cmp_ge_u32 s98, 0x40000
    s_cbranch_scc1 PD_90
    s_sleep 4
    buffer_load_dword v23, off, s[84:87], 0 sc1
    s_waitcnt vmcnt(0)
    s_branch PL_89
PD_90:
    s_lshl_b32 s96, s62, 2
    s_add_u32 s96, s96, 128
    v_mov_b32 v20, 1
    s_mov_b64 exec, 1
    buffer_atomic_add v20, off, s[84:87], s96 sc1
    s_mov_b64 exec, -1
    v_bfe_u32 v21, v1, 1, 4
    v_lshlrev_b32 v21, 4, v21
    v_and_b32 v22, 1, v1
    v_add_u32 v21, v21, v22
    s_lshl_b32 s92, s62, 1
    v_add_u32 v21, s92, v21
    v_lshlrev_b32 v21, 7, v21
    v_add_u32 v21, 98304, v21
    v_lshlrev_b32 v22, 5, v1
    v_min_u32 v22, 64, v22
    s_mov_b32 s98, 0
CL_L:
    buffer_load_dword v23, v21, s[80:83], 0 offen sc1
    buffer_load_dword v24, v22, s[84:87], s96 offen sc1
    s_waitcnt vmcnt(0)
    v_cmp_eq_u32 vcc, 1, v23
    v_readlane_b32 s94, v24, 0
    v_readlane_b32 s95, v24, 2
    s_nop 3
    s_mov_b32 s92, vcc_lo
    s_bcnt1_i32_b32 s93, s92
    s_add_u32 s93, s93, s94
    s_cmp_ge_u32 s93, 32
    s_cbranch_scc1 CL_D
    s_add_u32 s98, s98, 1
    s_cmp_ge_u32 s98, 0x20000
    s_cbranch_scc1 CL_D
    s_sleep 8
    s_branch CL_L
CL_D:
    s_or_b32 s92, s92, s95
    s_add_u32 s96, s96, 64
CL_C:
    s_not_b32 s93, s92
    s_cbranch_scc0 CL_E
    s_ff1_i32_b32 s63, s93
    s_lshl_b32 s93, 1, s63
    v_mov_b32 v20, s93
    s_mov_b64 exec, 1
    buffer_atomic_or v20, off, s[84:87], s96 sc0 sc1
    s_mov_b64 exec, -1
    s_waitcnt vmcnt(0)
    v_readfirstlane_b32 s94, v20
    s_nop 3
    s_or_b32 s92, s92, s94
    s_and_b32 s94, s94, s93
    s_cbranch_scc1 CL_C
CL_E:
    v_mov_b32 v24, s63
    v_mov_b32 v25, 162816
    ds_write_b32 v25, v24
    s_waitcnt lgkmcnt(0)
W0_88:
    s_barrier
    v_mov_b32 v25, 162816
    ds_read_b32 v24, v25
    s_waitcnt lgkmcnt(0)
    v_readfirstlane_b32 s63, v24
    s_nop 3
    s_and_b32 s63, s63, 31
    s_lshl_b32 s2, s63, 3
    s_add_u32 s2, s2, s62
    s_branch RESTART
KF_END:
    s_endpgm
.section .rodata,"a"
.p2align 6
.amdhsa_kernel kf_kernel
  .amdhsa_next_free_vgpr 512
  .amdhsa_next_free_sgpr 102
  .amdhsa_accum_offset 256
  .amdhsa_group_segment_fixed_size 0
  .amdhsa_kernarg_size 88
  .amdhsa_user_sgpr_count 2
  .amdhsa_user_sgpr_kernarg_segment_ptr 1
  .amdhsa_system_sgpr_workgroup_id_x 1
  .amdhsa_float_denorm_mode_32 3
.end_amdhsa_kernel
```
